```python
import torch

def _softmax(x, axis=-1):
    return torch.softmax(x, dim=axis)
def _gelu(x):
    return torch.nn.functional.gelu(x, approximate="tanh")
def _silu(x):
    return torch.nn.functional.silu(x)
def _sigmoid(x):
    return torch.sigmoid(x)
def _layernorm(x, axis=-1, eps=1e-5):
    m = x.mean(dim=axis, keepdim=True)
    v = x.var(dim=axis, keepdim=True, unbiased=False)
    return (x - m) / torch.sqrt(v + eps)
def _scatter_add(tgt, idx, src, axis=0):
    return tgt.clone().index_add_(axis, idx, src)
def _segment_sum(src, seg, n):
    out = torch.zeros((n,) + src.shape[1:], dtype=src.dtype)
    return out.index_add_(0, seg, src)
def _pad(x, pw):
    flat = tuple(v for pair in reversed(pw) for v in pair)
    return torch.nn.functional.pad(x, flat)

kernel_name = 'concat_heads__mha_block_cached__gqa_block_cached__near_ridge'

def setup_inputs():

    _w = (lambda a: (lambda t: t.to(torch.bfloat16) if t.is_floating_point() else t)(torch.as_tensor(a)))
    def _A_setup():
        B, Sq, D = 8, 160, 576
        H, Sk, Dh = 32, 512, 128
        return {
            "x": _w((lambda *s: torch.randn(*s, dtype=torch.bfloat16) * 0.8)(B, Sq, D)),
            "k_cache": _w((lambda *s: torch.randn(*s, dtype=torch.bfloat16) * 0.8)(B, H, Sk, Dh)),
            "v_cache": _w((lambda *s: torch.randn(*s, dtype=torch.bfloat16) * 0.05)(B, H, Sk, Dh)),
            "wq": _w((lambda *s: torch.randn(*s, dtype=torch.bfloat16) * 0.8)(D, H * Dh) * (D ** -0.5)),
            "wo": _w((lambda *s: torch.randn(*s, dtype=torch.bfloat16) * 0.05)(H * Dh, D) * ((H * Dh) ** -0.5)),
        }
    _A_in = _A_setup()

    def _B_setup():
        B, Sq, D = 8, 160, 576
        Hq, Hkv, Sk, Dh = 32, 32, 512, 128
        assert Hq % Hkv == 0, (Hq, Hkv)
        return {
            "x": _w((lambda *s: torch.randn(*s, dtype=torch.bfloat16) * 0.8)(B, Sq, D)),
            "k_cache": _w((lambda *s: torch.randn(*s, dtype=torch.bfloat16) * 0.8)(B, Hkv, Sk, Dh)),
            "v_cache": _w((lambda *s: torch.randn(*s, dtype=torch.bfloat16) * 0.05)(B, Hkv, Sk, Dh)),
            "wq": _w((lambda *s: torch.randn(*s, dtype=torch.bfloat16) * 0.8)(D, Hq * Dh) * (D ** -0.5)),
            "wo": _w((lambda *s: torch.randn(*s, dtype=torch.bfloat16) * 0.05)(Hq * Dh, D) * ((Hq * Dh) ** -0.5)),
        }
    _B_in = _B_setup()

    return {
        "A_x": _A_in["x"],
        "A_k_cache": _A_in["k_cache"],
        "A_v_cache": _A_in["v_cache"],
        "A_wq": _A_in["wq"],
        "A_wo": _A_in["wo"],
        "B_x": _B_in["x"],
        "B_k_cache": _B_in["k_cache"],
        "B_v_cache": _B_in["v_cache"],
        "B_wq": _B_in["wq"],
        "B_wo": _B_in["wo"],
    }

def reference(A_x, A_k_cache, A_v_cache, A_wq, A_wo, B_x, B_k_cache, B_v_cache, B_wq, B_wo):
    def _A_ref(x, k_cache, v_cache, wq, wo):
        B, Sq, D = x.shape
        H, Dh = 32, 128
        q = (lambda x, *d: x.permute(*d))((x @ wq).reshape(B, Sq, H, Dh), 0, 2, 1, 3)
        scores = torch.einsum("bhqd,bhkd->bhqk", q, k_cache) * (Dh ** -0.5)
        p = _softmax(scores, axis=-1)
        o = torch.einsum("bhqk,bhkd->bhqd", p, v_cache)
        return (lambda x, *d: x.permute(*d))(o, 0, 2, 1, 3).reshape(B, Sq, H * Dh) @ wo

    def _B_ref(x, k_cache, v_cache, wq, wo):
        B, Sq, D = x.shape
        Hq, Dh = 32, 128
        Hkv = k_cache.shape[1]
        rep = Hq // Hkv
        q = (lambda x, *d: x.permute(*d))((x @ wq).reshape(B, Sq, Hq, Dh), 0, 2, 1, 3)
        k = (lambda x, n, axis: torch.repeat_interleave(x, n, dim=axis))(k_cache, rep, axis=1)
        v = (lambda x, n, axis: torch.repeat_interleave(x, n, dim=axis))(v_cache, rep, axis=1)
        scores = torch.einsum("bhqd,bhkd->bhqk", q, k) * (Dh ** -0.5)
        p = _softmax(scores, axis=-1)
        o = torch.einsum("bhqk,bhkd->bhqd", p, v)
        return (lambda x, *d: x.permute(*d))(o, 0, 2, 1, 3).reshape(B, Sq, Hq * Dh) @ wo

    a = _A_ref(A_x, A_k_cache, A_v_cache, A_wq, A_wo)
    b = _B_ref(B_x, B_k_cache, B_v_cache, B_wq, B_wo)
    return torch.concatenate([a, b], axis=-1)
```

```asm
; @launch grid=(256,1,1) block=(512,1,1) lds=163840
.amdgcn_target "amdgcn-amd-amdhsa--gfx950"
.text
.globl concat_heads__mha_block_cached__gqa_block_cached__near_ridge_kernel
.p2align 8
.type concat_heads__mha_block_cached__gqa_block_cached__near_ridge_kernel,@function
concat_heads__mha_block_cached__gqa_block_cached__near_ridge_kernel:
    s_cmp_ge_u32 s2, 256
    s_cbranch_scc1 L_k1_end
    s_and_b32 s3, s2, 7
    s_lshr_b32 s34, s3, 2
    s_and_b32 s37, s3, 3
    s_lshr_b32 s3, s2, 3
    s_and_b32 s35, s3, 7
    s_lshr_b32 s38, s3, 3
    s_lshl_b32 s36, s37, 3
    s_add_u32 s36, s36, s38
    s_mul_i32 s5, s34, 40
    s_add_u32 s6, s0, s5
    s_addc_u32 s7, s1, 0
    s_load_dwordx4 s[80:83], s[6:7], 0
    s_load_dwordx4 s[84:87], s[6:7], 16
    s_load_dwordx2 s[64:65], s[6:7], 32
    s_load_dwordx4 s[4:7], s[0:1], 88
    v_lshrrev_b32 v2, 6, v0
    v_and_b32 v1, 63, v0
    v_readfirstlane_b32 s33, v2
    s_mov_b32 s52, 0xffff0000
    s_mov_b32 s53, 0xffff0000
    s_and_b32 s40, s33, 3
    s_mov_b32 s45, 0x30868630
    s_lshl_b32 s46, s33, 2
    s_lshr_b32 s45, s45, s46
    s_and_b32 s39, s45, 15
    s_and_b32 s59, s2, 7
    s_lshl_b32 s59, s59, 3
    s_add_u32 s59, s59, s35
    s_lshl_b32 s57, s40, 11
    s_mul_i32 s45, s35, 184320
    s_lshl_b32 s46, s35, 5
    s_add_u32 s46, s46, s36
    s_lshl_b32 s46, s46, 17
    s_waitcnt lgkmcnt(0)
    s_add_u32 s8, s80, s45
    s_addc_u32 s9, s81, 0
    s_mov_b32 s10, 184320
    s_mov_b32 s11, 0x20000
    s_add_u32 s16, s82, s46
    s_addc_u32 s17, s83, 0
    s_mov_b32 s18, 655360
    s_mov_b32 s19, 0x20000
    s_add_u32 s20, s84, s46
    s_addc_u32 s21, s85, 0
    s_mov_b32 s22, 655360
    s_mov_b32 s23, 0x20000
    s_mov_b32 s12, s86
    s_mov_b32 s13, s87
    s_mov_b32 s14, 4718592
    s_mov_b32 s15, 0x20000
    s_mov_b32 s24, s64
    s_mov_b32 s25, s65
    s_mov_b32 s26, 4718592
    s_mov_b32 s27, 0x20000
    s_mov_b32 s28, s6
    s_mov_b32 s29, s7
    s_mov_b32 s30, 268435456
    s_mov_b32 s31, 0x20000
    s_mov_b32 s44, 0
    s_mov_b32 s43, 0
    s_lshl_b32 s45, s59, 8
    s_lshl_b32 s46, s38, 2
    s_add_u32 s45, s45, s46
    s_add_u32 s49, s45, 117440512
    s_lshl_b32 s48, s34, 2
    s_add_u32 s48, s48, s38
    s_lshl_b32 s48, s48, 3
    s_add_u32 s48, s48, s35
    s_cmp_lg_u32 s33, 0
    s_cbranch_scc1 L_frs_1
    v_mov_b32 v2, 0
    s_mov_b64 s[70:71], exec
    s_mov_b64 exec, 1
    buffer_store_dword v2, v2, s[28:31], s49 offen sc0 sc1
    s_lshl_b32 s45, s48, 8
    s_lshl_b32 s46, s37, 2
    s_add_u32 s45, s45, s46
    s_add_u32 s45, s45, 117456896
    buffer_store_dword v2, v2, s[28:31], s45 offen sc0 sc1
    s_mov_b64 exec, s[70:71]
L_frs_1:
    s_add_u32 s45, s33, 2
    s_and_b32 s45, s45, 7
    s_cmp_lt_u32 s45, 4
    s_cbranch_scc0 L_nq2
    s_cmp_ge_u32 s33, 4
    s_cbranch_scc1 L_gw_2
    v_lshrrev_b32 v2, 4, v1
    v_and_b32 v6, 1, v2
    v_lshrrev_b32 v7, 1, v2
    v_lshlrev_b32 v7, 2, v7
    v_or_b32 v6, v6, v7
    s_and_b32 s45, s40, 1
    s_lshl_b32 s45, s45, 3
    v_or_b32 v6, s45, v6
    v_and_b32 v7, 15, v1
    v_xor_b32 v6, v6, v7
    v_lshlrev_b32 v6, 4, v6
    v_lshlrev_b32 v7, 13, v2
    v_add_u32 v28, v6, v7
    v_add_u32 v29, 31744, v28
    v_lshrrev_b32 v6, 3, v1
    v_mul_u32_u24 v6, 1152, v6
    v_and_b32 v7, 7, v1
    v_xor_b32 v7, v7, v2
    v_lshlrev_b32 v7, 4, v7
    s_and_b32 s45, s40, 1
    s_lshl_b32 s45, s45, 6
    v_xor_b32 v7, s45, v7
    v_xor_b32 v5, 64, v7
    v_add_u32 v32, v6, v7
    v_add_u32 v33, v6, v5
    v_add_u32 v33, 8192, v33
    v_add_u32 v34, v6, v7
    v_add_u32 v34, 16384, v34
    v_add_u32 v35, v6, v5
    v_add_u32 v35, 24576, v35
    v_add_u32 v36, v6, v7
    v_add_u32 v36, 36864, v36
    s_lshl_b32 s63, s40, 16
    s_lshl_b32 s45, s36, 8
    s_add_u32 s63, s63, s45
    s_lshl_b32 s69, s40, 11
    s_add_u32 s69, s69, 122880
    s_mul_i32 s72, s40, 46080
    s_mul_i32 s73, s40, 5120
    s_add_u32 s73, s73, 81920
    s_lshl_b32 s45, s38, 1
    s_add_u32 s45, s45, s35
    s_sub_u32 s46, s45, 9
    s_cmp_ge_u32 s45, 9
    s_cselect_b32 s45, s46, s45
    s_lshl_b32 s62, s45, 19
    s_lshl_b32 s66, s45, 7
    s_mov_b32 s65, 0
    s_mov_b32 s68, 0
    s_mov_b32 s64, 0
    s_mov_b32 s67, 0
    s_add_u32 s76, s66, s72
    s_add_u32 s77, s68, s73
    s_mov_b32 m0, s77
    s_add_u32 s66, s66, 128
    buffer_load_dwordx4 v32, s[8:11], s76 offen  lds
    s_cmp_eq_u32 s66, 1152
    s_cselect_b32 s66, 0, s66
    s_mov_b32 m0, s77
    s_nop 0
    buffer_load_dwordx4 v33, s[8:11], s76 offen offset:1024  lds
    s_mov_b32 m0, s77
    s_nop 0
    buffer_load_dwordx4 v34, s[8:11], s76 offen offset:2048  lds
    s_mov_b32 m0, s77
    s_nop 0
    buffer_load_dwordx4 v35, s[8:11], s76 offen offset:3072  lds
    s_add_u32 s77, s77, 4096
    s_mov_b32 m0, s77
    s_sub_u32 s68, 20480, s68
    buffer_load_dwordx4 v36, s[8:11], s76 offen  lds
    v_lshrrev_b32 v2, 4, v1
    v_and_b32 v3, 15, v1
    s_and_b32 s45, s40, 1
    s_lshl_b32 s45, s45, 3
    v_add_u32 v4, s45, v2
    v_xor_b32 v4, v4, v3
    v_lshlrev_b32 v4, 4, v4
    v_lshlrev_b32 v5, 8, v2
    v_add_u32 v8, v4, v5
    v_lshlrev_b32 v4, 1, v2
    v_xor_b32 v4, v4, v3
    v_lshlrev_b32 v4, 4, v4
    v_add_u32 v9, v4, v5
    s_mov_b32 s79, 0
    v_lshrrev_b32 v2, 4, v1
    v_bfe_u32 v3, v1, 2, 2
    v_and_b32 v4, 3, v1
    v_lshlrev_b32 v5, 3, v2
    v_add_u32 v5, v5, v3
    v_and_b32 v6, 1, v3
    v_lshrrev_b32 v7, 1, v3
    v_lshlrev_b32 v7, 2, v7
    v_or_b32 v6, v6, v7
    v_and_b32 v7, 1, v2
    v_lshlrev_b32 v7, 3, v7
    v_or_b32 v6, v6, v7
    v_xor_b32 v6, v6, v4
    v_lshlrev_b32 v6, 4, v6
    v_lshlrev_b32 v5, 8, v5
    v_add_u32 v5, v5, v6
    v_and_b32 v6, 1, v4
    v_lshlrev_b32 v6, 3, v6
    v_add_u32 v5, v5, v6
    v_xor_b32 v5, s79, v5
    v_add_u32 v5, 122880, v5
    v_mov_b32 v20, v5
    v_xor_b32 v21, 8, v5
    v_xor_b32 v22, 64, v5
    v_xor_b32 v23, 72, v5
    v_and_b32 v6, 15, v1
    v_lshrrev_b32 v7, 1, v6
    v_xor_b32 v7, v7, v2
    v_lshlrev_b32 v7, 4, v7
    v_lshlrev_b32 v6, 7, v6
    v_add_u32 v6, v6, v7
    s_lshl_b32 s45, s39, 11
    s_add_u32 s45, s45, 81920
    v_add_u32 v10, s45, v6
    v_xor_b32 v11, 64, v10
    s_mov_b32 s78, 0
    s_mov_b32 s54, 20480
    v_mov_b64 v[160:161], 0
    v_mov_b64 v[162:163], 0
    v_mov_b64 v[164:165], 0
    v_mov_b64 v[166:167], 0
    v_mov_b64 v[168:169], 0
    v_mov_b64 v[170:171], 0
    v_mov_b64 v[172:173], 0
    v_mov_b64 v[174:175], 0
    v_mov_b64 v[176:177], 0
    v_mov_b64 v[178:179], 0
    v_mov_b64 v[180:181], 0
    v_mov_b64 v[182:183], 0
    v_mov_b64 v[184:185], 0
    v_mov_b64 v[186:187], 0
    v_mov_b64 v[188:189], 0
    v_mov_b64 v[190:191], 0
    v_mov_b64 v[192:193], 0
    v_mov_b64 v[194:195], 0
    v_mov_b64 v[196:197], 0
    v_mov_b64 v[198:199], 0
    v_mov_b64 v[200:201], 0
    v_mov_b64 v[202:203], 0
    v_mov_b64 v[204:205], 0
    v_mov_b64 v[206:207], 0
    s_waitcnt vmcnt(0)
    s_barrier
    s_add_u32 s76, s66, s72
    s_add_u32 s77, s68, s73
    s_mov_b32 m0, s77
    s_add_u32 s66, s66, 128
    buffer_load_dwordx4 v32, s[8:11], s76 offen  lds
    s_cmp_eq_u32 s66, 1152
    s_cselect_b32 s66, 0, s66
    s_mov_b32 m0, s77
    s_nop 0
    buffer_load_dwordx4 v33, s[8:11], s76 offen offset:1024  lds
    s_mov_b32 m0, s77
    s_nop 0
    buffer_load_dwordx4 v34, s[8:11], s76 offen offset:2048  lds
    s_mov_b32 m0, s77
    s_nop 0
    buffer_load_dwordx4 v35, s[8:11], s76 offen offset:3072  lds
    s_add_u32 s77, s77, 4096
    s_mov_b32 m0, s77
    s_sub_u32 s68, 20480, s68
    buffer_load_dwordx4 v36, s[8:11], s76 offen  lds
    ds_read_b128 v[88:91], v10 offset:0
    ds_read_b128 v[92:95], v10 offset:2048
    ds_read_b128 v[96:99], v10 offset:4096
    ds_read_b64_tr_b16 v[56:57], v20
    ds_read_b64_tr_b16 v[58:59], v20 offset:1024
    ds_read_b64_tr_b16 v[60:61], v21
    ds_read_b64_tr_b16 v[62:63], v21 offset:1024
    ds_read_b64_tr_b16 v[64:65], v22
    ds_read_b64_tr_b16 v[66:67], v22 offset:1024
    ds_read_b64_tr_b16 v[68:69], v23
    ds_read_b64_tr_b16 v[70:71], v23 offset:1024
    s_add_u32 s78, s78, 8192
    s_mov_b32 s55, 8192
    s_cmp_eq_u32 s78, 32768
    s_cselect_b32 s78, 0, s78
    s_cselect_b32 s55, 4294942720, s55
    v_add_u32 v20, s55, v20
    v_add_u32 v21, s55, v21
    v_add_u32 v22, s55, v22
    v_add_u32 v23, s55, v23
    s_waitcnt lgkmcnt(0)
    s_mov_b32 s41, 0
L_q0_3:
    s_cmp_lg_u32 s41, 2
    s_cbranch_scc1 L_wo0_4
    v_lshlrev_b32 v7, 7, v1
    s_lshl_b32 s45, s38, 3
    s_add_u32 s45, s45, s35
    s_mul_i32 s45, s45, 36864
    s_mul_i32 s46, s37, 1179648
    s_add_u32 s45, s45, s46
    s_mul_i32 s47, s40, 9216
    s_add_u32 s47, s47, s45
    buffer_load_dword v40, v7, s[24:27], s47 offen
    s_add_u32 s47, s47, 1024
    buffer_load_dword v40, v7, s[24:27], s47 offen
L_wo0_4:
    s_barrier
    v_mfma_f32_16x16x32_bf16 v[160:163], v[56:59], v[88:91], v[160:163]
    ds_read_b128 v[100:103], v11 offset:0
    v_mfma_f32_16x16x32_bf16 v[176:179], v[56:59], v[92:95], v[176:179]
    ds_read_b128 v[104:107], v11 offset:2048
    v_mfma_f32_16x16x32_bf16 v[192:195], v[56:59], v[96:99], v[192:195]
    ds_read_b128 v[108:111], v11 offset:4096
    v_mfma_f32_16x16x32_bf16 v[164:167], v[60:63], v[88:91], v[164:167]
    ds_read_b64_tr_b16 v[72:73], v20
    ds_read_b64_tr_b16 v[74:75], v20 offset:1024
    v_mfma_f32_16x16x32_bf16 v[180:183], v[60:63], v[92:95], v[180:183]
    ds_read_b64_tr_b16 v[76:77], v21
    ds_read_b64_tr_b16 v[78:79], v21 offset:1024
    v_mfma_f32_16x16x32_bf16 v[196:199], v[60:63], v[96:99], v[196:199]
    ds_read_b64_tr_b16 v[80:81], v22
    ds_read_b64_tr_b16 v[82:83], v22 offset:1024
    v_mfma_f32_16x16x32_bf16 v[168:171], v[64:67], v[88:91], v[168:171]
    v_mfma_f32_16x16x32_bf16 v[184:187], v[64:67], v[92:95], v[184:187]
    ds_read_b64_tr_b16 v[84:85], v23
    ds_read_b64_tr_b16 v[86:87], v23 offset:1024
    v_mfma_f32_16x16x32_bf16 v[200:203], v[64:67], v[96:99], v[200:203]
    v_mfma_f32_16x16x32_bf16 v[172:175], v[68:71], v[88:91], v[172:175]
    s_add_u32 s78, s78, 8192
    s_mov_b32 s55, 8192
    s_cmp_eq_u32 s78, 32768
    s_cselect_b32 s78, 0, s78
    s_cselect_b32 s55, 4294942720, s55
    v_add_u32 v20, s55, v20
    v_add_u32 v21, s55, v21
    v_mfma_f32_16x16x32_bf16 v[188:191], v[68:71], v[92:95], v[188:191]
    v_add_u32 v22, s55, v22
    v_add_u32 v23, s55, v23
    v_mfma_f32_16x16x32_bf16 v[204:207], v[68:71], v[96:99], v[204:207]
    v_add_u32 v10, s54, v10
    v_add_u32 v11, s54, v11
    s_sub_u32 s54, 0, s54
    s_waitcnt lgkmcnt(0)
    s_cmp_eq_u32 s41, 2
    s_cbranch_scc1 L_xw_5
    s_waitcnt vmcnt(0)
    s_branch L_xw2_6
L_xw_5:
    s_waitcnt vmcnt(2)
L_xw2_6:
    s_barrier
    v_mfma_f32_16x16x32_bf16 v[160:163], v[72:75], v[100:103], v[160:163]
    ds_read_b128 v[88:91], v10 offset:0
    v_mfma_f32_16x16x32_bf16 v[176:179], v[72:75], v[104:107], v[176:179]
    ds_read_b128 v[92:95], v10 offset:2048
    s_add_u32 s76, s66, s72
    s_add_u32 s77, s68, s73
    s_mov_b32 m0, s77
    s_add_u32 s66, s66, 128
    buffer_load_dwordx4 v32, s[8:11], s76 offen  lds
    s_cmp_eq_u32 s66, 1152
    s_cselect_b32 s66, 0, s66
    v_mfma_f32_16x16x32_bf16 v[192:195], v[72:75], v[108:111], v[192:195]
    ds_read_b128 v[96:99], v10 offset:4096
    v_mfma_f32_16x16x32_bf16 v[164:167], v[76:79], v[100:103], v[164:167]
    ds_read_b64_tr_b16 v[56:57], v20
    ds_read_b64_tr_b16 v[58:59], v20 offset:1024
    s_mov_b32 m0, s77
    s_nop 0
    buffer_load_dwordx4 v33, s[8:11], s76 offen offset:1024  lds
    v_mfma_f32_16x16x32_bf16 v[180:183], v[76:79], v[104:107], v[180:183]
    ds_read_b64_tr_b16 v[60:61], v21
    ds_read_b64_tr_b16 v[62:63], v21 offset:1024
    v_mfma_f32_16x16x32_bf16 v[196:199], v[76:79], v[108:111], v[196:199]
    ds_read_b64_tr_b16 v[64:65], v22
    ds_read_b64_tr_b16 v[66:67], v22 offset:1024
    v_mfma_f32_16x16x32_bf16 v[168:171], v[80:83], v[100:103], v[168:171]
    s_mov_b32 m0, s77
    s_nop 0
    buffer_load_dwordx4 v34, s[8:11], s76 offen offset:2048  lds
    v_mfma_f32_16x16x32_bf16 v[184:187], v[80:83], v[104:107], v[184:187]
    ds_read_b64_tr_b16 v[68:69], v23
    ds_read_b64_tr_b16 v[70:71], v23 offset:1024
    v_mfma_f32_16x16x32_bf16 v[200:203], v[80:83], v[108:111], v[200:203]
    s_mov_b32 m0, s77
    s_nop 0
    buffer_load_dwordx4 v35, s[8:11], s76 offen offset:3072  lds
    v_mfma_f32_16x16x32_bf16 v[172:175], v[84:87], v[100:103], v[172:175]
    s_add_u32 s78, s78, 8192
    s_mov_b32 s55, 8192
    s_cmp_eq_u32 s78, 32768
    s_cselect_b32 s78, 0, s78
    s_cselect_b32 s55, 4294942720, s55
    v_mfma_f32_16x16x32_bf16 v[188:191], v[84:87], v[104:107], v[188:191]
    v_add_u32 v20, s55, v20
    v_add_u32 v21, s55, v21
    s_add_u32 s77, s77, 4096
    s_mov_b32 m0, s77
    s_sub_u32 s68, 20480, s68
    buffer_load_dwordx4 v36, s[8:11], s76 offen  lds
    v_mfma_f32_16x16x32_bf16 v[204:207], v[84:87], v[108:111], v[204:207]
    v_add_u32 v22, s55, v22
    v_add_u32 v23, s55, v23
    s_waitcnt lgkmcnt(0)
    s_add_u32 s41, s41, 1
    s_cmp_lt_u32 s41, 7
    s_cbranch_scc1 L_q0_3
    s_barrier
    v_mfma_f32_16x16x32_bf16 v[160:163], v[56:59], v[88:91], v[160:163]
    ds_read_b128 v[100:103], v11 offset:0
    v_mfma_f32_16x16x32_bf16 v[176:179], v[56:59], v[92:95], v[176:179]
    ds_read_b128 v[104:107], v11 offset:2048
    v_mfma_f32_16x16x32_bf16 v[192:195], v[56:59], v[96:99], v[192:195]
    ds_read_b128 v[108:111], v11 offset:4096
    v_mfma_f32_16x16x32_bf16 v[164:167], v[60:63], v[88:91], v[164:167]
    ds_read_b64_tr_b16 v[72:73], v20
    ds_read_b64_tr_b16 v[74:75], v20 offset:1024
    v_mfma_f32_16x16x32_bf16 v[180:183], v[60:63], v[92:95], v[180:183]
    ds_read_b64_tr_b16 v[76:77], v21
    ds_read_b64_tr_b16 v[78:79], v21 offset:1024
    v_mfma_f32_16x16x32_bf16 v[196:199], v[60:63], v[96:99], v[196:199]
    ds_read_b64_tr_b16 v[80:81], v22
    ds_read_b64_tr_b16 v[82:83], v22 offset:1024
    v_mfma_f32_16x16x32_bf16 v[168:171], v[64:67], v[88:91], v[168:171]
    v_mfma_f32_16x16x32_bf16 v[184:187], v[64:67], v[92:95], v[184:187]
    ds_read_b64_tr_b16 v[84:85], v23
    ds_read_b64_tr_b16 v[86:87], v23 offset:1024
    v_mfma_f32_16x16x32_bf16 v[200:203], v[64:67], v[96:99], v[200:203]
    v_mfma_f32_16x16x32_bf16 v[172:175], v[68:71], v[88:91], v[172:175]
    s_add_u32 s78, s78, 8192
    s_mov_b32 s55, 8192
    s_cmp_eq_u32 s78, 32768
    s_cselect_b32 s78, 0, s78
    s_cselect_b32 s55, 4294942720, s55
    v_add_u32 v20, s55, v20
    v_add_u32 v21, s55, v21
    v_mfma_f32_16x16x32_bf16 v[188:191], v[68:71], v[92:95], v[188:191]
    v_add_u32 v22, s55, v22
    v_add_u32 v23, s55, v23
    v_mfma_f32_16x16x32_bf16 v[204:207], v[68:71], v[96:99], v[204:207]
    v_add_u32 v10, s54, v10
    v_add_u32 v11, s54, v11
    s_sub_u32 s54, 0, s54
    s_waitcnt lgkmcnt(0)
    s_waitcnt vmcnt(0)
    s_barrier
    v_mfma_f32_16x16x32_bf16 v[160:163], v[72:75], v[100:103], v[160:163]
    ds_read_b128 v[88:91], v10 offset:0
    s_add_u32 s76, s66, s72
    s_add_u32 s77, s68, s73
    s_mov_b32 m0, s77
    s_add_u32 s66, s66, 128
    buffer_load_dwordx4 v32, s[8:11], s76 offen  lds
    s_cmp_eq_u32 s66, 1152
    s_cselect_b32 s66, 0, s66
    v_mfma_f32_16x16x32_bf16 v[176:179], v[72:75], v[104:107], v[176:179]
    ds_read_b128 v[92:95], v10 offset:2048
    v_mfma_f32_16x16x32_bf16 v[192:195], v[72:75], v[108:111], v[192:195]
    ds_read_b128 v[96:99], v10 offset:4096
    s_mov_b32 m0, s77
    s_nop 0
    buffer_load_dwordx4 v33, s[8:11], s76 offen offset:1024  lds
    v_mfma_f32_16x16x32_bf16 v[164:167], v[76:79], v[100:103], v[164:167]
    ds_read_b64_tr_b16 v[56:57], v20
    ds_read_b64_tr_b16 v[58:59], v20 offset:1024
    s_mov_b32 m0, s77
    s_nop 0
    buffer_load_dwordx4 v34, s[8:11], s76 offen offset:2048  lds
    v_mfma_f32_16x16x32_bf16 v[180:183], v[76:79], v[104:107], v[180:183]
    ds_read_b64_tr_b16 v[60:61], v21
    ds_read_b64_tr_b16 v[62:63], v21 offset:1024
    s_mov_b32 m0, s77
    s_nop 0
    buffer_load_dwordx4 v35, s[8:11], s76 offen offset:3072  lds
    v_mfma_f32_16x16x32_bf16 v[196:199], v[76:79], v[108:111], v[196:199]
    ds_read_b64_tr_b16 v[64:65], v22
    ds_read_b64_tr_b16 v[66:67], v22 offset:1024
    v_mfma_f32_16x16x32_bf16 v[168:171], v[80:83], v[100:103], v[168:171]
    s_add_u32 s77, s77, 4096
    s_mov_b32 m0, s77
    s_sub_u32 s68, 20480, s68
    buffer_load_dwordx4 v36, s[8:11], s76 offen  lds
    v_mfma_f32_16x16x32_bf16 v[184:187], v[80:83], v[104:107], v[184:187]
    ds_read_b64_tr_b16 v[68:69], v23
    ds_read_b64_tr_b16 v[70:71], v23 offset:1024
    s_add_u32 s60, s43, s57
    s_add_u32 s61, s44, s57
    s_mov_b32 m0, s60
    v_xor_b32 v6, 64, v8
    buffer_load_dwordx4 v8, s[16:19], s61 offen nt lds
    v_mfma_f32_16x16x32_bf16 v[200:203], v[80:83], v[108:111], v[200:203]
    s_mov_b32 m0, s60
    s_nop 0
    buffer_load_dwordx4 v6, s[16:19], s61 offen offset:1024 nt lds
    v_mfma_f32_16x16x32_bf16 v[172:175], v[84:87], v[100:103], v[172:175]
    s_add_u32 s78, s78, 8192
    s_mov_b32 s55, 8192
    s_cmp_eq_u32 s78, 32768
    s_cselect_b32 s78, 0, s78
    s_cselect_b32 s55, 4294942720, s55
    v_mfma_f32_16x16x32_bf16 v[188:191], v[84:87], v[104:107], v[188:191]
    v_add_u32 v20, s55, v20
    v_add_u32 v21, s55, v21
    s_add_u32 s60, s60, 8192
    s_mov_b32 m0, s60
    v_xor_b32 v7, 128, v9
    buffer_load_dwordx4 v9, s[20:23], s61 offen nt lds
    v_mfma_f32_16x16x32_bf16 v[204:207], v[84:87], v[108:111], v[204:207]
    v_add_u32 v22, s55, v22
    v_add_u32 v23, s55, v23
    s_mov_b32 m0, s60
    s_add_u32 s44, s44, 8192
    buffer_load_dwordx4 v7, s[20:23], s61 offen offset:1024 nt lds
    s_cmp_eq_u32 s44, 131072
    s_cselect_b32 s44, 524288, s44
    s_add_u32 s43, s43, 16384
    s_cmp_eq_u32 s43, 81920
    s_cselect_b32 s43, 0, s43
    s_waitcnt lgkmcnt(0)
    s_add_u32 s41, s41, 1
    s_barrier
    v_mfma_f32_16x16x32_bf16 v[160:163], v[56:59], v[88:91], v[160:163]
    ds_read_b128 v[100:103], v11 offset:0
    v_mfma_f32_16x16x32_bf16 v[176:179], v[56:59], v[92:95], v[176:179]
    ds_read_b128 v[104:107], v11 offset:2048
    s_add_u32 s60, s43, s57
    s_add_u32 s61, s44, s57
    s_mov_b32 m0, s60
    v_xor_b32 v6, 64, v8
    buffer_load_dwordx4 v8, s[16:19], s61 offen nt lds
    v_mfma_f32_16x16x32_bf16 v[192:195], v[56:59], v[96:99], v[192:195]
    ds_read_b128 v[108:111], v11 offset:4096
    v_mfma_f32_16x16x32_bf16 v[164:167], v[60:63], v[88:91], v[164:167]
    ds_read_b64_tr_b16 v[72:73], v20
    ds_read_b64_tr_b16 v[74:75], v20 offset:1024
    v_mfma_f32_16x16x32_bf16 v[180:183], v[60:63], v[92:95], v[180:183]
    ds_read_b64_tr_b16 v[76:77], v21
    ds_read_b64_tr_b16 v[78:79], v21 offset:1024
    s_mov_b32 m0, s60
    s_nop 0
    buffer_load_dwordx4 v6, s[16:19], s61 offen offset:1024 nt lds
    v_mfma_f32_16x16x32_bf16 v[196:199], v[60:63], v[96:99], v[196:199]
    ds_read_b64_tr_b16 v[80:81], v22
    ds_read_b64_tr_b16 v[82:83], v22 offset:1024
    v_mfma_f32_16x16x32_bf16 v[168:171], v[64:67], v[88:91], v[168:171]
    v_mfma_f32_16x16x32_bf16 v[184:187], v[64:67], v[92:95], v[184:187]
    ds_read_b64_tr_b16 v[84:85], v23
    ds_read_b64_tr_b16 v[86:87], v23 offset:1024
    s_add_u32 s60, s60, 8192
    s_mov_b32 m0, s60
    v_xor_b32 v7, 128, v9
    buffer_load_dwordx4 v9, s[20:23], s61 offen nt lds
    v_mfma_f32_16x16x32_bf16 v[200:203], v[64:67], v[96:99], v[200:203]
    v_mfma_f32_16x16x32_bf16 v[172:175], v[68:71], v[88:91], v[172:175]
    s_add_u32 s78, s78, 8192
    s_mov_b32 s55, 8192
    s_cmp_eq_u32 s78, 32768
    s_cselect_b32 s78, 0, s78
    s_cselect_b32 s55, 4294942720, s55
    v_add_u32 v20, s55, v20
    v_add_u32 v21, s55, v21
    v_mfma_f32_16x16x32_bf16 v[188:191], v[68:71], v[92:95], v[188:191]
    v_add_u32 v22, s55, v22
    v_add_u32 v23, s55, v23
    s_mov_b32 m0, s60
    s_add_u32 s44, s44, 8192
    buffer_load_dwordx4 v7, s[20:23], s61 offen offset:1024 nt lds
    s_cmp_eq_u32 s44, 131072
    s_cselect_b32 s44, 524288, s44
    s_add_u32 s43, s43, 16384
    s_cmp_eq_u32 s43, 81920
    s_cselect_b32 s43, 0, s43
    v_mfma_f32_16x16x32_bf16 v[204:207], v[68:71], v[96:99], v[204:207]
    v_add_u32 v10, s54, v10
    v_add_u32 v11, s54, v11
    s_sub_u32 s54, 0, s54
    s_waitcnt lgkmcnt(0)
    s_waitcnt vmcnt(8)
    s_barrier
    v_mfma_f32_16x16x32_bf16 v[160:163], v[72:75], v[100:103], v[160:163]
    s_add_u32 s76, s66, s72
    s_add_u32 s77, s68, s73
    s_mov_b32 m0, s77
    s_add_u32 s66, s66, 128
    buffer_load_dwordx4 v32, s[8:11], s76 offen  lds
    s_cmp_eq_u32 s66, 1152
    s_cselect_b32 s66, 0, s66
    v_mfma_f32_16x16x32_bf16 v[176:179], v[72:75], v[104:107], v[176:179]
    v_mfma_f32_16x16x32_bf16 v[192:195], v[72:75], v[108:111], v[192:195]
    s_mov_b32 m0, s77
    s_nop 0
    buffer_load_dwordx4 v33, s[8:11], s76 offen offset:1024  lds
    v_mfma_f32_16x16x32_bf16 v[164:167], v[76:79], v[100:103], v[164:167]
    s_mov_b32 m0, s77
    s_nop 0
    buffer_load_dwordx4 v34, s[8:11], s76 offen offset:2048  lds
    v_mfma_f32_16x16x32_bf16 v[180:183], v[76:79], v[104:107], v[180:183]
    s_mov_b32 m0, s77
    s_nop 0
    buffer_load_dwordx4 v35, s[8:11], s76 offen offset:3072  lds
    v_mfma_f32_16x16x32_bf16 v[196:199], v[76:79], v[108:111], v[196:199]
    v_mfma_f32_16x16x32_bf16 v[168:171], v[80:83], v[100:103], v[168:171]
    s_add_u32 s77, s77, 4096
    s_mov_b32 m0, s77
    s_sub_u32 s68, 20480, s68
    buffer_load_dwordx4 v36, s[8:11], s76 offen  lds
    v_mfma_f32_16x16x32_bf16 v[184:187], v[80:83], v[104:107], v[184:187]
    s_add_u32 s60, s43, s57
    s_add_u32 s61, s44, s57
    s_mov_b32 m0, s60
    v_xor_b32 v6, 64, v8
    buffer_load_dwordx4 v8, s[16:19], s61 offen nt lds
    v_mfma_f32_16x16x32_bf16 v[200:203], v[80:83], v[108:111], v[200:203]
    s_mov_b32 m0, s60
    s_nop 0
    buffer_load_dwordx4 v6, s[16:19], s61 offen offset:1024 nt lds
    v_mfma_f32_16x16x32_bf16 v[172:175], v[84:87], v[100:103], v[172:175]
    v_mfma_f32_16x16x32_bf16 v[188:191], v[84:87], v[104:107], v[188:191]
    s_add_u32 s60, s60, 8192
    s_mov_b32 m0, s60
    v_xor_b32 v7, 128, v9
    buffer_load_dwordx4 v9, s[20:23], s61 offen nt lds
    v_mfma_f32_16x16x32_bf16 v[204:207], v[84:87], v[108:111], v[204:207]
    s_mov_b32 m0, s60
    s_add_u32 s44, s44, 8192
    buffer_load_dwordx4 v7, s[20:23], s61 offen offset:1024 nt lds
    s_cmp_eq_u32 s44, 131072
    s_cselect_b32 s44, 524288, s44
    s_add_u32 s43, s43, 16384
    s_cmp_eq_u32 s43, 81920
    s_cselect_b32 s43, 0, s43
    s_waitcnt lgkmcnt(0)
    s_add_u32 s41, s41, 1
    s_mov_b32 s80, 0x3e0293ee
    s_mov_b32 s81, 0x3e0293ee
    s_nop 3
    v_pk_mul_f32 v[160:161], v[160:161], s[80:81]
    v_pk_mul_f32 v[162:163], v[162:163], s[80:81]
    v_pk_mul_f32 v[164:165], v[164:165], s[80:81]
    v_pk_mul_f32 v[166:167], v[166:167], s[80:81]
    v_cvt_pk_bf16_f32 v2, v160, v161
    v_cvt_pk_bf16_f32 v3, v162, v163
    v_cvt_pk_bf16_f32 v4, v164, v165
    v_cvt_pk_bf16_f32 v5, v166, v167
    v_cndmask_b32 v112, v2, v4, s[52:53]
    v_cndmask_b32 v113, v3, v5, s[52:53]
    v_cndmask_b32 v114, v4, v2, s[52:53]
    v_cndmask_b32 v115, v5, v3, s[52:53]
    v_pk_mul_f32 v[168:169], v[168:169], s[80:81]
    v_pk_mul_f32 v[170:171], v[170:171], s[80:81]
    v_pk_mul_f32 v[172:173], v[172:173], s[80:81]
    v_pk_mul_f32 v[174:175], v[174:175], s[80:81]
    v_cvt_pk_bf16_f32 v2, v168, v169
    v_cvt_pk_bf16_f32 v3, v170, v171
    v_cvt_pk_bf16_f32 v4, v172, v173
    v_cvt_pk_bf16_f32 v5, v174, v175
    v_cndmask_b32 v116, v2, v4, s[52:53]
    v_cndmask_b32 v117, v3, v5, s[52:53]
    v_cndmask_b32 v118, v4, v2, s[52:53]
    v_cndmask_b32 v119, v5, v3, s[52:53]
    v_pk_mul_f32 v[176:177], v[176:177], s[80:81]
    v_pk_mul_f32 v[178:179], v[178:179], s[80:81]
    v_pk_mul_f32 v[180:181], v[180:181], s[80:81]
    v_pk_mul_f32 v[182:183], v[182:183], s[80:81]
    v_cvt_pk_bf16_f32 v2, v176, v177
    v_cvt_pk_bf16_f32 v3, v178, v179
    v_cvt_pk_bf16_f32 v4, v180, v181
    v_cvt_pk_bf16_f32 v5, v182, v183
    v_cndmask_b32 v128, v2, v4, s[52:53]
    v_cndmask_b32 v129, v3, v5, s[52:53]
    v_cndmask_b32 v130, v4, v2, s[52:53]
    v_cndmask_b32 v131, v5, v3, s[52:53]
    v_pk_mul_f32 v[184:185], v[184:185], s[80:81]
    v_pk_mul_f32 v[186:187], v[186:187], s[80:81]
    v_pk_mul_f32 v[188:189], v[188:189], s[80:81]
    v_pk_mul_f32 v[190:191], v[190:191], s[80:81]
    v_cvt_pk_bf16_f32 v2, v184, v185
    v_cvt_pk_bf16_f32 v3, v186, v187
    v_cvt_pk_bf16_f32 v4, v188, v189
    v_cvt_pk_bf16_f32 v5, v190, v191
    v_cndmask_b32 v132, v2, v4, s[52:53]
    v_cndmask_b32 v133, v3, v5, s[52:53]
    v_cndmask_b32 v134, v4, v2, s[52:53]
    v_cndmask_b32 v135, v5, v3, s[52:53]
    v_pk_mul_f32 v[192:193], v[192:193], s[80:81]
    v_pk_mul_f32 v[194:195], v[194:195], s[80:81]
    v_pk_mul_f32 v[196:197], v[196:197], s[80:81]
    v_pk_mul_f32 v[198:199], v[198:199], s[80:81]
    v_cvt_pk_bf16_f32 v2, v192, v193
    v_cvt_pk_bf16_f32 v3, v194, v195
    v_cvt_pk_bf16_f32 v4, v196, v197
    v_cvt_pk_bf16_f32 v5, v198, v199
    v_cndmask_b32 v144, v2, v4, s[52:53]
    v_cndmask_b32 v145, v3, v5, s[52:53]
    v_cndmask_b32 v146, v4, v2, s[52:53]
    v_cndmask_b32 v147, v5, v3, s[52:53]
    v_pk_mul_f32 v[200:201], v[200:201], s[80:81]
    v_pk_mul_f32 v[202:203], v[202:203], s[80:81]
    v_pk_mul_f32 v[204:205], v[204:205], s[80:81]
    v_pk_mul_f32 v[206:207], v[206:207], s[80:81]
    v_cvt_pk_bf16_f32 v2, v200, v201
    v_cvt_pk_bf16_f32 v3, v202, v203
    v_cvt_pk_bf16_f32 v4, v204, v205
    v_cvt_pk_bf16_f32 v5, v206, v207
    v_cndmask_b32 v148, v2, v4, s[52:53]
    v_cndmask_b32 v149, v3, v5, s[52:53]
    v_cndmask_b32 v150, v4, v2, s[52:53]
    v_cndmask_b32 v151, v5, v3, s[52:53]
    v_lshrrev_b32 v2, 4, v1
    v_and_b32 v3, 15, v1
    v_xor_b32 v4, v2, v3
    v_lshlrev_b32 v4, 4, v4
    v_lshlrev_b32 v3, 8, v3
    v_add_u32 v6, v3, v4
    v_bfe_u32 v3, v1, 2, 2
    v_and_b32 v4, 3, v1
    v_lshlrev_b32 v0, 2, v2
    v_add_u32 v0, v0, v3
    v_and_b32 v2, 7, v0
    v_lshlrev_b32 v2, 1, v2
    v_lshrrev_b32 v3, 1, v4
    v_xor_b32 v2, v2, v3
    v_lshlrev_b32 v2, 4, v2
    v_lshlrev_b32 v0, 8, v0
    v_add_u32 v0, v0, v2
    v_and_b32 v2, 1, v4
    v_lshlrev_b32 v2, 3, v2
    v_add_u32 v0, v0, v2
    v_add_u32 v7, 8192, v0
    s_mov_b32 s51, 0x46800000
    s_mov_b32 s42, 0
    s_mov_b32 s56, 16384
    s_barrier
    v_mbcnt_lo_u32_b32 v2, -1, 0
    v_mbcnt_hi_u32_b32 v2, -1, v2
    v_lshlrev_b32 v2, 4, v2
    s_lshl_b32 s45, s39, 11
    s_add_u32 s45, s45, 61440
    v_add_u32 v2, s45, v2
    ds_read_b128 v[120:123], v2 offset:0
    ds_read_b128 v[124:127], v2 offset:1024
    ds_read_b128 v[136:139], v2 offset:2048
    ds_read_b128 v[140:143], v2 offset:3072
    ds_read_b128 v[152:155], v2 offset:4096
    ds_read_b128 v[156:159], v2 offset:5120
    s_waitcnt vmcnt(0)
    v_mov_b64 v[12:13], 0
    v_mov_b64 v[14:15], 0
    v_mov_b32 v8, 0
    v_mov_b64 v[16:17], 0
    v_mov_b64 v[18:19], 0
    v_mov_b32 v9, 0
    v_mov_b64 v[20:21], 0
    v_mov_b64 v[22:23], 0
    v_mov_b32 v10, 0
    v_mov_b64 v[24:25], 0
    v_mov_b64 v[26:27], 0
    v_mov_b64 v[28:29], 0
    v_mov_b64 v[30:31], 0
    v_mov_b64 v[32:33], 0
    v_mov_b64 v[34:35], 0
    v_mov_b64 v[36:37], 0
    v_mov_b64 v[38:39], 0
    v_mov_b64 v[40:41], 0
    v_mov_b64 v[42:43], 0
    v_mov_b64 v[44:45], 0
    v_mov_b64 v[46:47], 0
    v_mov_b64 v[48:49], 0
    v_mov_b64 v[50:51], 0
    v_mov_b64 v[52:53], 0
    v_mov_b64 v[54:55], 0
    v_mov_b64 v[104:105], 0
    v_mov_b64 v[106:107], 0
    v_mov_b32 v11, 0
    s_waitcnt lgkmcnt(0)
    s_cmp_lg_u32 s33, 0
    s_cbranch_scc1 L_frs2_7
    s_mov_b64 s[70:71], exec
    s_mov_b64 exec, 1
    s_lshl_b32 s45, s59, 2
    v_mov_b32 v2, s45
    v_mov_b32 v3, 1
    global_atomic_add v2, v3, s[4:5] sc1
    s_lshl_b32 s45, s48, 2
    v_mov_b32 v4, s45
    v_mov_b32 v5, 0x10000
    global_atomic_add v4, v5, s[4:5] sc1
    s_mov_b64 exec, s[70:71]
L_frs2_7:
    s_barrier
    v_add_u32 v4, s42, v6
    ds_read_b128 v[56:59], v4
    ds_read_b128 v[72:75], v4 offset:4096
    v_xor_b32 v1, 64, v4
    ds_read_b128 v[60:63], v1
    ds_read_b128 v[76:79], v1 offset:4096
    v_xor_b32 v0, 128, v4
    ds_read_b128 v[64:67], v0
    ds_read_b128 v[80:83], v0 offset:4096
    v_xor_b32 v1, 192, v4
    ds_read_b128 v[68:71], v1
    ds_read_b128 v[84:87], v1 offset:4096
    s_waitcnt lgkmcnt(0)
    v_mfma_f32_16x16x32_bf16 v[88:91], v[56:59], v[112:115], v[12:15]
    v_mfma_f32_16x16x32_bf16 v[92:95], v[72:75], v[112:115], v[12:15]
    v_mfma_f32_16x16x32_bf16 v[88:91], v[60:63], v[116:119], v[88:91]
    v_mfma_f32_16x16x32_bf16 v[92:95], v[76:79], v[116:119], v[92:95]
    v_mfma_f32_16x16x32_bf16 v[88:91], v[64:67], v[120:123], v[88:91]
    v_mfma_f32_16x16x32_bf16 v[92:95], v[80:83], v[120:123], v[92:95]
    v_mfma_f32_16x16x32_bf16 v[88:91], v[68:71], v[124:127], v[88:91]
    v_mfma_f32_16x16x32_bf16 v[92:95], v[84:87], v[124:127], v[92:95]
    s_barrier
    s_mov_b32 s50, 0
    s_setprio 1
    s_mov_b32 s62, 0
L_rnd_20:
    v_mfma_f32_16x16x32_bf16 v[224:227], v[24:27], v[104:107], 0
    v_add_u32 v4, s42, v7
    ds_read_b64_tr_b16 v[24:25], v4
    ds_read_b64_tr_b16 v[26:27], v4 offset:4096
    v_mfma_f32_16x16x32_bf16 v[228:231], v[28:31], v[104:107], 0
    v_add_f32 v10, v10, v11
    v_xor_b32 v1, 32, v4
    ds_read_b64_tr_b16 v[28:29], v1
    ds_read_b64_tr_b16 v[30:31], v1 offset:4096
    v_mfma_f32_16x16x32_bf16 v[232:235], v[32:35], v[104:107], 0
    v_xor_b32 v0, 64, v4
    ds_read_b64_tr_b16 v[32:33], v0
    ds_read_b64_tr_b16 v[34:35], v0 offset:4096
    v_mfma_f32_16x16x32_bf16 v[236:239], v[36:39], v[104:107], 0
    v_xor_b32 v1, 96, v4
    ds_read_b64_tr_b16 v[36:37], v1
    ds_read_b64_tr_b16 v[38:39], v1 offset:4096
    v_mfma_f32_16x16x32_bf16 v[240:243], v[40:43], v[104:107], 0
    v_xor_b32 v0, 128, v4
    ds_read_b64_tr_b16 v[40:41], v0
    ds_read_b64_tr_b16 v[42:43], v0 offset:4096
    v_mfma_f32_16x16x32_bf16 v[244:247], v[44:47], v[104:107], 0
    v_xor_b32 v1, 160, v4
    ds_read_b64_tr_b16 v[44:45], v1
    ds_read_b64_tr_b16 v[46:47], v1 offset:4096
    v_mfma_f32_16x16x32_bf16 v[248:251], v[48:51], v[104:107], 0
    v_xor_b32 v0, 192, v4
    ds_read_b64_tr_b16 v[48:49], v0
    ds_read_b64_tr_b16 v[50:51], v0 offset:4096
    v_mfma_f32_16x16x32_bf16 v[252:255], v[52:55], v[104:107], 0
    v_xor_b32 v1, 224, v4
    ds_read_b64_tr_b16 v[52:53], v1
    ds_read_b64_tr_b16 v[54:55], v1 offset:4096
    v_max3_f32 v2, v88, v89, v90
    v_max3_f32 v2, v2, v91, v92
    v_max3_f32 v2, v2, v93, v94
    v_max_f32 v2, v2, v95
    v_mov_b32 v3, v2
    s_nop 1
    v_permlane16_swap_b32 v2, v3
    v_max_f32 v2, v2, v3
    v_mov_b32 v3, v2
    s_nop 1
    v_permlane32_swap_b32 v2, v3
    v_max_f32 v2, v2, v3
    v_sub_f32 v12, 0, v2
    v_sub_f32 v13, 0, v2
    v_sub_f32 v14, 0, v2
    v_sub_f32 v15, 0, v2
    v_sub_f32 v88, v88, v2
    v_sub_f32 v89, v89, v2
    v_sub_f32 v90, v90, v2
    v_sub_f32 v91, v91, v2
    v_sub_f32 v92, v92, v2
    v_sub_f32 v93, v93, v2
    v_sub_f32 v94, v94, v2
    v_sub_f32 v95, v95, v2
    v_mfma_f32_16x16x32_bf16 v[96:99], v[56:59], v[128:131], v[16:19]
    v_exp_f32 v88, v88
    v_exp_f32 v89, v89
    v_exp_f32 v90, v90
    v_mfma_f32_16x16x32_bf16 v[100:103], v[72:75], v[128:131], v[16:19]
    v_exp_f32 v91, v91
    v_exp_f32 v92, v92
    v_mfma_f32_16x16x32_bf16 v[96:99], v[60:63], v[132:135], v[96:99]
    v_exp_f32 v93, v93
    v_exp_f32 v94, v94
    v_exp_f32 v95, v95
    v_mfma_f32_16x16x32_bf16 v[100:103], v[76:79], v[132:135], v[100:103]
    v_add_f32 v0, v88, v89
    v_add_f32 v1, v90, v91
    v_mfma_f32_16x16x32_bf16 v[96:99], v[64:67], v[136:139], v[96:99]
    v_add_f32 v2, v92, v93
    v_add_f32 v3, v94, v95
    v_add_f32 v0, v0, v1
    v_mfma_f32_16x16x32_bf16 v[100:103], v[80:83], v[136:139], v[100:103]
    v_add_f32 v2, v2, v3
    v_cvt_pk_bf16_f32 v88, v88, v89
    v_mfma_f32_16x16x32_bf16 v[96:99], v[68:71], v[140:143], v[96:99]
    v_add_f32 v11, v0, v2
    v_cvt_pk_bf16_f32 v89, v90, v91
    v_cmp_lt_f32 vcc, s51, v11
    v_mfma_f32_16x16x32_bf16 v[100:103], v[84:87], v[140:143], v[100:103]
    v_cvt_pk_bf16_f32 v90, v92, v93
    v_cvt_pk_bf16_f32 v91, v94, v95
    s_cbranch_vccnz L_rare_14
L_rret_15:
    s_waitcnt lgkmcnt(14)
    v_mfma_f32_16x16x32_bf16 v[160:163], v[24:27], v[88:91], 0
    s_waitcnt lgkmcnt(12)
    v_mfma_f32_16x16x32_bf16 v[164:167], v[28:31], v[88:91], 0
    v_add_f32 v8, v8, v11
    s_waitcnt lgkmcnt(10)
    v_mfma_f32_16x16x32_bf16 v[168:171], v[32:35], v[88:91], 0
    s_waitcnt lgkmcnt(8)
    v_mfma_f32_16x16x32_bf16 v[172:175], v[36:39], v[88:91], 0
    s_waitcnt lgkmcnt(6)
    v_mfma_f32_16x16x32_bf16 v[176:179], v[40:43], v[88:91], 0
    s_waitcnt lgkmcnt(4)
    v_mfma_f32_16x16x32_bf16 v[180:183], v[44:47], v[88:91], 0
    s_waitcnt lgkmcnt(2)
    v_mfma_f32_16x16x32_bf16 v[184:187], v[48:51], v[88:91], 0
    s_waitcnt lgkmcnt(0)
    v_mfma_f32_16x16x32_bf16 v[188:191], v[52:55], v[88:91], 0
    v_max3_f32 v2, v96, v97, v98
    v_max3_f32 v2, v2, v99, v100
    v_max3_f32 v2, v2, v101, v102
    v_max_f32 v2, v2, v103
    v_mov_b32 v3, v2
    s_nop 1
    v_permlane16_swap_b32 v2, v3
    v_max_f32 v2, v2, v3
    v_mov_b32 v3, v2
    s_nop 1
    v_permlane32_swap_b32 v2, v3
    v_max_f32 v2, v2, v3
    v_sub_f32 v16, 0, v2
    v_sub_f32 v17, 0, v2
    v_sub_f32 v18, 0, v2
    v_sub_f32 v19, 0, v2
    v_sub_f32 v96, v96, v2
    v_sub_f32 v97, v97, v2
    v_sub_f32 v98, v98, v2
    v_sub_f32 v99, v99, v2
    v_sub_f32 v100, v100, v2
    v_sub_f32 v101, v101, v2
    v_sub_f32 v102, v102, v2
    v_sub_f32 v103, v103, v2
    v_mfma_f32_16x16x32_bf16 v[104:107], v[56:59], v[144:147], v[20:23]
    v_exp_f32 v96, v96
    v_exp_f32 v97, v97
    v_exp_f32 v98, v98
    v_mfma_f32_16x16x32_bf16 v[108:111], v[72:75], v[144:147], v[20:23]
    v_exp_f32 v99, v99
    v_exp_f32 v100, v100
    v_mfma_f32_16x16x32_bf16 v[104:107], v[60:63], v[148:151], v[104:107]
    v_exp_f32 v101, v101
    v_exp_f32 v102, v102
    v_exp_f32 v103, v103
    v_mfma_f32_16x16x32_bf16 v[108:111], v[76:79], v[148:151], v[108:111]
    v_add_f32 v0, v96, v97
    v_add_f32 v1, v98, v99
    v_mfma_f32_16x16x32_bf16 v[104:107], v[64:67], v[152:155], v[104:107]
    v_add_f32 v2, v100, v101
    v_add_f32 v3, v102, v103
    v_add_f32 v0, v0, v1
    v_mfma_f32_16x16x32_bf16 v[108:111], v[80:83], v[152:155], v[108:111]
    v_add_f32 v2, v2, v3
    v_cvt_pk_bf16_f32 v96, v96, v97
    v_mfma_f32_16x16x32_bf16 v[104:107], v[68:71], v[156:159], v[104:107]
    v_add_f32 v11, v0, v2
    v_cvt_pk_bf16_f32 v97, v98, v99
    v_cmp_lt_f32 vcc, s51, v11
    v_mfma_f32_16x16x32_bf16 v[108:111], v[84:87], v[156:159], v[108:111]
    v_cvt_pk_bf16_f32 v98, v100, v101
    v_cvt_pk_bf16_f32 v99, v102, v103
    s_cbranch_vccnz L_rare_16
L_rret_17:
    s_nop 0
    v_mfma_f32_16x16x32_bf16 v[192:195], v[24:27], v[96:99], 0
    v_add_u32 v4, s56, v6
    ds_read_b128 v[56:59], v4
    ds_read_b128 v[72:75], v4 offset:4096
    v_mfma_f32_16x16x32_bf16 v[196:199], v[28:31], v[96:99], 0
    v_add_f32 v9, v9, v11
    v_xor_b32 v1, 64, v4
    ds_read_b128 v[60:63], v1
    ds_read_b128 v[76:79], v1 offset:4096
    v_mfma_f32_16x16x32_bf16 v[200:203], v[32:35], v[96:99], 0
    v_xor_b32 v0, 128, v4
    ds_read_b128 v[64:67], v0
    ds_read_b128 v[80:83], v0 offset:4096
    v_mfma_f32_16x16x32_bf16 v[204:207], v[36:39], v[96:99], 0
    v_xor_b32 v1, 192, v4
    ds_read_b128 v[68:71], v1
    ds_read_b128 v[84:87], v1 offset:4096
    v_mfma_f32_16x16x32_bf16 v[208:211], v[40:43], v[96:99], 0
    v_mfma_f32_16x16x32_bf16 v[212:215], v[44:47], v[96:99], 0
    v_mfma_f32_16x16x32_bf16 v[216:219], v[48:51], v[96:99], 0
    v_mfma_f32_16x16x32_bf16 v[220:223], v[52:55], v[96:99], 0
    v_max3_f32 v2, v104, v105, v106
    v_max3_f32 v2, v2, v107, v108
    v_max3_f32 v2, v2, v109, v110
    v_max_f32 v2, v2, v111
    v_mov_b32 v3, v2
    s_nop 1
    v_permlane16_swap_b32 v2, v3
    v_max_f32 v2, v2, v3
    v_mov_b32 v3, v2
    s_nop 1
    v_permlane32_swap_b32 v2, v3
    v_max_f32 v2, v2, v3
    v_sub_f32 v20, 0, v2
    v_sub_f32 v21, 0, v2
    v_sub_f32 v22, 0, v2
    v_sub_f32 v23, 0, v2
    v_sub_f32 v104, v104, v2
    v_sub_f32 v105, v105, v2
    v_sub_f32 v106, v106, v2
    v_sub_f32 v107, v107, v2
    v_sub_f32 v108, v108, v2
    v_sub_f32 v109, v109, v2
    v_sub_f32 v110, v110, v2
    v_sub_f32 v111, v111, v2
    s_waitcnt lgkmcnt(7)
    v_mfma_f32_16x16x32_bf16 v[88:91], v[56:59], v[112:115], v[12:15]
    v_exp_f32 v104, v104
    v_exp_f32 v105, v105
    v_exp_f32 v106, v106
    s_waitcnt lgkmcnt(6)
    v_mfma_f32_16x16x32_bf16 v[92:95], v[72:75], v[112:115], v[12:15]
    v_exp_f32 v107, v107
    v_exp_f32 v108, v108
    s_waitcnt lgkmcnt(5)
    v_mfma_f32_16x16x32_bf16 v[88:91], v[60:63], v[116:119], v[88:91]
    v_exp_f32 v109, v109
    v_exp_f32 v110, v110
    v_exp_f32 v111, v111
    s_waitcnt lgkmcnt(4)
    v_mfma_f32_16x16x32_bf16 v[92:95], v[76:79], v[116:119], v[92:95]
    v_add_f32 v0, v104, v105
    v_add_f32 v1, v106, v107
    s_waitcnt lgkmcnt(3)
    v_mfma_f32_16x16x32_bf16 v[88:91], v[64:67], v[120:123], v[88:91]
    v_add_f32 v2, v108, v109
    v_add_f32 v3, v110, v111
    v_add_f32 v0, v0, v1
    s_waitcnt lgkmcnt(2)
    v_mfma_f32_16x16x32_bf16 v[92:95], v[80:83], v[120:123], v[92:95]
    v_add_f32 v2, v2, v3
    v_cvt_pk_bf16_f32 v104, v104, v105
    s_waitcnt lgkmcnt(1)
    v_mfma_f32_16x16x32_bf16 v[88:91], v[68:71], v[124:127], v[88:91]
    v_add_f32 v11, v0, v2
    v_cvt_pk_bf16_f32 v105, v106, v107
    v_cmp_lt_f32 vcc, s51, v11
    s_waitcnt lgkmcnt(0)
    v_mfma_f32_16x16x32_bf16 v[92:95], v[84:87], v[124:127], v[92:95]
    v_cvt_pk_bf16_f32 v106, v108, v109
    v_cvt_pk_bf16_f32 v107, v110, v111
    s_cbranch_vccnz L_rare_18
L_rret_19:
    s_mov_b32 s42, s56
    s_add_u32 s56, s56, 16384
    s_cmp_eq_u32 s56, 81920
    s_cselect_b32 s56, 0, s56
    s_add_u32 s62, s62, 1
    s_waitcnt lgkmcnt(0)
    s_barrier
L_att_21:
    v_mfma_f32_16x16x32_bf16 v[224:227], v[24:27], v[104:107], v[224:227]
    v_add_u32 v4, s42, v7
    ds_read_b64_tr_b16 v[24:25], v4
    ds_read_b64_tr_b16 v[26:27], v4 offset:4096
    v_mfma_f32_16x16x32_bf16 v[228:231], v[28:31], v[104:107], v[228:231]
    v_add_f32 v10, v10, v11
    v_xor_b32 v1, 32, v4
    ds_read_b64_tr_b16 v[28:29], v1
    ds_read_b64_tr_b16 v[30:31], v1 offset:4096
    v_mfma_f32_16x16x32_bf16 v[232:235], v[32:35], v[104:107], v[232:235]
    v_xor_b32 v0, 64, v4
    ds_read_b64_tr_b16 v[32:33], v0
    ds_read_b64_tr_b16 v[34:35], v0 offset:4096
    v_mfma_f32_16x16x32_bf16 v[236:239], v[36:39], v[104:107], v[236:239]
    v_xor_b32 v1, 96, v4
    ds_read_b64_tr_b16 v[36:37], v1
    ds_read_b64_tr_b16 v[38:39], v1 offset:4096
    v_mfma_f32_16x16x32_bf16 v[240:243], v[40:43], v[104:107], v[240:243]
    v_xor_b32 v0, 128, v4
    ds_read_b64_tr_b16 v[40:41], v0
    ds_read_b64_tr_b16 v[42:43], v0 offset:4096
    v_mfma_f32_16x16x32_bf16 v[244:247], v[44:47], v[104:107], v[244:247]
    v_xor_b32 v1, 160, v4
    ds_read_b64_tr_b16 v[44:45], v1
    ds_read_b64_tr_b16 v[46:47], v1 offset:4096
    v_mfma_f32_16x16x32_bf16 v[248:251], v[48:51], v[104:107], v[248:251]
    v_xor_b32 v0, 192, v4
    ds_read_b64_tr_b16 v[48:49], v0
    ds_read_b64_tr_b16 v[50:51], v0 offset:4096
    v_mfma_f32_16x16x32_bf16 v[252:255], v[52:55], v[104:107], v[252:255]
    v_xor_b32 v1, 224, v4
    ds_read_b64_tr_b16 v[52:53], v1
    ds_read_b64_tr_b16 v[54:55], v1 offset:4096
    v_mfma_f32_16x16x32_bf16 v[96:99], v[56:59], v[128:131], v[16:19]
    v_exp_f32 v88, v88
    v_exp_f32 v89, v89
    v_exp_f32 v90, v90
    v_mfma_f32_16x16x32_bf16 v[100:103], v[72:75], v[128:131], v[16:19]
    v_exp_f32 v91, v91
    v_exp_f32 v92, v92
    v_mfma_f32_16x16x32_bf16 v[96:99], v[60:63], v[132:135], v[96:99]
    v_exp_f32 v93, v93
    v_exp_f32 v94, v94
    v_exp_f32 v95, v95
    v_mfma_f32_16x16x32_bf16 v[100:103], v[76:79], v[132:135], v[100:103]
    v_add_f32 v0, v88, v89
    v_add_f32 v1, v90, v91
    v_mfma_f32_16x16x32_bf16 v[96:99], v[64:67], v[136:139], v[96:99]
    v_add_f32 v2, v92, v93
    v_add_f32 v3, v94, v95
    v_add_f32 v0, v0, v1
    v_mfma_f32_16x16x32_bf16 v[100:103], v[80:83], v[136:139], v[100:103]
    v_add_f32 v2, v2, v3
    v_cvt_pk_bf16_f32 v88, v88, v89
    v_mfma_f32_16x16x32_bf16 v[96:99], v[68:71], v[140:143], v[96:99]
    v_add_f32 v11, v0, v2
    v_cvt_pk_bf16_f32 v89, v90, v91
    v_cmp_lt_f32 vcc, s51, v11
    v_mfma_f32_16x16x32_bf16 v[100:103], v[84:87], v[140:143], v[100:103]
    v_cvt_pk_bf16_f32 v90, v92, v93
    v_cvt_pk_bf16_f32 v91, v94, v95
    s_cbranch_vccnz L_rare_8
L_rret_9:
    s_waitcnt lgkmcnt(14)
    v_mfma_f32_16x16x32_bf16 v[160:163], v[24:27], v[88:91], v[160:163]
    s_waitcnt lgkmcnt(12)
    v_mfma_f32_16x16x32_bf16 v[164:167], v[28:31], v[88:91], v[164:167]
    v_add_f32 v8, v8, v11
    s_waitcnt lgkmcnt(10)
    v_mfma_f32_16x16x32_bf16 v[168:171], v[32:35], v[88:91], v[168:171]
    s_waitcnt lgkmcnt(8)
    v_mfma_f32_16x16x32_bf16 v[172:175], v[36:39], v[88:91], v[172:175]
    s_waitcnt lgkmcnt(6)
    v_mfma_f32_16x16x32_bf16 v[176:179], v[40:43], v[88:91], v[176:179]
    s_waitcnt lgkmcnt(4)
    v_mfma_f32_16x16x32_bf16 v[180:183], v[44:47], v[88:91], v[180:183]
    s_waitcnt lgkmcnt(2)
    v_mfma_f32_16x16x32_bf16 v[184:187], v[48:51], v[88:91], v[184:187]
    s_waitcnt lgkmcnt(0)
    v_mfma_f32_16x16x32_bf16 v[188:191], v[52:55], v[88:91], v[188:191]
    v_mfma_f32_16x16x32_bf16 v[104:107], v[56:59], v[144:147], v[20:23]
    v_exp_f32 v96, v96
    v_exp_f32 v97, v97
    v_exp_f32 v98, v98
    v_mfma_f32_16x16x32_bf16 v[108:111], v[72:75], v[144:147], v[20:23]
    v_exp_f32 v99, v99
    v_exp_f32 v100, v100
    v_mfma_f32_16x16x32_bf16 v[104:107], v[60:63], v[148:151], v[104:107]
    v_exp_f32 v101, v101
    v_exp_f32 v102, v102
    v_exp_f32 v103, v103
    v_mfma_f32_16x16x32_bf16 v[108:111], v[76:79], v[148:151], v[108:111]
    v_add_f32 v0, v96, v97
    v_add_f32 v1, v98, v99
    v_mfma_f32_16x16x32_bf16 v[104:107], v[64:67], v[152:155], v[104:107]
    v_add_f32 v2, v100, v101
    v_add_f32 v3, v102, v103
    v_add_f32 v0, v0, v1
    v_mfma_f32_16x16x32_bf16 v[108:111], v[80:83], v[152:155], v[108:111]
    v_add_f32 v2, v2, v3
    v_cvt_pk_bf16_f32 v96, v96, v97
    v_mfma_f32_16x16x32_bf16 v[104:107], v[68:71], v[156:159], v[104:107]
    v_add_f32 v11, v0, v2
    v_cvt_pk_bf16_f32 v97, v98, v99
    v_cmp_lt_f32 vcc, s51, v11
    v_mfma_f32_16x16x32_bf16 v[108:111], v[84:87], v[156:159], v[108:111]
    v_cvt_pk_bf16_f32 v98, v100, v101
    v_cvt_pk_bf16_f32 v99, v102, v103
    s_cbranch_vccnz L_rare_10
L_rret_11:
    s_nop 0
    v_mfma_f32_16x16x32_bf16 v[192:195], v[24:27], v[96:99], v[192:195]
    v_add_u32 v4, s56, v6
    ds_read_b128 v[56:59], v4
    ds_read_b128 v[72:75], v4 offset:4096
    v_mfma_f32_16x16x32_bf16 v[196:199], v[28:31], v[96:99], v[196:199]
    v_add_f32 v9, v9, v11
    v_xor_b32 v1, 64, v4
    ds_read_b128 v[60:63], v1
    ds_read_b128 v[76:79], v1 offset:4096
    v_mfma_f32_16x16x32_bf16 v[200:203], v[32:35], v[96:99], v[200:203]
    v_xor_b32 v0, 128, v4
    ds_read_b128 v[64:67], v0
    ds_read_b128 v[80:83], v0 offset:4096
    v_mfma_f32_16x16x32_bf16 v[204:207], v[36:39], v[96:99], v[204:207]
    v_xor_b32 v1, 192, v4
    ds_read_b128 v[68:71], v1
    ds_read_b128 v[84:87], v1 offset:4096
    v_mfma_f32_16x16x32_bf16 v[208:211], v[40:43], v[96:99], v[208:211]
    v_mfma_f32_16x16x32_bf16 v[212:215], v[44:47], v[96:99], v[212:215]
    v_mfma_f32_16x16x32_bf16 v[216:219], v[48:51], v[96:99], v[216:219]
    v_mfma_f32_16x16x32_bf16 v[220:223], v[52:55], v[96:99], v[220:223]
    s_waitcnt lgkmcnt(7)
    v_mfma_f32_16x16x32_bf16 v[88:91], v[56:59], v[112:115], v[12:15]
    v_exp_f32 v104, v104
    v_exp_f32 v105, v105
    v_exp_f32 v106, v106
    s_waitcnt lgkmcnt(6)
    v_mfma_f32_16x16x32_bf16 v[92:95], v[72:75], v[112:115], v[12:15]
    v_exp_f32 v107, v107
    v_exp_f32 v108, v108
    s_waitcnt lgkmcnt(5)
    v_mfma_f32_16x16x32_bf16 v[88:91], v[60:63], v[116:119], v[88:91]
    v_exp_f32 v109, v109
    v_exp_f32 v110, v110
    v_exp_f32 v111, v111
    s_waitcnt lgkmcnt(4)
    v_mfma_f32_16x16x32_bf16 v[92:95], v[76:79], v[116:119], v[92:95]
    v_add_f32 v0, v104, v105
    v_add_f32 v1, v106, v107
    s_waitcnt lgkmcnt(3)
    v_mfma_f32_16x16x32_bf16 v[88:91], v[64:67], v[120:123], v[88:91]
    v_add_f32 v2, v108, v109
    v_add_f32 v3, v110, v111
    v_add_f32 v0, v0, v1
    s_waitcnt lgkmcnt(2)
    v_mfma_f32_16x16x32_bf16 v[92:95], v[80:83], v[120:123], v[92:95]
    v_add_f32 v2, v2, v3
    v_cvt_pk_bf16_f32 v104, v104, v105
    s_waitcnt lgkmcnt(1)
    v_mfma_f32_16x16x32_bf16 v[88:91], v[68:71], v[124:127], v[88:91]
    v_add_f32 v11, v0, v2
    v_cvt_pk_bf16_f32 v105, v106, v107
    v_cmp_lt_f32 vcc, s51, v11
    s_waitcnt lgkmcnt(0)
    v_mfma_f32_16x16x32_bf16 v[92:95], v[84:87], v[124:127], v[92:95]
    v_cvt_pk_bf16_f32 v106, v108, v109
    v_cvt_pk_bf16_f32 v107, v110, v111
    s_cbranch_vccnz L_rare_12
L_rret_13:
    s_mov_b32 s42, s56
    s_add_u32 s56, s56, 16384
    s_cmp_eq_u32 s56, 81920
    s_cselect_b32 s56, 0, s56
    s_waitcnt lgkmcnt(0)
    s_cmp_eq_u32 s62, 17
    s_cbranch_scc1 L_sg_22
    s_barrier
L_sgr_23:
    s_add_u32 s62, s62, 1
    s_and_b32 s45, s62, 15
    s_cbranch_scc1 L_att_21
    s_nop 1
    v_add_f32 v10, v10, v11
    v_mfma_f32_16x16x32_bf16 v[224:227], v[24:27], v[104:107], v[224:227]
    v_mfma_f32_16x16x32_bf16 v[228:231], v[28:31], v[104:107], v[228:231]
    v_mfma_f32_16x16x32_bf16 v[232:235], v[32:35], v[104:107], v[232:235]
    v_mfma_f32_16x16x32_bf16 v[236:239], v[36:39], v[104:107], v[236:239]
    v_mfma_f32_16x16x32_bf16 v[240:243], v[40:43], v[104:107], v[240:243]
    v_mfma_f32_16x16x32_bf16 v[244:247], v[44:47], v[104:107], v[244:247]
    v_mfma_f32_16x16x32_bf16 v[248:251], v[48:51], v[104:107], v[248:251]
    v_mfma_f32_16x16x32_bf16 v[252:255], v[52:55], v[104:107], v[252:255]
    v_mbcnt_lo_u32_b32 v1, -1, 0
    v_mbcnt_hi_u32_b32 v1, -1, v1
    v_lshlrev_b32 v26, 4, v1
    s_cmp_eq_u32 s50, 1
    s_cbranch_scc1 L_atail_24
    s_nop 7
    v_mov_b32 v88, v8
    s_nop 1
    v_permlane16_swap_b32 v8, v88
    v_add_f32 v8, v8, v88
    v_mov_b32 v88, v8
    s_nop 1
    v_permlane32_swap_b32 v8, v88
    v_add_f32 v8, v8, v88
    v_mov_b32 v89, v9
    s_nop 1
    v_permlane16_swap_b32 v9, v89
    v_add_f32 v9, v9, v89
    v_mov_b32 v89, v9
    s_nop 1
    v_permlane32_swap_b32 v9, v89
    v_add_f32 v9, v9, v89
    v_mov_b32 v90, v10
    s_nop 1
    v_permlane16_swap_b32 v10, v90
    v_add_f32 v10, v10, v90
    v_mov_b32 v90, v10
    s_nop 1
    v_permlane32_swap_b32 v10, v90
    v_add_f32 v10, v10, v90
    v_rcp_f32 v92, v8
    v_rcp_f32 v94, v9
    v_rcp_f32 v96, v10
    v_pk_mul_f32 v[160:161], v[160:161], v[92:93] op_sel_hi:[1,0]
    v_pk_mul_f32 v[162:163], v[162:163], v[92:93] op_sel_hi:[1,0]
    v_pk_mul_f32 v[164:165], v[164:165], v[92:93] op_sel_hi:[1,0]
    v_pk_mul_f32 v[166:167], v[166:167], v[92:93] op_sel_hi:[1,0]
    v_cvt_pk_bf16_f32 v112, v160, v161
    v_cvt_pk_bf16_f32 v113, v162, v163
    v_cvt_pk_bf16_f32 v114, v164, v165
    v_cvt_pk_bf16_f32 v115, v166, v167
    v_pk_mul_f32 v[168:169], v[168:169], v[92:93] op_sel_hi:[1,0]
    v_pk_mul_f32 v[170:171], v[170:171], v[92:93] op_sel_hi:[1,0]
    v_pk_mul_f32 v[172:173], v[172:173], v[92:93] op_sel_hi:[1,0]
    v_pk_mul_f32 v[174:175], v[174:175], v[92:93] op_sel_hi:[1,0]
    v_cvt_pk_bf16_f32 v116, v168, v169
    v_cvt_pk_bf16_f32 v117, v170, v171
    v_cvt_pk_bf16_f32 v118, v172, v173
    v_cvt_pk_bf16_f32 v119, v174, v175
    v_pk_mul_f32 v[176:177], v[176:177], v[92:93] op_sel_hi:[1,0]
    v_pk_mul_f32 v[178:179], v[178:179], v[92:93] op_sel_hi:[1,0]
    v_pk_mul_f32 v[180:181], v[180:181], v[92:93] op_sel_hi:[1,0]
    v_pk_mul_f32 v[182:183], v[182:183], v[92:93] op_sel_hi:[1,0]
    v_cvt_pk_bf16_f32 v120, v176, v177
    v_cvt_pk_bf16_f32 v121, v178, v179
    v_cvt_pk_bf16_f32 v122, v180, v181
    v_cvt_pk_bf16_f32 v123, v182, v183
    v_pk_mul_f32 v[184:185], v[184:185], v[92:93] op_sel_hi:[1,0]
    v_pk_mul_f32 v[186:187], v[186:187], v[92:93] op_sel_hi:[1,0]
    v_pk_mul_f32 v[188:189], v[188:189], v[92:93] op_sel_hi:[1,0]
    v_pk_mul_f32 v[190:191], v[190:191], v[92:93] op_sel_hi:[1,0]
    v_cvt_pk_bf16_f32 v124, v184, v185
    v_cvt_pk_bf16_f32 v125, v186, v187
    v_cvt_pk_bf16_f32 v126, v188, v189
    v_cvt_pk_bf16_f32 v127, v190, v191
    v_pk_mul_f32 v[192:193], v[192:193], v[94:95] op_sel_hi:[1,0]
    v_pk_mul_f32 v[194:195], v[194:195], v[94:95] op_sel_hi:[1,0]
    v_pk_mul_f32 v[196:197], v[196:197], v[94:95] op_sel_hi:[1,0]
    v_pk_mul_f32 v[198:199], v[198:199], v[94:95] op_sel_hi:[1,0]
    v_cvt_pk_bf16_f32 v128, v192, v193
    v_cvt_pk_bf16_f32 v129, v194, v195
    v_cvt_pk_bf16_f32 v130, v196, v197
    v_cvt_pk_bf16_f32 v131, v198, v199
    v_pk_mul_f32 v[200:201], v[200:201], v[94:95] op_sel_hi:[1,0]
    v_pk_mul_f32 v[202:203], v[202:203], v[94:95] op_sel_hi:[1,0]
    v_pk_mul_f32 v[204:205], v[204:205], v[94:95] op_sel_hi:[1,0]
    v_pk_mul_f32 v[206:207], v[206:207], v[94:95] op_sel_hi:[1,0]
    v_cvt_pk_bf16_f32 v132, v200, v201
    v_cvt_pk_bf16_f32 v133, v202, v203
    v_cvt_pk_bf16_f32 v134, v204, v205
    v_cvt_pk_bf16_f32 v135, v206, v207
    v_pk_mul_f32 v[208:209], v[208:209], v[94:95] op_sel_hi:[1,0]
    v_pk_mul_f32 v[210:211], v[210:211], v[94:95] op_sel_hi:[1,0]
    v_pk_mul_f32 v[212:213], v[212:213], v[94:95] op_sel_hi:[1,0]
    v_pk_mul_f32 v[214:215], v[214:215], v[94:95] op_sel_hi:[1,0]
    v_cvt_pk_bf16_f32 v136, v208, v209
    v_cvt_pk_bf16_f32 v137, v210, v211
    v_cvt_pk_bf16_f32 v138, v212, v213
    v_cvt_pk_bf16_f32 v139, v214, v215
    v_pk_mul_f32 v[216:217], v[216:217], v[94:95] op_sel_hi:[1,0]
    v_pk_mul_f32 v[218:219], v[218:219], v[94:95] op_sel_hi:[1,0]
    v_pk_mul_f32 v[220:221], v[220:221], v[94:95] op_sel_hi:[1,0]
    v_pk_mul_f32 v[222:223], v[222:223], v[94:95] op_sel_hi:[1,0]
    v_cvt_pk_bf16_f32 v140, v216, v217
    v_cvt_pk_bf16_f32 v141, v218, v219
    v_cvt_pk_bf16_f32 v142, v220, v221
    v_cvt_pk_bf16_f32 v143, v222, v223
    v_pk_mul_f32 v[224:225], v[224:225], v[96:97] op_sel_hi:[1,0]
    v_pk_mul_f32 v[226:227], v[226:227], v[96:97] op_sel_hi:[1,0]
    v_pk_mul_f32 v[228:229], v[228:229], v[96:97] op_sel_hi:[1,0]
    v_pk_mul_f32 v[230:231], v[230:231], v[96:97] op_sel_hi:[1,0]
    v_cvt_pk_bf16_f32 v144, v224, v225
    v_cvt_pk_bf16_f32 v145, v226, v227
    v_cvt_pk_bf16_f32 v146, v228, v229
    v_cvt_pk_bf16_f32 v147, v230, v231
    v_pk_mul_f32 v[232:233], v[232:233], v[96:97] op_sel_hi:[1,0]
    v_pk_mul_f32 v[234:235], v[234:235], v[96:97] op_sel_hi:[1,0]
    v_pk_mul_f32 v[236:237], v[236:237], v[96:97] op_sel_hi:[1,0]
    v_pk_mul_f32 v[238:239], v[238:239], v[96:97] op_sel_hi:[1,0]
    v_cvt_pk_bf16_f32 v148, v232, v233
    v_cvt_pk_bf16_f32 v149, v234, v235
    v_cvt_pk_bf16_f32 v150, v236, v237
    v_cvt_pk_bf16_f32 v151, v238, v239
    v_pk_mul_f32 v[240:241], v[240:241], v[96:97] op_sel_hi:[1,0]
    v_pk_mul_f32 v[242:243], v[242:243], v[96:97] op_sel_hi:[1,0]
    v_pk_mul_f32 v[244:245], v[244:245], v[96:97] op_sel_hi:[1,0]
    v_pk_mul_f32 v[246:247], v[246:247], v[96:97] op_sel_hi:[1,0]
    v_cvt_pk_bf16_f32 v152, v240, v241
    v_cvt_pk_bf16_f32 v153, v242, v243
    v_cvt_pk_bf16_f32 v154, v244, v245
    v_cvt_pk_bf16_f32 v155, v246, v247
    v_pk_mul_f32 v[248:249], v[248:249], v[96:97] op_sel_hi:[1,0]
    v_pk_mul_f32 v[250:251], v[250:251], v[96:97] op_sel_hi:[1,0]
    v_pk_mul_f32 v[252:253], v[252:253], v[96:97] op_sel_hi:[1,0]
    v_pk_mul_f32 v[254:255], v[254:255], v[96:97] op_sel_hi:[1,0]
    v_cvt_pk_bf16_f32 v156, v248, v249
    v_cvt_pk_bf16_f32 v157, v250, v251
    v_cvt_pk_bf16_f32 v158, v252, v253
    v_cvt_pk_bf16_f32 v159, v254, v255
    s_lshl_b32 s45, s34, 3
    s_add_u32 s45, s45, s35
    s_lshl_b32 s45, s45, 5
    s_lshl_b32 s46, s50, 2
    s_add_u32 s45, s45, s46
    s_add_u32 s45, s45, s36
    s_mul_i32 s45, s45, 40
    s_add_u32 s45, s45, s39
    s_lshl_b32 s58, s45, 10
    s_add_u32 s45, s58, 0
    buffer_store_dwordx4 v[112:115], v26, s[28:31], s45 offen sc1
    s_add_u32 s45, s58, 10240
    buffer_store_dwordx4 v[116:119], v26, s[28:31], s45 offen sc1
    s_add_u32 s45, s58, 20480
    buffer_store_dwordx4 v[120:123], v26, s[28:31], s45 offen sc1
    s_add_u32 s45, s58, 30720
    buffer_store_dwordx4 v[124:127], v26, s[28:31], s45 offen sc1
    s_add_u32 s45, s58, 1024
    buffer_store_dwordx4 v[128:131], v26, s[28:31], s45 offen sc1
    s_add_u32 s45, s58, 11264
    buffer_store_dwordx4 v[132:135], v26, s[28:31], s45 offen sc1
    s_add_u32 s45, s58, 21504
    buffer_store_dwordx4 v[136:139], v26, s[28:31], s45 offen sc1
    s_add_u32 s45, s58, 31744
    buffer_store_dwordx4 v[140:143], v26, s[28:31], s45 offen sc1
    s_add_u32 s45, s58, 2048
    buffer_store_dwordx4 v[144:147], v26, s[28:31], s45 offen sc1
    s_add_u32 s45, s58, 12288
    buffer_store_dwordx4 v[148:151], v26, s[28:31], s45 offen sc1
    s_add_u32 s45, s58, 22528
    buffer_store_dwordx4 v[152:155], v26, s[28:31], s45 offen sc1
    s_add_u32 s45, s58, 32768
    buffer_store_dwordx4 v[156:159], v26, s[28:31], s45 offen sc1
    s_barrier
    s_lshl_b32 s45, s39, 12
    s_add_u32 s45, s45, 81920
    v_add_u32 v2, s45, v26
    ds_read_b128 v[112:115], v2 offset:0
    ds_read_b128 v[116:119], v2 offset:1024
    ds_read_b128 v[120:123], v2 offset:2048
    ds_read_b128 v[124:127], v2 offset:3072
    ds_read_b128 v[128:131], v2 offset:4096
    ds_read_b128 v[132:135], v2 offset:5120
    ds_read_b128 v[136:139], v2 offset:6144
    ds_read_b128 v[140:143], v2 offset:7168
    ds_read_b128 v[144:147], v2 offset:8192
    ds_read_b128 v[148:151], v2 offset:9216
    ds_read_b128 v[152:155], v2 offset:10240
    ds_read_b128 v[156:159], v2 offset:11264
    v_mov_b64 v[12:13], 0
    v_mov_b64 v[14:15], 0
    v_mov_b32 v8, 0
    v_mov_b64 v[16:17], 0
    v_mov_b64 v[18:19], 0
    v_mov_b32 v9, 0
    v_mov_b64 v[20:21], 0
    v_mov_b64 v[22:23], 0
    v_mov_b32 v10, 0
    v_mov_b64 v[24:25], 0
    v_mov_b64 v[26:27], 0
    v_mov_b64 v[28:29], 0
    v_mov_b64 v[30:31], 0
    v_mov_b64 v[32:33], 0
    v_mov_b64 v[34:35], 0
    v_mov_b64 v[36:37], 0
    v_mov_b64 v[38:39], 0
    v_mov_b64 v[40:41], 0
    v_mov_b64 v[42:43], 0
    v_mov_b64 v[44:45], 0
    v_mov_b64 v[46:47], 0
    v_mov_b64 v[48:49], 0
    v_mov_b64 v[50:51], 0
    v_mov_b64 v[52:53], 0
    v_mov_b64 v[54:55], 0
    v_mov_b64 v[104:105], 0
    v_mov_b64 v[106:107], 0
    v_mov_b32 v11, 0
    s_waitcnt lgkmcnt(0)
    s_nop 1
    v_mfma_f32_16x16x32_bf16 v[88:91], v[56:59], v[112:115], v[12:15]
    v_mfma_f32_16x16x32_bf16 v[92:95], v[72:75], v[112:115], v[12:15]
    v_mfma_f32_16x16x32_bf16 v[88:91], v[60:63], v[116:119], v[88:91]
    v_mfma_f32_16x16x32_bf16 v[92:95], v[76:79], v[116:119], v[92:95]
    v_mfma_f32_16x16x32_bf16 v[88:91], v[64:67], v[120:123], v[88:91]
    v_mfma_f32_16x16x32_bf16 v[92:95], v[80:83], v[120:123], v[92:95]
    v_mfma_f32_16x16x32_bf16 v[88:91], v[68:71], v[124:127], v[88:91]
    v_mfma_f32_16x16x32_bf16 v[92:95], v[84:87], v[124:127], v[92:95]
    s_mov_b32 s50, 1
    s_branch L_rnd_20
L_sg_22:
    s_waitcnt vmcnt(0)
    s_barrier
    s_cmp_lg_u32 s33, 0
    s_cbranch_scc1 L_sig_25
    v_mov_b32 v2, 0
    v_mov_b32 v3, 1
    s_mov_b64 s[70:71], exec
    s_mov_b64 exec, 1
    buffer_store_dword v3, v2, s[28:31], s49 offen sc0 sc1
    s_mov_b64 exec, s[70:71]
L_sig_25:
    s_branch L_sgr_23
L_atail_24:
    v_mbcnt_lo_u32_b32 v1, -1, 0
    v_mbcnt_hi_u32_b32 v1, -1, v1
    v_lshlrev_b32 v26, 4, v1
    s_setprio 0
    s_mov_b32 s79, 1
    s_waitcnt vmcnt(0)
    s_barrier
    s_nop 7
    v_mov_b32 v88, v8
    s_nop 1
    v_permlane16_swap_b32 v8, v88
    v_add_f32 v8, v8, v88
    v_mov_b32 v88, v8
    s_nop 1
    v_permlane32_swap_b32 v8, v88
    v_add_f32 v8, v8, v88
    v_mov_b32 v89, v9
    s_nop 1
    v_permlane16_swap_b32 v9, v89
    v_add_f32 v9, v9, v89
    v_mov_b32 v89, v9
    s_nop 1
    v_permlane32_swap_b32 v9, v89
    v_add_f32 v9, v9, v89
    v_mov_b32 v90, v10
    s_nop 1
    v_permlane16_swap_b32 v10, v90
    v_add_f32 v10, v10, v90
    v_mov_b32 v90, v10
    s_nop 1
    v_permlane32_swap_b32 v10, v90
    v_add_f32 v10, v10, v90
    v_rcp_f32 v92, v8
    v_rcp_f32 v94, v9
    v_rcp_f32 v96, v10
    v_pk_mul_f32 v[160:161], v[160:161], v[92:93] op_sel_hi:[1,0]
    v_pk_mul_f32 v[162:163], v[162:163], v[92:93] op_sel_hi:[1,0]
    v_pk_mul_f32 v[164:165], v[164:165], v[92:93] op_sel_hi:[1,0]
    v_pk_mul_f32 v[166:167], v[166:167], v[92:93] op_sel_hi:[1,0]
    v_cvt_pk_bf16_f32 v112, v160, v161
    v_cvt_pk_bf16_f32 v113, v162, v163
    v_cvt_pk_bf16_f32 v114, v164, v165
    v_cvt_pk_bf16_f32 v115, v166, v167
    v_pk_mul_f32 v[168:169], v[168:169], v[92:93] op_sel_hi:[1,0]
    v_pk_mul_f32 v[170:171], v[170:171], v[92:93] op_sel_hi:[1,0]
    v_pk_mul_f32 v[172:173], v[172:173], v[92:93] op_sel_hi:[1,0]
    v_pk_mul_f32 v[174:175], v[174:175], v[92:93] op_sel_hi:[1,0]
    v_cvt_pk_bf16_f32 v116, v168, v169
    v_cvt_pk_bf16_f32 v117, v170, v171
    v_cvt_pk_bf16_f32 v118, v172, v173
    v_cvt_pk_bf16_f32 v119, v174, v175
    v_pk_mul_f32 v[176:177], v[176:177], v[92:93] op_sel_hi:[1,0]
    v_pk_mul_f32 v[178:179], v[178:179], v[92:93] op_sel_hi:[1,0]
    v_pk_mul_f32 v[180:181], v[180:181], v[92:93] op_sel_hi:[1,0]
    v_pk_mul_f32 v[182:183], v[182:183], v[92:93] op_sel_hi:[1,0]
    v_cvt_pk_bf16_f32 v120, v176, v177
    v_cvt_pk_bf16_f32 v121, v178, v179
    v_cvt_pk_bf16_f32 v122, v180, v181
    v_cvt_pk_bf16_f32 v123, v182, v183
    v_pk_mul_f32 v[184:185], v[184:185], v[92:93] op_sel_hi:[1,0]
    v_pk_mul_f32 v[186:187], v[186:187], v[92:93] op_sel_hi:[1,0]
    v_pk_mul_f32 v[188:189], v[188:189], v[92:93] op_sel_hi:[1,0]
    v_pk_mul_f32 v[190:191], v[190:191], v[92:93] op_sel_hi:[1,0]
    v_cvt_pk_bf16_f32 v124, v184, v185
    v_cvt_pk_bf16_f32 v125, v186, v187
    v_cvt_pk_bf16_f32 v126, v188, v189
    v_cvt_pk_bf16_f32 v127, v190, v191
    v_pk_mul_f32 v[192:193], v[192:193], v[94:95] op_sel_hi:[1,0]
    v_pk_mul_f32 v[194:195], v[194:195], v[94:95] op_sel_hi:[1,0]
    v_pk_mul_f32 v[196:197], v[196:197], v[94:95] op_sel_hi:[1,0]
    v_pk_mul_f32 v[198:199], v[198:199], v[94:95] op_sel_hi:[1,0]
    v_cvt_pk_bf16_f32 v128, v192, v193
    v_cvt_pk_bf16_f32 v129, v194, v195
    v_cvt_pk_bf16_f32 v130, v196, v197
    v_cvt_pk_bf16_f32 v131, v198, v199
    v_pk_mul_f32 v[200:201], v[200:201], v[94:95] op_sel_hi:[1,0]
    v_pk_mul_f32 v[202:203], v[202:203], v[94:95] op_sel_hi:[1,0]
    v_pk_mul_f32 v[204:205], v[204:205], v[94:95] op_sel_hi:[1,0]
    v_pk_mul_f32 v[206:207], v[206:207], v[94:95] op_sel_hi:[1,0]
    v_cvt_pk_bf16_f32 v132, v200, v201
    v_cvt_pk_bf16_f32 v133, v202, v203
    v_cvt_pk_bf16_f32 v134, v204, v205
    v_cvt_pk_bf16_f32 v135, v206, v207
    v_pk_mul_f32 v[208:209], v[208:209], v[94:95] op_sel_hi:[1,0]
    v_pk_mul_f32 v[210:211], v[210:211], v[94:95] op_sel_hi:[1,0]
    v_pk_mul_f32 v[212:213], v[212:213], v[94:95] op_sel_hi:[1,0]
    v_pk_mul_f32 v[214:215], v[214:215], v[94:95] op_sel_hi:[1,0]
    v_cvt_pk_bf16_f32 v136, v208, v209
    v_cvt_pk_bf16_f32 v137, v210, v211
    v_cvt_pk_bf16_f32 v138, v212, v213
    v_cvt_pk_bf16_f32 v139, v214, v215
    v_pk_mul_f32 v[216:217], v[216:217], v[94:95] op_sel_hi:[1,0]
    v_pk_mul_f32 v[218:219], v[218:219], v[94:95] op_sel_hi:[1,0]
    v_pk_mul_f32 v[220:221], v[220:221], v[94:95] op_sel_hi:[1,0]
    v_pk_mul_f32 v[222:223], v[222:223], v[94:95] op_sel_hi:[1,0]
    v_cvt_pk_bf16_f32 v140, v216, v217
    v_cvt_pk_bf16_f32 v141, v218, v219
    v_cvt_pk_bf16_f32 v142, v220, v221
    v_cvt_pk_bf16_f32 v143, v222, v223
    v_pk_mul_f32 v[224:225], v[224:225], v[96:97] op_sel_hi:[1,0]
    v_pk_mul_f32 v[226:227], v[226:227], v[96:97] op_sel_hi:[1,0]
    v_pk_mul_f32 v[228:229], v[228:229], v[96:97] op_sel_hi:[1,0]
    v_pk_mul_f32 v[230:231], v[230:231], v[96:97] op_sel_hi:[1,0]
    v_cvt_pk_bf16_f32 v144, v224, v225
    v_cvt_pk_bf16_f32 v145, v226, v227
    v_cvt_pk_bf16_f32 v146, v228, v229
    v_cvt_pk_bf16_f32 v147, v230, v231
    v_pk_mul_f32 v[232:233], v[232:233], v[96:97] op_sel_hi:[1,0]
    v_pk_mul_f32 v[234:235], v[234:235], v[96:97] op_sel_hi:[1,0]
    v_pk_mul_f32 v[236:237], v[236:237], v[96:97] op_sel_hi:[1,0]
    v_pk_mul_f32 v[238:239], v[238:239], v[96:97] op_sel_hi:[1,0]
    v_cvt_pk_bf16_f32 v148, v232, v233
    v_cvt_pk_bf16_f32 v149, v234, v235
    v_cvt_pk_bf16_f32 v150, v236, v237
    v_cvt_pk_bf16_f32 v151, v238, v239
    v_pk_mul_f32 v[240:241], v[240:241], v[96:97] op_sel_hi:[1,0]
    v_pk_mul_f32 v[242:243], v[242:243], v[96:97] op_sel_hi:[1,0]
    v_pk_mul_f32 v[244:245], v[244:245], v[96:97] op_sel_hi:[1,0]
    v_pk_mul_f32 v[246:247], v[246:247], v[96:97] op_sel_hi:[1,0]
    v_cvt_pk_bf16_f32 v152, v240, v241
    v_cvt_pk_bf16_f32 v153, v242, v243
    v_cvt_pk_bf16_f32 v154, v244, v245
    v_cvt_pk_bf16_f32 v155, v246, v247
    v_pk_mul_f32 v[248:249], v[248:249], v[96:97] op_sel_hi:[1,0]
    v_pk_mul_f32 v[250:251], v[250:251], v[96:97] op_sel_hi:[1,0]
    v_pk_mul_f32 v[252:253], v[252:253], v[96:97] op_sel_hi:[1,0]
    v_pk_mul_f32 v[254:255], v[254:255], v[96:97] op_sel_hi:[1,0]
    v_cvt_pk_bf16_f32 v156, v248, v249
    v_cvt_pk_bf16_f32 v157, v250, v251
    v_cvt_pk_bf16_f32 v158, v252, v253
    v_cvt_pk_bf16_f32 v159, v254, v255
    s_lshl_b32 s45, s34, 3
    s_add_u32 s45, s45, s35
    s_lshl_b32 s45, s45, 5
    s_lshl_b32 s46, s50, 2
    s_add_u32 s45, s45, s46
    s_add_u32 s45, s45, s36
    s_mul_i32 s45, s45, 40
    s_add_u32 s45, s45, s39
    s_lshl_b32 s58, s45, 10
    v_lshrrev_b32 v2, 4, v1
    v_bfe_u32 v3, v1, 2, 2
    v_lshlrev_b32 v2, 2, v2
    v_add_u32 v2, v2, v3
    v_mul_u32_u24 v2, 288, v2
    v_and_b32 v3, 3, v1
    v_lshlrev_b32 v3, 3, v3
    v_add_u32 v2, v2, v3
    v_add_u32 v24, 10240, v2
    s_lshl_b32 s45, s39, 10
    v_add_u32 v25, s45, v26
    v_mov_b64 v[160:161], 0
    v_mov_b64 v[162:163], 0
    v_mov_b64 v[164:165], 0
    v_mov_b64 v[166:167], 0
    v_mov_b64 v[168:169], 0
    v_mov_b64 v[170:171], 0
    v_mov_b64 v[172:173], 0
    v_mov_b64 v[174:175], 0
    v_mov_b64 v[176:177], 0
    v_mov_b64 v[178:179], 0
    v_mov_b64 v[180:181], 0
    v_mov_b64 v[182:183], 0
    v_mov_b64 v[184:185], 0
    v_mov_b64 v[186:187], 0
    v_mov_b64 v[188:189], 0
    v_mov_b64 v[190:191], 0
    v_mov_b64 v[192:193], 0
    v_mov_b64 v[194:195], 0
    v_mov_b64 v[196:197], 0
    v_mov_b64 v[198:199], 0
    v_mov_b64 v[200:201], 0
    v_mov_b64 v[202:203], 0
    v_mov_b64 v[204:205], 0
    v_mov_b64 v[206:207], 0
    v_mov_b64 v[208:209], 0
    v_mov_b64 v[210:211], 0
    v_mov_b64 v[212:213], 0
    v_mov_b64 v[214:215], 0
    v_mov_b64 v[216:217], 0
    v_mov_b64 v[218:219], 0
    s_mov_b32 s77, 81920
    v_add_u32 v2, s77, v24
    v_add_u32 v3, s77, v25
    s_add_u32 s77, s77, 20480
    s_cmp_eq_u32 s77, 163840
    s_cselect_b32 s77, 0, s77
    ds_read_b128 v[56:59], v3 offset:0
    ds_read_b128 v[60:63], v3 offset:1024
    ds_read_b128 v[64:67], v3 offset:2048
    ds_read_b64_tr_b16 v[80:81], v2 offset:0
    ds_read_b64_tr_b16 v[82:83], v2 offset:4608
    ds_read_b64_tr_b16 v[84:85], v2 offset:32
    ds_read_b64_tr_b16 v[86:87], v2 offset:4640
    ds_read_b64_tr_b16 v[88:89], v2 offset:64
    ds_read_b64_tr_b16 v[90:91], v2 offset:4672
    ds_read_b64_tr_b16 v[92:93], v2 offset:96
    ds_read_b64_tr_b16 v[94:95], v2 offset:4704
    ds_read_b64_tr_b16 v[96:97], v2 offset:128
    ds_read_b64_tr_b16 v[98:99], v2 offset:4736
    s_waitcnt lgkmcnt(0)
    s_barrier
    v_mfma_f32_16x16x32_bf16 v[160:163], v[80:83], v[56:59], v[160:163]
    v_add_u32 v4, s77, v24
    v_add_u32 v5, s77, v25
    s_add_u32 s77, s77, 20480
    s_cmp_eq_u32 s77, 163840
    s_cselect_b32 s77, 0, s77
    v_mfma_f32_16x16x32_bf16 v[180:183], v[80:83], v[60:63], v[180:183]
    ds_read_b128 v[68:71], v5 offset:0
    v_mfma_f32_16x16x32_bf16 v[200:203], v[80:83], v[64:67], v[200:203]
    ds_read_b128 v[72:75], v5 offset:1024
    v_mfma_f32_16x16x32_bf16 v[164:167], v[84:87], v[56:59], v[164:167]
    ds_read_b128 v[76:79], v5 offset:2048
    s_add_u32 s45, s58, 0
    buffer_store_dwordx4 v[112:115], v26, s[28:31], s45 offen sc1
    v_mfma_f32_16x16x32_bf16 v[184:187], v[84:87], v[60:63], v[184:187]
    ds_read_b64_tr_b16 v[220:221], v4 offset:0
    ds_read_b64_tr_b16 v[222:223], v4 offset:4608
    v_mfma_f32_16x16x32_bf16 v[204:207], v[84:87], v[64:67], v[204:207]
    ds_read_b64_tr_b16 v[224:225], v4 offset:32
    ds_read_b64_tr_b16 v[226:227], v4 offset:4640
    v_mfma_f32_16x16x32_bf16 v[168:171], v[88:91], v[56:59], v[168:171]
    ds_read_b64_tr_b16 v[228:229], v4 offset:64
    ds_read_b64_tr_b16 v[230:231], v4 offset:4672
    v_mfma_f32_16x16x32_bf16 v[188:191], v[88:91], v[60:63], v[188:191]
    ds_read_b64_tr_b16 v[232:233], v4 offset:96
    ds_read_b64_tr_b16 v[234:235], v4 offset:4704
    v_mfma_f32_16x16x32_bf16 v[208:211], v[88:91], v[64:67], v[208:211]
    ds_read_b64_tr_b16 v[236:237], v4 offset:128
    ds_read_b64_tr_b16 v[238:239], v4 offset:4736
    s_add_u32 s45, s58, 10240
    buffer_store_dwordx4 v[116:119], v26, s[28:31], s45 offen sc1
    v_mfma_f32_16x16x32_bf16 v[172:175], v[92:95], v[56:59], v[172:175]
    v_mfma_f32_16x16x32_bf16 v[192:195], v[92:95], v[60:63], v[192:195]
    v_mfma_f32_16x16x32_bf16 v[212:215], v[92:95], v[64:67], v[212:215]
    v_mfma_f32_16x16x32_bf16 v[176:179], v[96:99], v[56:59], v[176:179]
    v_mfma_f32_16x16x32_bf16 v[196:199], v[96:99], v[60:63], v[196:199]
    s_add_u32 s45, s58, 20480
    buffer_store_dwordx4 v[120:123], v26, s[28:31], s45 offen sc1
    v_mfma_f32_16x16x32_bf16 v[216:219], v[96:99], v[64:67], v[216:219]
    s_waitcnt lgkmcnt(8)
    v_mfma_f32_16x16x32_bf16 v[160:163], v[220:223], v[68:71], v[160:163]
    v_add_u32 v2, s77, v24
    v_add_u32 v3, s77, v25
    s_add_u32 s77, s77, 20480
    s_cmp_eq_u32 s77, 163840
    s_cselect_b32 s77, 0, s77
    v_mfma_f32_16x16x32_bf16 v[180:183], v[220:223], v[72:75], v[180:183]
    ds_read_b128 v[56:59], v3 offset:0
    v_mfma_f32_16x16x32_bf16 v[200:203], v[220:223], v[76:79], v[200:203]
    ds_read_b128 v[60:63], v3 offset:1024
    s_waitcnt lgkmcnt(8)
    v_mfma_f32_16x16x32_bf16 v[164:167], v[224:227], v[68:71], v[164:167]
    ds_read_b128 v[64:67], v3 offset:2048
    s_add_u32 s45, s58, 30720
    buffer_store_dwordx4 v[124:127], v26, s[28:31], s45 offen sc1
    v_mfma_f32_16x16x32_bf16 v[184:187], v[224:227], v[72:75], v[184:187]
    ds_read_b64_tr_b16 v[80:81], v2 offset:0
    ds_read_b64_tr_b16 v[82:83], v2 offset:4608
    v_mfma_f32_16x16x32_bf16 v[204:207], v[224:227], v[76:79], v[204:207]
    ds_read_b64_tr_b16 v[84:85], v2 offset:32
    ds_read_b64_tr_b16 v[86:87], v2 offset:4640
    s_waitcnt lgkmcnt(11)
    v_mfma_f32_16x16x32_bf16 v[168:171], v[228:231], v[68:71], v[168:171]
    ds_read_b64_tr_b16 v[88:89], v2 offset:64
    ds_read_b64_tr_b16 v[90:91], v2 offset:4672
    v_mfma_f32_16x16x32_bf16 v[188:191], v[228:231], v[72:75], v[188:191]
    ds_read_b64_tr_b16 v[92:93], v2 offset:96
    ds_read_b64_tr_b16 v[94:95], v2 offset:4704
    v_mfma_f32_16x16x32_bf16 v[208:211], v[228:231], v[76:79], v[208:211]
    ds_read_b64_tr_b16 v[96:97], v2 offset:128
    ds_read_b64_tr_b16 v[98:99], v2 offset:4736
    s_add_u32 s45, s58, 1024
    buffer_store_dwordx4 v[128:131], v26, s[28:31], s45 offen sc1
    s_waitcnt lgkmcnt(15)
    v_mfma_f32_16x16x32_bf16 v[172:175], v[232:235], v[68:71], v[172:175]
    v_mfma_f32_16x16x32_bf16 v[192:195], v[232:235], v[72:75], v[192:195]
    v_mfma_f32_16x16x32_bf16 v[212:215], v[232:235], v[76:79], v[212:215]
    s_waitcnt lgkmcnt(13)
    v_mfma_f32_16x16x32_bf16 v[176:179], v[236:239], v[68:71], v[176:179]
    v_mfma_f32_16x16x32_bf16 v[196:199], v[236:239], v[72:75], v[196:199]
    s_add_u32 s45, s58, 11264
    buffer_store_dwordx4 v[132:135], v26, s[28:31], s45 offen sc1
    v_mfma_f32_16x16x32_bf16 v[216:219], v[236:239], v[76:79], v[216:219]
    s_waitcnt lgkmcnt(0)
    s_barrier
    v_mfma_f32_16x16x32_bf16 v[160:163], v[80:83], v[56:59], v[160:163]
    v_add_u32 v4, s77, v24
    v_add_u32 v5, s77, v25
    s_add_u32 s77, s77, 20480
    s_cmp_eq_u32 s77, 163840
    s_cselect_b32 s77, 0, s77
    v_mfma_f32_16x16x32_bf16 v[180:183], v[80:83], v[60:63], v[180:183]
    ds_read_b128 v[68:71], v5 offset:0
    v_mfma_f32_16x16x32_bf16 v[200:203], v[80:83], v[64:67], v[200:203]
    ds_read_b128 v[72:75], v5 offset:1024
    v_mfma_f32_16x16x32_bf16 v[164:167], v[84:87], v[56:59], v[164:167]
    ds_read_b128 v[76:79], v5 offset:2048
    s_add_u32 s45, s58, 21504
    buffer_store_dwordx4 v[136:139], v26, s[28:31], s45 offen sc1
    v_mfma_f32_16x16x32_bf16 v[184:187], v[84:87], v[60:63], v[184:187]
    ds_read_b64_tr_b16 v[220:221], v4 offset:0
    ds_read_b64_tr_b16 v[222:223], v4 offset:4608
    v_mfma_f32_16x16x32_bf16 v[204:207], v[84:87], v[64:67], v[204:207]
    ds_read_b64_tr_b16 v[224:225], v4 offset:32
    ds_read_b64_tr_b16 v[226:227], v4 offset:4640
    v_mfma_f32_16x16x32_bf16 v[168:171], v[88:91], v[56:59], v[168:171]
    ds_read_b64_tr_b16 v[228:229], v4 offset:64
    ds_read_b64_tr_b16 v[230:231], v4 offset:4672
    v_mfma_f32_16x16x32_bf16 v[188:191], v[88:91], v[60:63], v[188:191]
    ds_read_b64_tr_b16 v[232:233], v4 offset:96
    ds_read_b64_tr_b16 v[234:235], v4 offset:4704
    v_mfma_f32_16x16x32_bf16 v[208:211], v[88:91], v[64:67], v[208:211]
    ds_read_b64_tr_b16 v[236:237], v4 offset:128
    ds_read_b64_tr_b16 v[238:239], v4 offset:4736
    s_add_u32 s45, s58, 31744
    buffer_store_dwordx4 v[140:143], v26, s[28:31], s45 offen sc1
    v_mfma_f32_16x16x32_bf16 v[172:175], v[92:95], v[56:59], v[172:175]
    v_mfma_f32_16x16x32_bf16 v[192:195], v[92:95], v[60:63], v[192:195]
    v_mfma_f32_16x16x32_bf16 v[212:215], v[92:95], v[64:67], v[212:215]
    v_mfma_f32_16x16x32_bf16 v[176:179], v[96:99], v[56:59], v[176:179]
    v_mfma_f32_16x16x32_bf16 v[196:199], v[96:99], v[60:63], v[196:199]
    s_add_u32 s45, s58, 2048
    buffer_store_dwordx4 v[144:147], v26, s[28:31], s45 offen sc1
    v_mfma_f32_16x16x32_bf16 v[216:219], v[96:99], v[64:67], v[216:219]
    s_waitcnt lgkmcnt(8)
    v_mfma_f32_16x16x32_bf16 v[160:163], v[220:223], v[68:71], v[160:163]
    v_add_u32 v2, s77, v24
    v_add_u32 v3, s77, v25
    s_add_u32 s77, s77, 20480
    s_cmp_eq_u32 s77, 163840
    s_cselect_b32 s77, 0, s77
    v_mfma_f32_16x16x32_bf16 v[180:183], v[220:223], v[72:75], v[180:183]
    ds_read_b128 v[56:59], v3 offset:0
    v_mfma_f32_16x16x32_bf16 v[200:203], v[220:223], v[76:79], v[200:203]
    ds_read_b128 v[60:63], v3 offset:1024
    s_waitcnt lgkmcnt(8)
    v_mfma_f32_16x16x32_bf16 v[164:167], v[224:227], v[68:71], v[164:167]
    ds_read_b128 v[64:67], v3 offset:2048
    s_add_u32 s45, s58, 12288
    buffer_store_dwordx4 v[148:151], v26, s[28:31], s45 offen sc1
    v_mfma_f32_16x16x32_bf16 v[184:187], v[224:227], v[72:75], v[184:187]
    ds_read_b64_tr_b16 v[80:81], v2 offset:0
    ds_read_b64_tr_b16 v[82:83], v2 offset:4608
    v_mfma_f32_16x16x32_bf16 v[204:207], v[224:227], v[76:79], v[204:207]
    ds_read_b64_tr_b16 v[84:85], v2 offset:32
    ds_read_b64_tr_b16 v[86:87], v2 offset:4640
    s_waitcnt lgkmcnt(11)
    v_mfma_f32_16x16x32_bf16 v[168:171], v[228:231], v[68:71], v[168:171]
    ds_read_b64_tr_b16 v[88:89], v2 offset:64
    ds_read_b64_tr_b16 v[90:91], v2 offset:4672
    v_mfma_f32_16x16x32_bf16 v[188:191], v[228:231], v[72:75], v[188:191]
    ds_read_b64_tr_b16 v[92:93], v2 offset:96
    ds_read_b64_tr_b16 v[94:95], v2 offset:4704
    v_mfma_f32_16x16x32_bf16 v[208:211], v[228:231], v[76:79], v[208:211]
    ds_read_b64_tr_b16 v[96:97], v2 offset:128
    ds_read_b64_tr_b16 v[98:99], v2 offset:4736
    s_add_u32 s45, s58, 22528
    buffer_store_dwordx4 v[152:155], v26, s[28:31], s45 offen sc1
    s_waitcnt lgkmcnt(15)
    v_mfma_f32_16x16x32_bf16 v[172:175], v[232:235], v[68:71], v[172:175]
    v_mfma_f32_16x16x32_bf16 v[192:195], v[232:235], v[72:75], v[192:195]
    v_mfma_f32_16x16x32_bf16 v[212:215], v[232:235], v[76:79], v[212:215]
    s_waitcnt lgkmcnt(13)
    v_mfma_f32_16x16x32_bf16 v[176:179], v[236:239], v[68:71], v[176:179]
    v_mfma_f32_16x16x32_bf16 v[196:199], v[236:239], v[72:75], v[196:199]
    s_add_u32 s45, s58, 32768
    buffer_store_dwordx4 v[156:159], v26, s[28:31], s45 offen sc1
    v_mfma_f32_16x16x32_bf16 v[216:219], v[236:239], v[76:79], v[216:219]
    s_waitcnt lgkmcnt(0)
    s_mov_b32 s41, 4
L_op_26:
    s_barrier
    s_cmp_lg_u32 s41, 8
    s_cbranch_scc1 L_k6_28
    s_cmp_lg_u32 s33, 0
    s_cbranch_scc1 L_sig_29
    v_mov_b32 v2, 0
    v_mov_b32 v3, 3
    s_mov_b64 s[70:71], exec
    s_mov_b64 exec, 1
    buffer_store_dword v3, v2, s[28:31], s49 offen sc0 sc1
    s_mov_b64 exec, s[70:71]
L_sig_29:
L_k6_28:
    s_cmp_lg_u32 s41, 10
    s_cbranch_scc1 L_k10_30
    s_cmp_lg_u32 s33, 4
    s_cbranch_scc1 L_polld_32
    s_and_b32 s45, s49, 0xffffff00
    v_mov_b32 v2, 0
    s_mov_b32 s46, 0
L_poll_31:
    buffer_load_dwordx4 v[4:7], v2, s[28:31], s45 offen sc0 sc1
    s_waitcnt vmcnt(0)
    v_and_b32 v4, v4, v5
    v_and_b32 v6, v6, v7
    v_and_b32 v4, v4, v6
    s_nop 0
    v_readfirstlane_b32 s47, v4
    s_add_u32 s46, s46, 1
    s_and_b32 s47, s47, 2
    s_cmp_eq_u32 s47, 2
    s_cbranch_scc1 L_polld_32
    s_sleep 2
    s_cmp_lt_u32 s46, 200000
    s_cbranch_scc1 L_poll_31
L_polld_32:
    s_barrier
L_k10_30:
    v_mfma_f32_16x16x32_bf16 v[160:163], v[80:83], v[56:59], v[160:163]
    v_add_u32 v4, s77, v24
    v_add_u32 v5, s77, v25
    s_add_u32 s77, s77, 20480
    s_cmp_eq_u32 s77, 163840
    s_cselect_b32 s77, 0, s77
    v_mfma_f32_16x16x32_bf16 v[180:183], v[80:83], v[60:63], v[180:183]
    ds_read_b128 v[68:71], v5 offset:0
    v_mfma_f32_16x16x32_bf16 v[200:203], v[80:83], v[64:67], v[200:203]
    ds_read_b128 v[72:75], v5 offset:1024
    v_mfma_f32_16x16x32_bf16 v[164:167], v[84:87], v[56:59], v[164:167]
    ds_read_b128 v[76:79], v5 offset:2048
    v_mfma_f32_16x16x32_bf16 v[184:187], v[84:87], v[60:63], v[184:187]
    ds_read_b64_tr_b16 v[220:221], v4 offset:0
    ds_read_b64_tr_b16 v[222:223], v4 offset:4608
    v_mfma_f32_16x16x32_bf16 v[204:207], v[84:87], v[64:67], v[204:207]
    ds_read_b64_tr_b16 v[224:225], v4 offset:32
    ds_read_b64_tr_b16 v[226:227], v4 offset:4640
    v_mfma_f32_16x16x32_bf16 v[168:171], v[88:91], v[56:59], v[168:171]
    ds_read_b64_tr_b16 v[228:229], v4 offset:64
    ds_read_b64_tr_b16 v[230:231], v4 offset:4672
    v_mfma_f32_16x16x32_bf16 v[188:191], v[88:91], v[60:63], v[188:191]
    ds_read_b64_tr_b16 v[232:233], v4 offset:96
    ds_read_b64_tr_b16 v[234:235], v4 offset:4704
    v_mfma_f32_16x16x32_bf16 v[208:211], v[88:91], v[64:67], v[208:211]
    ds_read_b64_tr_b16 v[236:237], v4 offset:128
    ds_read_b64_tr_b16 v[238:239], v4 offset:4736
    v_mfma_f32_16x16x32_bf16 v[172:175], v[92:95], v[56:59], v[172:175]
    v_mfma_f32_16x16x32_bf16 v[192:195], v[92:95], v[60:63], v[192:195]
    v_mfma_f32_16x16x32_bf16 v[212:215], v[92:95], v[64:67], v[212:215]
    v_mfma_f32_16x16x32_bf16 v[176:179], v[96:99], v[56:59], v[176:179]
    v_mfma_f32_16x16x32_bf16 v[196:199], v[96:99], v[60:63], v[196:199]
    v_mfma_f32_16x16x32_bf16 v[216:219], v[96:99], v[64:67], v[216:219]
    s_waitcnt lgkmcnt(8)
    v_mfma_f32_16x16x32_bf16 v[160:163], v[220:223], v[68:71], v[160:163]
    v_add_u32 v2, s77, v24
    v_add_u32 v3, s77, v25
    s_add_u32 s77, s77, 20480
    s_cmp_eq_u32 s77, 163840
    s_cselect_b32 s77, 0, s77
    v_mfma_f32_16x16x32_bf16 v[180:183], v[220:223], v[72:75], v[180:183]
    ds_read_b128 v[56:59], v3 offset:0
    v_mfma_f32_16x16x32_bf16 v[200:203], v[220:223], v[76:79], v[200:203]
    ds_read_b128 v[60:63], v3 offset:1024
    s_waitcnt lgkmcnt(8)
    v_mfma_f32_16x16x32_bf16 v[164:167], v[224:227], v[68:71], v[164:167]
    ds_read_b128 v[64:67], v3 offset:2048
    v_mfma_f32_16x16x32_bf16 v[184:187], v[224:227], v[72:75], v[184:187]
    ds_read_b64_tr_b16 v[80:81], v2 offset:0
    ds_read_b64_tr_b16 v[82:83], v2 offset:4608
    v_mfma_f32_16x16x32_bf16 v[204:207], v[224:227], v[76:79], v[204:207]
    ds_read_b64_tr_b16 v[84:85], v2 offset:32
    ds_read_b64_tr_b16 v[86:87], v2 offset:4640
    s_waitcnt lgkmcnt(11)
    v_mfma_f32_16x16x32_bf16 v[168:171], v[228:231], v[68:71], v[168:171]
    ds_read_b64_tr_b16 v[88:89], v2 offset:64
    ds_read_b64_tr_b16 v[90:91], v2 offset:4672
    v_mfma_f32_16x16x32_bf16 v[188:191], v[228:231], v[72:75], v[188:191]
    ds_read_b64_tr_b16 v[92:93], v2 offset:96
    ds_read_b64_tr_b16 v[94:95], v2 offset:4704
    v_mfma_f32_16x16x32_bf16 v[208:211], v[228:231], v[76:79], v[208:211]
    ds_read_b64_tr_b16 v[96:97], v2 offset:128
    ds_read_b64_tr_b16 v[98:99], v2 offset:4736
    s_waitcnt lgkmcnt(15)
    v_mfma_f32_16x16x32_bf16 v[172:175], v[232:235], v[68:71], v[172:175]
    v_mfma_f32_16x16x32_bf16 v[192:195], v[232:235], v[72:75], v[192:195]
    v_mfma_f32_16x16x32_bf16 v[212:215], v[232:235], v[76:79], v[212:215]
    s_waitcnt lgkmcnt(13)
    v_mfma_f32_16x16x32_bf16 v[176:179], v[236:239], v[68:71], v[176:179]
    v_mfma_f32_16x16x32_bf16 v[196:199], v[236:239], v[72:75], v[196:199]
    v_mfma_f32_16x16x32_bf16 v[216:219], v[236:239], v[76:79], v[216:219]
    s_waitcnt lgkmcnt(0)
    s_cmp_lg_u32 s41, 6
    s_cbranch_scc1 L_k4_33
    s_waitcnt vmcnt(0)
L_k4_33:
    s_add_u32 s41, s41, 2
    s_cmp_lt_u32 s41, 32
    s_cbranch_scc1 L_op_26
    s_nop 7
    s_mul_i32 s66, s39, 3
    s_lshr_b32 s66, s66, 3
    s_lshl_b32 s78, s48, 8
    s_lshl_b32 s46, s37, 2
    s_add_u32 s78, s78, s46
    s_add_u32 s78, s78, 117456896
    s_lshl_b32 s67, s48, 4
    s_add_u32 s67, s67, s66
    s_lshl_b32 s67, s67, 1
    s_add_u32 s67, s67, s79
    s_lshl_b32 s67, s67, 13
    s_add_u32 s67, s67, 67108864
    s_cmp_eq_u32 s66, s37
    s_cbranch_scc1 L_keep_34
    v_cvt_pk_bf16_f32 v56, v160, v161
    v_cvt_pk_bf16_f32 v57, v162, v163
    v_cvt_pk_bf16_f32 v58, v164, v165
    v_cvt_pk_bf16_f32 v59, v166, v167
    v_cvt_pk_bf16_f32 v60, v168, v169
    v_cvt_pk_bf16_f32 v61, v170, v171
    v_cvt_pk_bf16_f32 v62, v172, v173
    v_cvt_pk_bf16_f32 v63, v174, v175
    v_cvt_pk_bf16_f32 v64, v176, v177
    v_cvt_pk_bf16_f32 v65, v178, v179
    v_cvt_pk_bf16_f32 v66, v180, v181
    v_cvt_pk_bf16_f32 v67, v182, v183
    v_cvt_pk_bf16_f32 v68, v184, v185
    v_cvt_pk_bf16_f32 v69, v186, v187
    v_cvt_pk_bf16_f32 v70, v188, v189
    v_cvt_pk_bf16_f32 v71, v190, v191
    v_cvt_pk_bf16_f32 v72, v192, v193
    v_cvt_pk_bf16_f32 v73, v194, v195
    v_cvt_pk_bf16_f32 v74, v196, v197
    v_cvt_pk_bf16_f32 v75, v198, v199
    v_cvt_pk_bf16_f32 v76, v200, v201
    v_cvt_pk_bf16_f32 v77, v202, v203
    v_cvt_pk_bf16_f32 v78, v204, v205
    v_cvt_pk_bf16_f32 v79, v206, v207
    v_cvt_pk_bf16_f32 v80, v208, v209
    v_cvt_pk_bf16_f32 v81, v210, v211
    v_cvt_pk_bf16_f32 v82, v212, v213
    v_cvt_pk_bf16_f32 v83, v214, v215
    v_cvt_pk_bf16_f32 v84, v216, v217
    v_cvt_pk_bf16_f32 v85, v218, v219
    s_lshl_b32 s45, s37, 16
    s_add_u32 s45, s45, s67
    s_add_u32 s46, s45, 0
    buffer_store_dwordx4 v[56:59], v26, s[28:31], s46 offen sc0 sc1
    s_add_u32 s46, s45, 1024
    buffer_store_dwordx4 v[60:63], v26, s[28:31], s46 offen sc0 sc1
    s_add_u32 s46, s45, 2048
    buffer_store_dwordx4 v[64:67], v26, s[28:31], s46 offen sc0 sc1
    s_add_u32 s46, s45, 3072
    buffer_store_dwordx4 v[68:71], v26, s[28:31], s46 offen sc0 sc1
    s_add_u32 s46, s45, 4096
    buffer_store_dwordx4 v[72:75], v26, s[28:31], s46 offen sc0 sc1
    s_add_u32 s46, s45, 5120
    buffer_store_dwordx4 v[76:79], v26, s[28:31], s46 offen sc0 sc1
    s_add_u32 s46, s45, 6144
    buffer_store_dwordx4 v[80:83], v26, s[28:31], s46 offen sc0 sc1
    s_add_u32 s46, s45, 7168
    buffer_store_dwordx4 v[84:87], v26, s[28:31], s46 offen sc0 sc1
L_keep_34:
    s_waitcnt vmcnt(0)
    s_barrier
    s_cmp_lg_u32 s33, 0
    s_cbranch_scc1 L_sig_37
    v_mov_b32 v2, 0
    v_mov_b32 v3, 1
    s_mov_b64 s[70:71], exec
    s_mov_b64 exec, 1
    buffer_store_dword v3, v2, s[28:31], s78 offen sc0 sc1
    s_mov_b64 exec, s[70:71]
L_sig_37:
    s_cmp_lg_u32 s33, 0
    s_cbranch_scc1 L_polld_39
    s_and_b32 s45, s78, 0xffffff00
    v_mov_b32 v2, 0
    s_mov_b32 s46, 0
L_poll_38:
    buffer_load_dwordx4 v[4:7], v2, s[28:31], s45 offen sc0 sc1
    s_waitcnt vmcnt(0)
    v_and_b32 v4, v4, v5
    v_and_b32 v6, v6, v7
    v_and_b32 v4, v4, v6
    s_nop 0
    v_readfirstlane_b32 s47, v4
    s_add_u32 s46, s46, 1
    s_and_b32 s47, s47, 1
    s_cmp_eq_u32 s47, 1
    s_cbranch_scc1 L_polld_39
    s_sleep 2
    s_cmp_lt_u32 s46, 200000
    s_cbranch_scc1 L_poll_38
L_polld_39:
    s_barrier
    s_cmp_lg_u32 s66, s37
    s_cbranch_scc1 L_s2e_36
    s_add_u32 s45, s37, 1
    s_and_b32 s45, s45, 3
    s_lshl_b32 s45, s45, 16
    s_add_u32 s45, s45, s67
    s_add_u32 s46, s45, 0
    buffer_load_dwordx4 v[56:59], v26, s[28:31], s46 offen sc0 sc1
    s_add_u32 s46, s45, 1024
    buffer_load_dwordx4 v[60:63], v26, s[28:31], s46 offen sc0 sc1
    s_add_u32 s46, s45, 2048
    buffer_load_dwordx4 v[64:67], v26, s[28:31], s46 offen sc0 sc1
    s_add_u32 s46, s45, 3072
    buffer_load_dwordx4 v[68:71], v26, s[28:31], s46 offen sc0 sc1
    s_add_u32 s46, s45, 4096
    buffer_load_dwordx4 v[72:75], v26, s[28:31], s46 offen sc0 sc1
    s_add_u32 s46, s45, 5120
    buffer_load_dwordx4 v[76:79], v26, s[28:31], s46 offen sc0 sc1
    s_add_u32 s46, s45, 6144
    buffer_load_dwordx4 v[80:83], v26, s[28:31], s46 offen sc0 sc1
    s_add_u32 s46, s45, 7168
    buffer_load_dwordx4 v[84:87], v26, s[28:31], s46 offen sc0 sc1
    s_add_u32 s45, s37, 2
    s_and_b32 s45, s45, 3
    s_lshl_b32 s45, s45, 16
    s_add_u32 s45, s45, s67
    s_add_u32 s46, s45, 0
    buffer_load_dwordx4 v[88:91], v26, s[28:31], s46 offen sc0 sc1
    s_add_u32 s46, s45, 1024
    buffer_load_dwordx4 v[92:95], v26, s[28:31], s46 offen sc0 sc1
    s_add_u32 s46, s45, 2048
    buffer_load_dwordx4 v[96:99], v26, s[28:31], s46 offen sc0 sc1
    s_add_u32 s46, s45, 3072
    buffer_load_dwordx4 v[100:103], v26, s[28:31], s46 offen sc0 sc1
    s_add_u32 s46, s45, 4096
    buffer_load_dwordx4 v[104:107], v26, s[28:31], s46 offen sc0 sc1
    s_add_u32 s46, s45, 5120
    buffer_load_dwordx4 v[108:111], v26, s[28:31], s46 offen sc0 sc1
    s_add_u32 s46, s45, 6144
    buffer_load_dwordx4 v[112:115], v26, s[28:31], s46 offen sc0 sc1
    s_add_u32 s46, s45, 7168
    buffer_load_dwordx4 v[116:119], v26, s[28:31], s46 offen sc0 sc1
    s_add_u32 s45, s37, 3
    s_and_b32 s45, s45, 3
    s_lshl_b32 s45, s45, 16
    s_add_u32 s45, s45, s67
    s_add_u32 s46, s45, 0
    buffer_load_dwordx4 v[120:123], v26, s[28:31], s46 offen sc0 sc1
    s_add_u32 s46, s45, 1024
    buffer_load_dwordx4 v[124:127], v26, s[28:31], s46 offen sc0 sc1
    s_add_u32 s46, s45, 2048
    buffer_load_dwordx4 v[128:131], v26, s[28:31], s46 offen sc0 sc1
    s_add_u32 s46, s45, 3072
    buffer_load_dwordx4 v[132:135], v26, s[28:31], s46 offen sc0 sc1
    s_add_u32 s46, s45, 4096
    buffer_load_dwordx4 v[136:139], v26, s[28:31], s46 offen sc0 sc1
    s_add_u32 s46, s45, 5120
    buffer_load_dwordx4 v[140:143], v26, s[28:31], s46 offen sc0 sc1
    s_add_u32 s46, s45, 6144
    buffer_load_dwordx4 v[144:147], v26, s[28:31], s46 offen sc0 sc1
    s_add_u32 s46, s45, 7168
    buffer_load_dwordx4 v[148:151], v26, s[28:31], s46 offen sc0 sc1
    s_load_dwordx2 s[80:81], s[0:1], 80
    v_and_b32 v2, 15, v1
    v_mul_u32_u24 v2, 2304, v2
    v_lshrrev_b32 v3, 4, v1
    v_lshlrev_b32 v3, 3, v3
    v_add_u32 v2, v2, v3
    s_mul_i32 s45, s35, 160
    s_lshl_b32 s46, s39, 4
    s_add_u32 s45, s45, s46
    s_mul_i32 s45, s45, 2304
    s_mul_i32 s46, s34, 1152
    s_add_u32 s45, s45, s46
    s_mul_i32 s46, s38, 288
    s_add_u32 s45, s45, s46
    s_waitcnt lgkmcnt(0)
    s_mov_b32 s16, s80
    s_mov_b32 s17, s81
    s_mov_b32 s18, 2949120
    s_mov_b32 s19, 0x20000
    s_waitcnt vmcnt(16)
    v_lshlrev_b32 v4, 16, v56
    v_and_b32 v5, 0xffff0000, v56
    v_add_f32 v160, v160, v4
    v_add_f32 v161, v161, v5
    v_lshlrev_b32 v4, 16, v57
    v_and_b32 v5, 0xffff0000, v57
    v_add_f32 v162, v162, v4
    v_add_f32 v163, v163, v5
    v_lshlrev_b32 v4, 16, v58
    v_and_b32 v5, 0xffff0000, v58
    v_add_f32 v164, v164, v4
    v_add_f32 v165, v165, v5
    v_lshlrev_b32 v4, 16, v59
    v_and_b32 v5, 0xffff0000, v59
    v_add_f32 v166, v166, v4
    v_add_f32 v167, v167, v5
    v_lshlrev_b32 v4, 16, v60
    v_and_b32 v5, 0xffff0000, v60
    v_add_f32 v168, v168, v4
    v_add_f32 v169, v169, v5
    v_lshlrev_b32 v4, 16, v61
    v_and_b32 v5, 0xffff0000, v61
    v_add_f32 v170, v170, v4
    v_add_f32 v171, v171, v5
    v_lshlrev_b32 v4, 16, v62
    v_and_b32 v5, 0xffff0000, v62
    v_add_f32 v172, v172, v4
    v_add_f32 v173, v173, v5
    v_lshlrev_b32 v4, 16, v63
    v_and_b32 v5, 0xffff0000, v63
    v_add_f32 v174, v174, v4
    v_add_f32 v175, v175, v5
    v_lshlrev_b32 v4, 16, v64
    v_and_b32 v5, 0xffff0000, v64
    v_add_f32 v176, v176, v4
    v_add_f32 v177, v177, v5
    v_lshlrev_b32 v4, 16, v65
    v_and_b32 v5, 0xffff0000, v65
    v_add_f32 v178, v178, v4
    v_add_f32 v179, v179, v5
    v_lshlrev_b32 v4, 16, v66
    v_and_b32 v5, 0xffff0000, v66
    v_add_f32 v180, v180, v4
    v_add_f32 v181, v181, v5
    v_lshlrev_b32 v4, 16, v67
    v_and_b32 v5, 0xffff0000, v67
    v_add_f32 v182, v182, v4
    v_add_f32 v183, v183, v5
    v_lshlrev_b32 v4, 16, v68
    v_and_b32 v5, 0xffff0000, v68
    v_add_f32 v184, v184, v4
    v_add_f32 v185, v185, v5
    v_lshlrev_b32 v4, 16, v69
    v_and_b32 v5, 0xffff0000, v69
    v_add_f32 v186, v186, v4
    v_add_f32 v187, v187, v5
    v_lshlrev_b32 v4, 16, v70
    v_and_b32 v5, 0xffff0000, v70
    v_add_f32 v188, v188, v4
    v_add_f32 v189, v189, v5
    v_lshlrev_b32 v4, 16, v71
    v_and_b32 v5, 0xffff0000, v71
    v_add_f32 v190, v190, v4
    v_add_f32 v191, v191, v5
    v_lshlrev_b32 v4, 16, v72
    v_and_b32 v5, 0xffff0000, v72
    v_add_f32 v192, v192, v4
    v_add_f32 v193, v193, v5
    v_lshlrev_b32 v4, 16, v73
    v_and_b32 v5, 0xffff0000, v73
    v_add_f32 v194, v194, v4
    v_add_f32 v195, v195, v5
    v_lshlrev_b32 v4, 16, v74
    v_and_b32 v5, 0xffff0000, v74
    v_add_f32 v196, v196, v4
    v_add_f32 v197, v197, v5
    v_lshlrev_b32 v4, 16, v75
    v_and_b32 v5, 0xffff0000, v75
    v_add_f32 v198, v198, v4
    v_add_f32 v199, v199, v5
    v_lshlrev_b32 v4, 16, v76
    v_and_b32 v5, 0xffff0000, v76
    v_add_f32 v200, v200, v4
    v_add_f32 v201, v201, v5
    v_lshlrev_b32 v4, 16, v77
    v_and_b32 v5, 0xffff0000, v77
    v_add_f32 v202, v202, v4
    v_add_f32 v203, v203, v5
    v_lshlrev_b32 v4, 16, v78
    v_and_b32 v5, 0xffff0000, v78
    v_add_f32 v204, v204, v4
    v_add_f32 v205, v205, v5
    v_lshlrev_b32 v4, 16, v79
    v_and_b32 v5, 0xffff0000, v79
    v_add_f32 v206, v206, v4
    v_add_f32 v207, v207, v5
    v_lshlrev_b32 v4, 16, v80
    v_and_b32 v5, 0xffff0000, v80
    v_add_f32 v208, v208, v4
    v_add_f32 v209, v209, v5
    v_lshlrev_b32 v4, 16, v81
    v_and_b32 v5, 0xffff0000, v81
    v_add_f32 v210, v210, v4
    v_add_f32 v211, v211, v5
    v_lshlrev_b32 v4, 16, v82
    v_and_b32 v5, 0xffff0000, v82
    v_add_f32 v212, v212, v4
    v_add_f32 v213, v213, v5
    v_lshlrev_b32 v4, 16, v83
    v_and_b32 v5, 0xffff0000, v83
    v_add_f32 v214, v214, v4
    v_add_f32 v215, v215, v5
    v_lshlrev_b32 v4, 16, v84
    v_and_b32 v5, 0xffff0000, v84
    v_add_f32 v216, v216, v4
    v_add_f32 v217, v217, v5
    v_lshlrev_b32 v4, 16, v85
    v_and_b32 v5, 0xffff0000, v85
    v_add_f32 v218, v218, v4
    v_add_f32 v219, v219, v5
    s_waitcnt vmcnt(8)
    v_lshlrev_b32 v4, 16, v88
    v_and_b32 v5, 0xffff0000, v88
    v_add_f32 v160, v160, v4
    v_add_f32 v161, v161, v5
    v_lshlrev_b32 v4, 16, v89
    v_and_b32 v5, 0xffff0000, v89
    v_add_f32 v162, v162, v4
    v_add_f32 v163, v163, v5
    v_lshlrev_b32 v4, 16, v90
    v_and_b32 v5, 0xffff0000, v90
    v_add_f32 v164, v164, v4
    v_add_f32 v165, v165, v5
    v_lshlrev_b32 v4, 16, v91
    v_and_b32 v5, 0xffff0000, v91
    v_add_f32 v166, v166, v4
    v_add_f32 v167, v167, v5
    v_lshlrev_b32 v4, 16, v92
    v_and_b32 v5, 0xffff0000, v92
    v_add_f32 v168, v168, v4
    v_add_f32 v169, v169, v5
    v_lshlrev_b32 v4, 16, v93
    v_and_b32 v5, 0xffff0000, v93
    v_add_f32 v170, v170, v4
    v_add_f32 v171, v171, v5
    v_lshlrev_b32 v4, 16, v94
    v_and_b32 v5, 0xffff0000, v94
    v_add_f32 v172, v172, v4
    v_add_f32 v173, v173, v5
    v_lshlrev_b32 v4, 16, v95
    v_and_b32 v5, 0xffff0000, v95
    v_add_f32 v174, v174, v4
    v_add_f32 v175, v175, v5
    v_lshlrev_b32 v4, 16, v96
    v_and_b32 v5, 0xffff0000, v96
    v_add_f32 v176, v176, v4
    v_add_f32 v177, v177, v5
    v_lshlrev_b32 v4, 16, v97
    v_and_b32 v5, 0xffff0000, v97
    v_add_f32 v178, v178, v4
    v_add_f32 v179, v179, v5
    v_lshlrev_b32 v4, 16, v98
    v_and_b32 v5, 0xffff0000, v98
    v_add_f32 v180, v180, v4
    v_add_f32 v181, v181, v5
    v_lshlrev_b32 v4, 16, v99
    v_and_b32 v5, 0xffff0000, v99
    v_add_f32 v182, v182, v4
    v_add_f32 v183, v183, v5
    v_lshlrev_b32 v4, 16, v100
    v_and_b32 v5, 0xffff0000, v100
    v_add_f32 v184, v184, v4
    v_add_f32 v185, v185, v5
    v_lshlrev_b32 v4, 16, v101
    v_and_b32 v5, 0xffff0000, v101
    v_add_f32 v186, v186, v4
    v_add_f32 v187, v187, v5
    v_lshlrev_b32 v4, 16, v102
    v_and_b32 v5, 0xffff0000, v102
    v_add_f32 v188, v188, v4
    v_add_f32 v189, v189, v5
    v_lshlrev_b32 v4, 16, v103
    v_and_b32 v5, 0xffff0000, v103
    v_add_f32 v190, v190, v4
    v_add_f32 v191, v191, v5
    v_lshlrev_b32 v4, 16, v104
    v_and_b32 v5, 0xffff0000, v104
    v_add_f32 v192, v192, v4
    v_add_f32 v193, v193, v5
    v_lshlrev_b32 v4, 16, v105
    v_and_b32 v5, 0xffff0000, v105
    v_add_f32 v194, v194, v4
    v_add_f32 v195, v195, v5
    v_lshlrev_b32 v4, 16, v106
    v_and_b32 v5, 0xffff0000, v106
    v_add_f32 v196, v196, v4
    v_add_f32 v197, v197, v5
    v_lshlrev_b32 v4, 16, v107
    v_and_b32 v5, 0xffff0000, v107
    v_add_f32 v198, v198, v4
    v_add_f32 v199, v199, v5
    v_lshlrev_b32 v4, 16, v108
    v_and_b32 v5, 0xffff0000, v108
    v_add_f32 v200, v200, v4
    v_add_f32 v201, v201, v5
    v_lshlrev_b32 v4, 16, v109
    v_and_b32 v5, 0xffff0000, v109
    v_add_f32 v202, v202, v4
    v_add_f32 v203, v203, v5
    v_lshlrev_b32 v4, 16, v110
    v_and_b32 v5, 0xffff0000, v110
    v_add_f32 v204, v204, v4
    v_add_f32 v205, v205, v5
    v_lshlrev_b32 v4, 16, v111
    v_and_b32 v5, 0xffff0000, v111
    v_add_f32 v206, v206, v4
    v_add_f32 v207, v207, v5
    v_lshlrev_b32 v4, 16, v112
    v_and_b32 v5, 0xffff0000, v112
    v_add_f32 v208, v208, v4
    v_add_f32 v209, v209, v5
    v_lshlrev_b32 v4, 16, v113
    v_and_b32 v5, 0xffff0000, v113
    v_add_f32 v210, v210, v4
    v_add_f32 v211, v211, v5
    v_lshlrev_b32 v4, 16, v114
    v_and_b32 v5, 0xffff0000, v114
    v_add_f32 v212, v212, v4
    v_add_f32 v213, v213, v5
    v_lshlrev_b32 v4, 16, v115
    v_and_b32 v5, 0xffff0000, v115
    v_add_f32 v214, v214, v4
    v_add_f32 v215, v215, v5
    v_lshlrev_b32 v4, 16, v116
    v_and_b32 v5, 0xffff0000, v116
    v_add_f32 v216, v216, v4
    v_add_f32 v217, v217, v5
    v_lshlrev_b32 v4, 16, v117
    v_and_b32 v5, 0xffff0000, v117
    v_add_f32 v218, v218, v4
    v_add_f32 v219, v219, v5
    s_waitcnt vmcnt(0)
    v_lshlrev_b32 v4, 16, v120
    v_and_b32 v5, 0xffff0000, v120
    v_add_f32 v160, v160, v4
    v_add_f32 v161, v161, v5
    v_lshlrev_b32 v4, 16, v121
    v_and_b32 v5, 0xffff0000, v121
    v_add_f32 v162, v162, v4
    v_add_f32 v163, v163, v5
    v_lshlrev_b32 v4, 16, v122
    v_and_b32 v5, 0xffff0000, v122
    v_add_f32 v164, v164, v4
    v_add_f32 v165, v165, v5
    v_lshlrev_b32 v4, 16, v123
    v_and_b32 v5, 0xffff0000, v123
    v_add_f32 v166, v166, v4
    v_add_f32 v167, v167, v5
    v_lshlrev_b32 v4, 16, v124
    v_and_b32 v5, 0xffff0000, v124
    v_add_f32 v168, v168, v4
    v_add_f32 v169, v169, v5
    v_lshlrev_b32 v4, 16, v125
    v_and_b32 v5, 0xffff0000, v125
    v_add_f32 v170, v170, v4
    v_add_f32 v171, v171, v5
    v_lshlrev_b32 v4, 16, v126
    v_and_b32 v5, 0xffff0000, v126
    v_add_f32 v172, v172, v4
    v_add_f32 v173, v173, v5
    v_lshlrev_b32 v4, 16, v127
    v_and_b32 v5, 0xffff0000, v127
    v_add_f32 v174, v174, v4
    v_add_f32 v175, v175, v5
    v_lshlrev_b32 v4, 16, v128
    v_and_b32 v5, 0xffff0000, v128
    v_add_f32 v176, v176, v4
    v_add_f32 v177, v177, v5
    v_lshlrev_b32 v4, 16, v129
    v_and_b32 v5, 0xffff0000, v129
    v_add_f32 v178, v178, v4
    v_add_f32 v179, v179, v5
    v_lshlrev_b32 v4, 16, v130
    v_and_b32 v5, 0xffff0000, v130
    v_add_f32 v180, v180, v4
    v_add_f32 v181, v181, v5
    v_lshlrev_b32 v4, 16, v131
    v_and_b32 v5, 0xffff0000, v131
    v_add_f32 v182, v182, v4
    v_add_f32 v183, v183, v5
    v_lshlrev_b32 v4, 16, v132
    v_and_b32 v5, 0xffff0000, v132
    v_add_f32 v184, v184, v4
    v_add_f32 v185, v185, v5
    v_lshlrev_b32 v4, 16, v133
    v_and_b32 v5, 0xffff0000, v133
    v_add_f32 v186, v186, v4
    v_add_f32 v187, v187, v5
    v_lshlrev_b32 v4, 16, v134
    v_and_b32 v5, 0xffff0000, v134
    v_add_f32 v188, v188, v4
    v_add_f32 v189, v189, v5
    v_lshlrev_b32 v4, 16, v135
    v_and_b32 v5, 0xffff0000, v135
    v_add_f32 v190, v190, v4
    v_add_f32 v191, v191, v5
    v_lshlrev_b32 v4, 16, v136
    v_and_b32 v5, 0xffff0000, v136
    v_add_f32 v192, v192, v4
    v_add_f32 v193, v193, v5
    v_lshlrev_b32 v4, 16, v137
    v_and_b32 v5, 0xffff0000, v137
    v_add_f32 v194, v194, v4
    v_add_f32 v195, v195, v5
    v_lshlrev_b32 v4, 16, v138
    v_and_b32 v5, 0xffff0000, v138
    v_add_f32 v196, v196, v4
    v_add_f32 v197, v197, v5
    v_lshlrev_b32 v4, 16, v139
    v_and_b32 v5, 0xffff0000, v139
    v_add_f32 v198, v198, v4
    v_add_f32 v199, v199, v5
    v_lshlrev_b32 v4, 16, v140
    v_and_b32 v5, 0xffff0000, v140
    v_add_f32 v200, v200, v4
    v_add_f32 v201, v201, v5
    v_lshlrev_b32 v4, 16, v141
    v_and_b32 v5, 0xffff0000, v141
    v_add_f32 v202, v202, v4
    v_add_f32 v203, v203, v5
    v_lshlrev_b32 v4, 16, v142
    v_and_b32 v5, 0xffff0000, v142
    v_add_f32 v204, v204, v4
    v_add_f32 v205, v205, v5
    v_lshlrev_b32 v4, 16, v143
    v_and_b32 v5, 0xffff0000, v143
    v_add_f32 v206, v206, v4
    v_add_f32 v207, v207, v5
    v_lshlrev_b32 v4, 16, v144
    v_and_b32 v5, 0xffff0000, v144
    v_add_f32 v208, v208, v4
    v_add_f32 v209, v209, v5
    v_lshlrev_b32 v4, 16, v145
    v_and_b32 v5, 0xffff0000, v145
    v_add_f32 v210, v210, v4
    v_add_f32 v211, v211, v5
    v_lshlrev_b32 v4, 16, v146
    v_and_b32 v5, 0xffff0000, v146
    v_add_f32 v212, v212, v4
    v_add_f32 v213, v213, v5
    v_lshlrev_b32 v4, 16, v147
    v_and_b32 v5, 0xffff0000, v147
    v_add_f32 v214, v214, v4
    v_add_f32 v215, v215, v5
    v_lshlrev_b32 v4, 16, v148
    v_and_b32 v5, 0xffff0000, v148
    v_add_f32 v216, v216, v4
    v_add_f32 v217, v217, v5
    v_lshlrev_b32 v4, 16, v149
    v_and_b32 v5, 0xffff0000, v149
    v_add_f32 v218, v218, v4
    v_add_f32 v219, v219, v5
    v_cvt_pk_bf16_f32 v56, v160, v161
    v_cvt_pk_bf16_f32 v57, v162, v163
    s_add_u32 s46, s45, 0
    buffer_store_dwordx2 v[56:57], v2, s[16:19], s46 offen
    v_cvt_pk_bf16_f32 v58, v164, v165
    v_cvt_pk_bf16_f32 v59, v166, v167
    s_add_u32 s46, s45, 32
    buffer_store_dwordx2 v[58:59], v2, s[16:19], s46 offen
    v_cvt_pk_bf16_f32 v60, v168, v169
    v_cvt_pk_bf16_f32 v61, v170, v171
    s_add_u32 s46, s45, 64
    buffer_store_dwordx2 v[60:61], v2, s[16:19], s46 offen
    v_cvt_pk_bf16_f32 v62, v172, v173
    v_cvt_pk_bf16_f32 v63, v174, v175
    s_add_u32 s46, s45, 96
    buffer_store_dwordx2 v[62:63], v2, s[16:19], s46 offen
    v_cvt_pk_bf16_f32 v64, v176, v177
    v_cvt_pk_bf16_f32 v65, v178, v179
    s_add_u32 s46, s45, 128
    buffer_store_dwordx2 v[64:65], v2, s[16:19], s46 offen
    v_cvt_pk_bf16_f32 v66, v180, v181
    v_cvt_pk_bf16_f32 v67, v182, v183
    s_add_u32 s46, s45, 36864
    buffer_store_dwordx2 v[66:67], v2, s[16:19], s46 offen
    v_cvt_pk_bf16_f32 v68, v184, v185
    v_cvt_pk_bf16_f32 v69, v186, v187
    s_add_u32 s46, s45, 36896
    buffer_store_dwordx2 v[68:69], v2, s[16:19], s46 offen
    v_cvt_pk_bf16_f32 v70, v188, v189
    v_cvt_pk_bf16_f32 v71, v190, v191
    s_add_u32 s46, s45, 36928
    buffer_store_dwordx2 v[70:71], v2, s[16:19], s46 offen
    v_cvt_pk_bf16_f32 v72, v192, v193
    v_cvt_pk_bf16_f32 v73, v194, v195
    s_add_u32 s46, s45, 36960
    buffer_store_dwordx2 v[72:73], v2, s[16:19], s46 offen
    v_cvt_pk_bf16_f32 v74, v196, v197
    v_cvt_pk_bf16_f32 v75, v198, v199
    s_add_u32 s46, s45, 36992
    buffer_store_dwordx2 v[74:75], v2, s[16:19], s46 offen
    v_cvt_pk_bf16_f32 v76, v200, v201
    v_cvt_pk_bf16_f32 v77, v202, v203
    s_add_u32 s46, s45, 73728
    buffer_store_dwordx2 v[76:77], v2, s[16:19], s46 offen
    v_cvt_pk_bf16_f32 v78, v204, v205
    v_cvt_pk_bf16_f32 v79, v206, v207
    s_add_u32 s46, s45, 73760
    buffer_store_dwordx2 v[78:79], v2, s[16:19], s46 offen
    v_cvt_pk_bf16_f32 v80, v208, v209
    v_cvt_pk_bf16_f32 v81, v210, v211
    s_add_u32 s46, s45, 73792
    buffer_store_dwordx2 v[80:81], v2, s[16:19], s46 offen
    v_cvt_pk_bf16_f32 v82, v212, v213
    v_cvt_pk_bf16_f32 v83, v214, v215
    s_add_u32 s46, s45, 73824
    buffer_store_dwordx2 v[82:83], v2, s[16:19], s46 offen
    v_cvt_pk_bf16_f32 v84, v216, v217
    v_cvt_pk_bf16_f32 v85, v218, v219
    s_add_u32 s46, s45, 73856
    buffer_store_dwordx2 v[84:85], v2, s[16:19], s46 offen
L_s2e_36:
    s_branch L_k1_fin
L_rare_8:
    s_waitcnt lgkmcnt(0)
    s_nop 9
    v_add_u32 v4, s42, v6
    v_mov_b32 v11, v4
    v_xor_b32 v4, 0, v11
    ds_read_b128 v[0:3], v4 offset:0
    s_waitcnt lgkmcnt(0)
    v_mfma_f32_16x16x32_bf16 v[88:91], v[0:3], v[112:115], v[12:15]
    s_nop 5
    v_xor_b32 v4, 64, v11
    ds_read_b128 v[0:3], v4 offset:0
    s_waitcnt lgkmcnt(0)
    v_mfma_f32_16x16x32_bf16 v[88:91], v[0:3], v[116:119], v[88:91]
    s_nop 5
    v_xor_b32 v4, 128, v11
    ds_read_b128 v[0:3], v4 offset:0
    s_waitcnt lgkmcnt(0)
    v_mfma_f32_16x16x32_bf16 v[88:91], v[0:3], v[120:123], v[88:91]
    s_nop 5
    v_xor_b32 v4, 192, v11
    ds_read_b128 v[0:3], v4 offset:0
    s_waitcnt lgkmcnt(0)
    v_mfma_f32_16x16x32_bf16 v[88:91], v[0:3], v[124:127], v[88:91]
    s_nop 5
    v_xor_b32 v4, 0, v11
    ds_read_b128 v[0:3], v4 offset:4096
    s_waitcnt lgkmcnt(0)
    v_mfma_f32_16x16x32_bf16 v[92:95], v[0:3], v[112:115], v[12:15]
    s_nop 5
    v_xor_b32 v4, 64, v11
    ds_read_b128 v[0:3], v4 offset:4096
    s_waitcnt lgkmcnt(0)
    v_mfma_f32_16x16x32_bf16 v[92:95], v[0:3], v[116:119], v[92:95]
    s_nop 5
    v_xor_b32 v4, 128, v11
    ds_read_b128 v[0:3], v4 offset:4096
    s_waitcnt lgkmcnt(0)
    v_mfma_f32_16x16x32_bf16 v[92:95], v[0:3], v[120:123], v[92:95]
    s_nop 5
    v_xor_b32 v4, 192, v11
    ds_read_b128 v[0:3], v4 offset:4096
    s_waitcnt lgkmcnt(0)
    v_mfma_f32_16x16x32_bf16 v[92:95], v[0:3], v[124:127], v[92:95]
    s_nop 5
    s_nop 7
    v_max3_f32 v2, v88, v89, v90
    v_max3_f32 v2, v2, v91, v92
    v_max3_f32 v2, v2, v93, v94
    v_max_f32 v2, v2, v95
    v_mbcnt_lo_u32_b32 v0, -1, 0
    v_mbcnt_hi_u32_b32 v0, -1, v0
    v_xor_b32 v3, 16, v0
    v_lshlrev_b32 v3, 2, v3
    ds_bpermute_b32 v4, v3, v2
    s_waitcnt lgkmcnt(0)
    v_max_f32 v2, v2, v4
    v_xor_b32 v3, 32, v0
    v_lshlrev_b32 v3, 2, v3
    ds_bpermute_b32 v4, v3, v2
    s_waitcnt lgkmcnt(0)
    v_max_f32 v2, v2, v4
    v_max_f32 v2, 0, v2
    v_sub_f32 v3, 0, v2
    v_exp_f32 v3, v3
    v_sub_f32 v12, v12, v2
    v_sub_f32 v13, v13, v2
    v_sub_f32 v14, v14, v2
    v_sub_f32 v15, v15, v2
    v_sub_f32 v88, v88, v2
    v_sub_f32 v89, v89, v2
    v_sub_f32 v90, v90, v2
    v_sub_f32 v91, v91, v2
    v_sub_f32 v92, v92, v2
    v_sub_f32 v93, v93, v2
    v_sub_f32 v94, v94, v2
    v_sub_f32 v95, v95, v2
    v_exp_f32 v88, v88
    v_exp_f32 v89, v89
    v_exp_f32 v90, v90
    v_exp_f32 v91, v91
    v_exp_f32 v92, v92
    v_exp_f32 v93, v93
    v_exp_f32 v94, v94
    v_exp_f32 v95, v95
    v_mul_f32 v160, v160, v3
    v_mul_f32 v161, v161, v3
    v_mul_f32 v162, v162, v3
    v_mul_f32 v163, v163, v3
    v_mul_f32 v164, v164, v3
    v_mul_f32 v165, v165, v3
    v_mul_f32 v166, v166, v3
    v_mul_f32 v167, v167, v3
    v_mul_f32 v168, v168, v3
    v_mul_f32 v169, v169, v3
    v_mul_f32 v170, v170, v3
    v_mul_f32 v171, v171, v3
    v_mul_f32 v172, v172, v3
    v_mul_f32 v173, v173, v3
    v_mul_f32 v174, v174, v3
    v_mul_f32 v175, v175, v3
    v_mul_f32 v176, v176, v3
    v_mul_f32 v177, v177, v3
    v_mul_f32 v178, v178, v3
    v_mul_f32 v179, v179, v3
    v_mul_f32 v180, v180, v3
    v_mul_f32 v181, v181, v3
    v_mul_f32 v182, v182, v3
    v_mul_f32 v183, v183, v3
    v_mul_f32 v184, v184, v3
    v_mul_f32 v185, v185, v3
    v_mul_f32 v186, v186, v3
    v_mul_f32 v187, v187, v3
    v_mul_f32 v188, v188, v3
    v_mul_f32 v189, v189, v3
    v_mul_f32 v190, v190, v3
    v_mul_f32 v191, v191, v3
    v_mul_f32 v8, v8, v3
    v_add_f32 v0, v88, v89
    v_add_f32 v1, v90, v91
    v_add_f32 v2, v92, v93
    v_add_f32 v3, v94, v95
    v_add_f32 v0, v0, v1
    v_add_f32 v2, v2, v3
    v_add_f32 v11, v0, v2
    v_cvt_pk_bf16_f32 v88, v88, v89
    v_cvt_pk_bf16_f32 v89, v90, v91
    v_cvt_pk_bf16_f32 v90, v92, v93
    v_cvt_pk_bf16_f32 v91, v94, v95
    s_nop 3
    s_branch L_rret_9
L_rare_14:
    s_waitcnt lgkmcnt(0)
    s_nop 9
    v_add_u32 v4, s42, v6
    v_mov_b32 v11, v4
    v_xor_b32 v4, 0, v11
    ds_read_b128 v[0:3], v4 offset:0
    s_waitcnt lgkmcnt(0)
    v_mfma_f32_16x16x32_bf16 v[88:91], v[0:3], v[112:115], v[12:15]
    s_nop 5
    v_xor_b32 v4, 64, v11
    ds_read_b128 v[0:3], v4 offset:0
    s_waitcnt lgkmcnt(0)
    v_mfma_f32_16x16x32_bf16 v[88:91], v[0:3], v[116:119], v[88:91]
    s_nop 5
    v_xor_b32 v4, 128, v11
    ds_read_b128 v[0:3], v4 offset:0
    s_waitcnt lgkmcnt(0)
    v_mfma_f32_16x16x32_bf16 v[88:91], v[0:3], v[120:123], v[88:91]
    s_nop 5
    v_xor_b32 v4, 192, v11
    ds_read_b128 v[0:3], v4 offset:0
    s_waitcnt lgkmcnt(0)
    v_mfma_f32_16x16x32_bf16 v[88:91], v[0:3], v[124:127], v[88:91]
    s_nop 5
    v_xor_b32 v4, 0, v11
    ds_read_b128 v[0:3], v4 offset:4096
    s_waitcnt lgkmcnt(0)
    v_mfma_f32_16x16x32_bf16 v[92:95], v[0:3], v[112:115], v[12:15]
    s_nop 5
    v_xor_b32 v4, 64, v11
    ds_read_b128 v[0:3], v4 offset:4096
    s_waitcnt lgkmcnt(0)
    v_mfma_f32_16x16x32_bf16 v[92:95], v[0:3], v[116:119], v[92:95]
    s_nop 5
    v_xor_b32 v4, 128, v11
    ds_read_b128 v[0:3], v4 offset:4096
    s_waitcnt lgkmcnt(0)
    v_mfma_f32_16x16x32_bf16 v[92:95], v[0:3], v[120:123], v[92:95]
    s_nop 5
    v_xor_b32 v4, 192, v11
    ds_read_b128 v[0:3], v4 offset:4096
    s_waitcnt lgkmcnt(0)
    v_mfma_f32_16x16x32_bf16 v[92:95], v[0:3], v[124:127], v[92:95]
    s_nop 5
    s_nop 7
    v_max3_f32 v2, v88, v89, v90
    v_max3_f32 v2, v2, v91, v92
    v_max3_f32 v2, v2, v93, v94
    v_max_f32 v2, v2, v95
    v_mbcnt_lo_u32_b32 v0, -1, 0
    v_mbcnt_hi_u32_b32 v0, -1, v0
    v_xor_b32 v3, 16, v0
    v_lshlrev_b32 v3, 2, v3
    ds_bpermute_b32 v4, v3, v2
    s_waitcnt lgkmcnt(0)
    v_max_f32 v2, v2, v4
    v_xor_b32 v3, 32, v0
    v_lshlrev_b32 v3, 2, v3
    ds_bpermute_b32 v4, v3, v2
    s_waitcnt lgkmcnt(0)
    v_max_f32 v2, v2, v4
    v_max_f32 v2, 0, v2
    v_sub_f32 v3, 0, v2
    v_exp_f32 v3, v3
    v_sub_f32 v12, v12, v2
    v_sub_f32 v13, v13, v2
    v_sub_f32 v14, v14, v2
    v_sub_f32 v15, v15, v2
    v_sub_f32 v88, v88, v2
    v_sub_f32 v89, v89, v2
    v_sub_f32 v90, v90, v2
    v_sub_f32 v91, v91, v2
    v_sub_f32 v92, v92, v2
    v_sub_f32 v93, v93, v2
    v_sub_f32 v94, v94, v2
    v_sub_f32 v95, v95, v2
    v_exp_f32 v88, v88
    v_exp_f32 v89, v89
    v_exp_f32 v90, v90
    v_exp_f32 v91, v91
    v_exp_f32 v92, v92
    v_exp_f32 v93, v93
    v_exp_f32 v94, v94
    v_exp_f32 v95, v95
    v_mul_f32 v160, v160, v3
    v_mul_f32 v161, v161, v3
    v_mul_f32 v162, v162, v3
    v_mul_f32 v163, v163, v3
    v_mul_f32 v164, v164, v3
    v_mul_f32 v165, v165, v3
    v_mul_f32 v166, v166, v3
    v_mul_f32 v167, v167, v3
    v_mul_f32 v168, v168, v3
    v_mul_f32 v169, v169, v3
    v_mul_f32 v170, v170, v3
    v_mul_f32 v171, v171, v3
    v_mul_f32 v172, v172, v3
    v_mul_f32 v173, v173, v3
    v_mul_f32 v174, v174, v3
    v_mul_f32 v175, v175, v3
    v_mul_f32 v176, v176, v3
    v_mul_f32 v177, v177, v3
    v_mul_f32 v178, v178, v3
    v_mul_f32 v179, v179, v3
    v_mul_f32 v180, v180, v3
    v_mul_f32 v181, v181, v3
    v_mul_f32 v182, v182, v3
    v_mul_f32 v183, v183, v3
    v_mul_f32 v184, v184, v3
    v_mul_f32 v185, v185, v3
    v_mul_f32 v186, v186, v3
    v_mul_f32 v187, v187, v3
    v_mul_f32 v188, v188, v3
    v_mul_f32 v189, v189, v3
    v_mul_f32 v190, v190, v3
    v_mul_f32 v191, v191, v3
    v_mul_f32 v8, v8, v3
    v_add_f32 v0, v88, v89
    v_add_f32 v1, v90, v91
    v_add_f32 v2, v92, v93
    v_add_f32 v3, v94, v95
    v_add_f32 v0, v0, v1
    v_add_f32 v2, v2, v3
    v_add_f32 v11, v0, v2
    v_cvt_pk_bf16_f32 v88, v88, v89
    v_cvt_pk_bf16_f32 v89, v90, v91
    v_cvt_pk_bf16_f32 v90, v92, v93
    v_cvt_pk_bf16_f32 v91, v94, v95
    s_nop 3
    s_branch L_rret_15
L_rare_10:
    s_waitcnt lgkmcnt(0)
    s_nop 9
    v_add_u32 v4, s42, v6
    v_mov_b32 v11, v4
    v_xor_b32 v4, 0, v11
    ds_read_b128 v[0:3], v4 offset:0
    s_waitcnt lgkmcnt(0)
    v_mfma_f32_16x16x32_bf16 v[96:99], v[0:3], v[128:131], v[16:19]
    s_nop 5
    v_xor_b32 v4, 64, v11
    ds_read_b128 v[0:3], v4 offset:0
    s_waitcnt lgkmcnt(0)
    v_mfma_f32_16x16x32_bf16 v[96:99], v[0:3], v[132:135], v[96:99]
    s_nop 5
    v_xor_b32 v4, 128, v11
    ds_read_b128 v[0:3], v4 offset:0
    s_waitcnt lgkmcnt(0)
    v_mfma_f32_16x16x32_bf16 v[96:99], v[0:3], v[136:139], v[96:99]
    s_nop 5
    v_xor_b32 v4, 192, v11
    ds_read_b128 v[0:3], v4 offset:0
    s_waitcnt lgkmcnt(0)
    v_mfma_f32_16x16x32_bf16 v[96:99], v[0:3], v[140:143], v[96:99]
    s_nop 5
    v_xor_b32 v4, 0, v11
    ds_read_b128 v[0:3], v4 offset:4096
    s_waitcnt lgkmcnt(0)
    v_mfma_f32_16x16x32_bf16 v[100:103], v[0:3], v[128:131], v[16:19]
    s_nop 5
    v_xor_b32 v4, 64, v11
    ds_read_b128 v[0:3], v4 offset:4096
    s_waitcnt lgkmcnt(0)
    v_mfma_f32_16x16x32_bf16 v[100:103], v[0:3], v[132:135], v[100:103]
    s_nop 5
    v_xor_b32 v4, 128, v11
    ds_read_b128 v[0:3], v4 offset:4096
    s_waitcnt lgkmcnt(0)
    v_mfma_f32_16x16x32_bf16 v[100:103], v[0:3], v[136:139], v[100:103]
    s_nop 5
    v_xor_b32 v4, 192, v11
    ds_read_b128 v[0:3], v4 offset:4096
    s_waitcnt lgkmcnt(0)
    v_mfma_f32_16x16x32_bf16 v[100:103], v[0:3], v[140:143], v[100:103]
    s_nop 5
    s_nop 7
    v_max3_f32 v2, v96, v97, v98
    v_max3_f32 v2, v2, v99, v100
    v_max3_f32 v2, v2, v101, v102
    v_max_f32 v2, v2, v103
    v_mbcnt_lo_u32_b32 v0, -1, 0
    v_mbcnt_hi_u32_b32 v0, -1, v0
    v_xor_b32 v3, 16, v0
    v_lshlrev_b32 v3, 2, v3
    ds_bpermute_b32 v4, v3, v2
    s_waitcnt lgkmcnt(0)
    v_max_f32 v2, v2, v4
    v_xor_b32 v3, 32, v0
    v_lshlrev_b32 v3, 2, v3
    ds_bpermute_b32 v4, v3, v2
    s_waitcnt lgkmcnt(0)
    v_max_f32 v2, v2, v4
    v_max_f32 v2, 0, v2
    v_sub_f32 v3, 0, v2
    v_exp_f32 v3, v3
    v_sub_f32 v16, v16, v2
    v_sub_f32 v17, v17, v2
    v_sub_f32 v18, v18, v2
    v_sub_f32 v19, v19, v2
    v_sub_f32 v96, v96, v2
    v_sub_f32 v97, v97, v2
    v_sub_f32 v98, v98, v2
    v_sub_f32 v99, v99, v2
    v_sub_f32 v100, v100, v2
    v_sub_f32 v101, v101, v2
    v_sub_f32 v102, v102, v2
    v_sub_f32 v103, v103, v2
    v_exp_f32 v96, v96
    v_exp_f32 v97, v97
    v_exp_f32 v98, v98
    v_exp_f32 v99, v99
    v_exp_f32 v100, v100
    v_exp_f32 v101, v101
    v_exp_f32 v102, v102
    v_exp_f32 v103, v103
    v_mul_f32 v192, v192, v3
    v_mul_f32 v193, v193, v3
    v_mul_f32 v194, v194, v3
    v_mul_f32 v195, v195, v3
    v_mul_f32 v196, v196, v3
    v_mul_f32 v197, v197, v3
    v_mul_f32 v198, v198, v3
    v_mul_f32 v199, v199, v3
    v_mul_f32 v200, v200, v3
    v_mul_f32 v201, v201, v3
    v_mul_f32 v202, v202, v3
    v_mul_f32 v203, v203, v3
    v_mul_f32 v204, v204, v3
    v_mul_f32 v205, v205, v3
    v_mul_f32 v206, v206, v3
    v_mul_f32 v207, v207, v3
    v_mul_f32 v208, v208, v3
    v_mul_f32 v209, v209, v3
    v_mul_f32 v210, v210, v3
    v_mul_f32 v211, v211, v3
    v_mul_f32 v212, v212, v3
    v_mul_f32 v213, v213, v3
    v_mul_f32 v214, v214, v3
    v_mul_f32 v215, v215, v3
    v_mul_f32 v216, v216, v3
    v_mul_f32 v217, v217, v3
    v_mul_f32 v218, v218, v3
    v_mul_f32 v219, v219, v3
    v_mul_f32 v220, v220, v3
    v_mul_f32 v221, v221, v3
    v_mul_f32 v222, v222, v3
    v_mul_f32 v223, v223, v3
    v_mul_f32 v9, v9, v3
    v_add_f32 v0, v96, v97
    v_add_f32 v1, v98, v99
    v_add_f32 v2, v100, v101
    v_add_f32 v3, v102, v103
    v_add_f32 v0, v0, v1
    v_add_f32 v2, v2, v3
    v_add_f32 v11, v0, v2
    v_cvt_pk_bf16_f32 v96, v96, v97
    v_cvt_pk_bf16_f32 v97, v98, v99
    v_cvt_pk_bf16_f32 v98, v100, v101
    v_cvt_pk_bf16_f32 v99, v102, v103
    s_nop 3
    s_branch L_rret_11
L_rare_16:
    s_waitcnt lgkmcnt(0)
    s_nop 9
    v_add_u32 v4, s42, v6
    v_mov_b32 v11, v4
    v_xor_b32 v4, 0, v11
    ds_read_b128 v[0:3], v4 offset:0
    s_waitcnt lgkmcnt(0)
    v_mfma_f32_16x16x32_bf16 v[96:99], v[0:3], v[128:131], v[16:19]
    s_nop 5
    v_xor_b32 v4, 64, v11
    ds_read_b128 v[0:3], v4 offset:0
    s_waitcnt lgkmcnt(0)
    v_mfma_f32_16x16x32_bf16 v[96:99], v[0:3], v[132:135], v[96:99]
    s_nop 5
    v_xor_b32 v4, 128, v11
    ds_read_b128 v[0:3], v4 offset:0
    s_waitcnt lgkmcnt(0)
    v_mfma_f32_16x16x32_bf16 v[96:99], v[0:3], v[136:139], v[96:99]
    s_nop 5
    v_xor_b32 v4, 192, v11
    ds_read_b128 v[0:3], v4 offset:0
    s_waitcnt lgkmcnt(0)
    v_mfma_f32_16x16x32_bf16 v[96:99], v[0:3], v[140:143], v[96:99]
    s_nop 5
    v_xor_b32 v4, 0, v11
    ds_read_b128 v[0:3], v4 offset:4096
    s_waitcnt lgkmcnt(0)
    v_mfma_f32_16x16x32_bf16 v[100:103], v[0:3], v[128:131], v[16:19]
    s_nop 5
    v_xor_b32 v4, 64, v11
    ds_read_b128 v[0:3], v4 offset:4096
    s_waitcnt lgkmcnt(0)
    v_mfma_f32_16x16x32_bf16 v[100:103], v[0:3], v[132:135], v[100:103]
    s_nop 5
    v_xor_b32 v4, 128, v11
    ds_read_b128 v[0:3], v4 offset:4096
    s_waitcnt lgkmcnt(0)
    v_mfma_f32_16x16x32_bf16 v[100:103], v[0:3], v[136:139], v[100:103]
    s_nop 5
    v_xor_b32 v4, 192, v11
    ds_read_b128 v[0:3], v4 offset:4096
    s_waitcnt lgkmcnt(0)
    v_mfma_f32_16x16x32_bf16 v[100:103], v[0:3], v[140:143], v[100:103]
    s_nop 5
    s_nop 7
    v_max3_f32 v2, v96, v97, v98
    v_max3_f32 v2, v2, v99, v100
    v_max3_f32 v2, v2, v101, v102
    v_max_f32 v2, v2, v103
    v_mbcnt_lo_u32_b32 v0, -1, 0
    v_mbcnt_hi_u32_b32 v0, -1, v0
    v_xor_b32 v3, 16, v0
    v_lshlrev_b32 v3, 2, v3
    ds_bpermute_b32 v4, v3, v2
    s_waitcnt lgkmcnt(0)
    v_max_f32 v2, v2, v4
    v_xor_b32 v3, 32, v0
    v_lshlrev_b32 v3, 2, v3
    ds_bpermute_b32 v4, v3, v2
    s_waitcnt lgkmcnt(0)
    v_max_f32 v2, v2, v4
    v_max_f32 v2, 0, v2
    v_sub_f32 v3, 0, v2
    v_exp_f32 v3, v3
    v_sub_f32 v16, v16, v2
    v_sub_f32 v17, v17, v2
    v_sub_f32 v18, v18, v2
    v_sub_f32 v19, v19, v2
    v_sub_f32 v96, v96, v2
    v_sub_f32 v97, v97, v2
    v_sub_f32 v98, v98, v2
    v_sub_f32 v99, v99, v2
    v_sub_f32 v100, v100, v2
    v_sub_f32 v101, v101, v2
    v_sub_f32 v102, v102, v2
    v_sub_f32 v103, v103, v2
    v_exp_f32 v96, v96
    v_exp_f32 v97, v97
    v_exp_f32 v98, v98
    v_exp_f32 v99, v99
    v_exp_f32 v100, v100
    v_exp_f32 v101, v101
    v_exp_f32 v102, v102
    v_exp_f32 v103, v103
    v_mul_f32 v192, v192, v3
    v_mul_f32 v193, v193, v3
    v_mul_f32 v194, v194, v3
    v_mul_f32 v195, v195, v3
    v_mul_f32 v196, v196, v3
    v_mul_f32 v197, v197, v3
    v_mul_f32 v198, v198, v3
    v_mul_f32 v199, v199, v3
    v_mul_f32 v200, v200, v3
    v_mul_f32 v201, v201, v3
    v_mul_f32 v202, v202, v3
    v_mul_f32 v203, v203, v3
    v_mul_f32 v204, v204, v3
    v_mul_f32 v205, v205, v3
    v_mul_f32 v206, v206, v3
    v_mul_f32 v207, v207, v3
    v_mul_f32 v208, v208, v3
    v_mul_f32 v209, v209, v3
    v_mul_f32 v210, v210, v3
    v_mul_f32 v211, v211, v3
    v_mul_f32 v212, v212, v3
    v_mul_f32 v213, v213, v3
    v_mul_f32 v214, v214, v3
    v_mul_f32 v215, v215, v3
    v_mul_f32 v216, v216, v3
    v_mul_f32 v217, v217, v3
    v_mul_f32 v218, v218, v3
    v_mul_f32 v219, v219, v3
    v_mul_f32 v220, v220, v3
    v_mul_f32 v221, v221, v3
    v_mul_f32 v222, v222, v3
    v_mul_f32 v223, v223, v3
    v_mul_f32 v9, v9, v3
    v_add_f32 v0, v96, v97
    v_add_f32 v1, v98, v99
    v_add_f32 v2, v100, v101
    v_add_f32 v3, v102, v103
    v_add_f32 v0, v0, v1
    v_add_f32 v2, v2, v3
    v_add_f32 v11, v0, v2
    v_cvt_pk_bf16_f32 v96, v96, v97
    v_cvt_pk_bf16_f32 v97, v98, v99
    v_cvt_pk_bf16_f32 v98, v100, v101
    v_cvt_pk_bf16_f32 v99, v102, v103
    s_nop 3
    s_branch L_rret_17
L_rare_12:
    s_waitcnt lgkmcnt(0)
    s_nop 9
    v_add_u32 v4, s42, v6
    v_mov_b32 v11, v4
    v_xor_b32 v4, 0, v11
    ds_read_b128 v[0:3], v4 offset:0
    s_waitcnt lgkmcnt(0)
    v_mfma_f32_16x16x32_bf16 v[104:107], v[0:3], v[144:147], v[20:23]
    s_nop 5
    v_xor_b32 v4, 64, v11
    ds_read_b128 v[0:3], v4 offset:0
    s_waitcnt lgkmcnt(0)
    v_mfma_f32_16x16x32_bf16 v[104:107], v[0:3], v[148:151], v[104:107]
    s_nop 5
    v_xor_b32 v4, 128, v11
    ds_read_b128 v[0:3], v4 offset:0
    s_waitcnt lgkmcnt(0)
    v_mfma_f32_16x16x32_bf16 v[104:107], v[0:3], v[152:155], v[104:107]
    s_nop 5
    v_xor_b32 v4, 192, v11
    ds_read_b128 v[0:3], v4 offset:0
    s_waitcnt lgkmcnt(0)
    v_mfma_f32_16x16x32_bf16 v[104:107], v[0:3], v[156:159], v[104:107]
    s_nop 5
    v_xor_b32 v4, 0, v11
    ds_read_b128 v[0:3], v4 offset:4096
    s_waitcnt lgkmcnt(0)
    v_mfma_f32_16x16x32_bf16 v[108:111], v[0:3], v[144:147], v[20:23]
    s_nop 5
    v_xor_b32 v4, 64, v11
    ds_read_b128 v[0:3], v4 offset:4096
    s_waitcnt lgkmcnt(0)
    v_mfma_f32_16x16x32_bf16 v[108:111], v[0:3], v[148:151], v[108:111]
    s_nop 5
    v_xor_b32 v4, 128, v11
    ds_read_b128 v[0:3], v4 offset:4096
    s_waitcnt lgkmcnt(0)
    v_mfma_f32_16x16x32_bf16 v[108:111], v[0:3], v[152:155], v[108:111]
    s_nop 5
    v_xor_b32 v4, 192, v11
    ds_read_b128 v[0:3], v4 offset:4096
    s_waitcnt lgkmcnt(0)
    v_mfma_f32_16x16x32_bf16 v[108:111], v[0:3], v[156:159], v[108:111]
    s_nop 5
    s_nop 7
    v_max3_f32 v2, v104, v105, v106
    v_max3_f32 v2, v2, v107, v108
    v_max3_f32 v2, v2, v109, v110
    v_max_f32 v2, v2, v111
    v_mbcnt_lo_u32_b32 v0, -1, 0
    v_mbcnt_hi_u32_b32 v0, -1, v0
    v_xor_b32 v3, 16, v0
    v_lshlrev_b32 v3, 2, v3
    ds_bpermute_b32 v4, v3, v2
    s_waitcnt lgkmcnt(0)
    v_max_f32 v2, v2, v4
    v_xor_b32 v3, 32, v0
    v_lshlrev_b32 v3, 2, v3
    ds_bpermute_b32 v4, v3, v2
    s_waitcnt lgkmcnt(0)
    v_max_f32 v2, v2, v4
    v_max_f32 v2, 0, v2
    v_sub_f32 v3, 0, v2
    v_exp_f32 v3, v3
    v_sub_f32 v20, v20, v2
    v_sub_f32 v21, v21, v2
    v_sub_f32 v22, v22, v2
    v_sub_f32 v23, v23, v2
    v_sub_f32 v104, v104, v2
    v_sub_f32 v105, v105, v2
    v_sub_f32 v106, v106, v2
    v_sub_f32 v107, v107, v2
    v_sub_f32 v108, v108, v2
    v_sub_f32 v109, v109, v2
    v_sub_f32 v110, v110, v2
    v_sub_f32 v111, v111, v2
    v_exp_f32 v104, v104
    v_exp_f32 v105, v105
    v_exp_f32 v106, v106
    v_exp_f32 v107, v107
    v_exp_f32 v108, v108
    v_exp_f32 v109, v109
    v_exp_f32 v110, v110
    v_exp_f32 v111, v111
    v_mul_f32 v224, v224, v3
    v_mul_f32 v225, v225, v3
    v_mul_f32 v226, v226, v3
    v_mul_f32 v227, v227, v3
    v_mul_f32 v228, v228, v3
    v_mul_f32 v229, v229, v3
    v_mul_f32 v230, v230, v3
    v_mul_f32 v231, v231, v3
    v_mul_f32 v232, v232, v3
    v_mul_f32 v233, v233, v3
    v_mul_f32 v234, v234, v3
    v_mul_f32 v235, v235, v3
    v_mul_f32 v236, v236, v3
    v_mul_f32 v237, v237, v3
    v_mul_f32 v238, v238, v3
    v_mul_f32 v239, v239, v3
    v_mul_f32 v240, v240, v3
    v_mul_f32 v241, v241, v3
    v_mul_f32 v242, v242, v3
    v_mul_f32 v243, v243, v3
    v_mul_f32 v244, v244, v3
    v_mul_f32 v245, v245, v3
    v_mul_f32 v246, v246, v3
    v_mul_f32 v247, v247, v3
    v_mul_f32 v248, v248, v3
    v_mul_f32 v249, v249, v3
    v_mul_f32 v250, v250, v3
    v_mul_f32 v251, v251, v3
    v_mul_f32 v252, v252, v3
    v_mul_f32 v253, v253, v3
    v_mul_f32 v254, v254, v3
    v_mul_f32 v255, v255, v3
    v_mul_f32 v10, v10, v3
    v_add_f32 v0, v104, v105
    v_add_f32 v1, v106, v107
    v_add_f32 v2, v108, v109
    v_add_f32 v3, v110, v111
    v_add_f32 v0, v0, v1
    v_add_f32 v2, v2, v3
    v_add_f32 v11, v0, v2
    v_cvt_pk_bf16_f32 v104, v104, v105
    v_cvt_pk_bf16_f32 v105, v106, v107
    v_cvt_pk_bf16_f32 v106, v108, v109
    v_cvt_pk_bf16_f32 v107, v110, v111
    s_nop 3
    s_branch L_rret_13
L_rare_18:
    s_waitcnt lgkmcnt(0)
    s_nop 9
    v_add_u32 v4, s42, v6
    v_mov_b32 v11, v4
    v_xor_b32 v4, 0, v11
    ds_read_b128 v[0:3], v4 offset:0
    s_waitcnt lgkmcnt(0)
    v_mfma_f32_16x16x32_bf16 v[104:107], v[0:3], v[144:147], v[20:23]
    s_nop 5
    v_xor_b32 v4, 64, v11
    ds_read_b128 v[0:3], v4 offset:0
    s_waitcnt lgkmcnt(0)
    v_mfma_f32_16x16x32_bf16 v[104:107], v[0:3], v[148:151], v[104:107]
    s_nop 5
    v_xor_b32 v4, 128, v11
    ds_read_b128 v[0:3], v4 offset:0
    s_waitcnt lgkmcnt(0)
    v_mfma_f32_16x16x32_bf16 v[104:107], v[0:3], v[152:155], v[104:107]
    s_nop 5
    v_xor_b32 v4, 192, v11
    ds_read_b128 v[0:3], v4 offset:0
    s_waitcnt lgkmcnt(0)
    v_mfma_f32_16x16x32_bf16 v[104:107], v[0:3], v[156:159], v[104:107]
    s_nop 5
    v_xor_b32 v4, 0, v11
    ds_read_b128 v[0:3], v4 offset:4096
    s_waitcnt lgkmcnt(0)
    v_mfma_f32_16x16x32_bf16 v[108:111], v[0:3], v[144:147], v[20:23]
    s_nop 5
    v_xor_b32 v4, 64, v11
    ds_read_b128 v[0:3], v4 offset:4096
    s_waitcnt lgkmcnt(0)
    v_mfma_f32_16x16x32_bf16 v[108:111], v[0:3], v[148:151], v[108:111]
    s_nop 5
    v_xor_b32 v4, 128, v11
    ds_read_b128 v[0:3], v4 offset:4096
    s_waitcnt lgkmcnt(0)
    v_mfma_f32_16x16x32_bf16 v[108:111], v[0:3], v[152:155], v[108:111]
    s_nop 5
    v_xor_b32 v4, 192, v11
    ds_read_b128 v[0:3], v4 offset:4096
    s_waitcnt lgkmcnt(0)
    v_mfma_f32_16x16x32_bf16 v[108:111], v[0:3], v[156:159], v[108:111]
    s_nop 5
    s_nop 7
    v_max3_f32 v2, v104, v105, v106
    v_max3_f32 v2, v2, v107, v108
    v_max3_f32 v2, v2, v109, v110
    v_max_f32 v2, v2, v111
    v_mbcnt_lo_u32_b32 v0, -1, 0
    v_mbcnt_hi_u32_b32 v0, -1, v0
    v_xor_b32 v3, 16, v0
    v_lshlrev_b32 v3, 2, v3
    ds_bpermute_b32 v4, v3, v2
    s_waitcnt lgkmcnt(0)
    v_max_f32 v2, v2, v4
    v_xor_b32 v3, 32, v0
    v_lshlrev_b32 v3, 2, v3
    ds_bpermute_b32 v4, v3, v2
    s_waitcnt lgkmcnt(0)
    v_max_f32 v2, v2, v4
    v_max_f32 v2, 0, v2
    v_sub_f32 v3, 0, v2
    v_exp_f32 v3, v3
    v_sub_f32 v20, v20, v2
    v_sub_f32 v21, v21, v2
    v_sub_f32 v22, v22, v2
    v_sub_f32 v23, v23, v2
    v_sub_f32 v104, v104, v2
    v_sub_f32 v105, v105, v2
    v_sub_f32 v106, v106, v2
    v_sub_f32 v107, v107, v2
    v_sub_f32 v108, v108, v2
    v_sub_f32 v109, v109, v2
    v_sub_f32 v110, v110, v2
    v_sub_f32 v111, v111, v2
    v_exp_f32 v104, v104
    v_exp_f32 v105, v105
    v_exp_f32 v106, v106
    v_exp_f32 v107, v107
    v_exp_f32 v108, v108
    v_exp_f32 v109, v109
    v_exp_f32 v110, v110
    v_exp_f32 v111, v111
    v_mul_f32 v224, v224, v3
    v_mul_f32 v225, v225, v3
    v_mul_f32 v226, v226, v3
    v_mul_f32 v227, v227, v3
    v_mul_f32 v228, v228, v3
    v_mul_f32 v229, v229, v3
    v_mul_f32 v230, v230, v3
    v_mul_f32 v231, v231, v3
    v_mul_f32 v232, v232, v3
    v_mul_f32 v233, v233, v3
    v_mul_f32 v234, v234, v3
    v_mul_f32 v235, v235, v3
    v_mul_f32 v236, v236, v3
    v_mul_f32 v237, v237, v3
    v_mul_f32 v238, v238, v3
    v_mul_f32 v239, v239, v3
    v_mul_f32 v240, v240, v3
    v_mul_f32 v241, v241, v3
    v_mul_f32 v242, v242, v3
    v_mul_f32 v243, v243, v3
    v_mul_f32 v244, v244, v3
    v_mul_f32 v245, v245, v3
    v_mul_f32 v246, v246, v3
    v_mul_f32 v247, v247, v3
    v_mul_f32 v248, v248, v3
    v_mul_f32 v249, v249, v3
    v_mul_f32 v250, v250, v3
    v_mul_f32 v251, v251, v3
    v_mul_f32 v252, v252, v3
    v_mul_f32 v253, v253, v3
    v_mul_f32 v254, v254, v3
    v_mul_f32 v255, v255, v3
    v_mul_f32 v10, v10, v3
    v_add_f32 v0, v104, v105
    v_add_f32 v1, v106, v107
    v_add_f32 v2, v108, v109
    v_add_f32 v3, v110, v111
    v_add_f32 v0, v0, v1
    v_add_f32 v2, v2, v3
    v_add_f32 v11, v0, v2
    v_cvt_pk_bf16_f32 v104, v104, v105
    v_cvt_pk_bf16_f32 v105, v106, v107
    v_cvt_pk_bf16_f32 v106, v108, v109
    v_cvt_pk_bf16_f32 v107, v110, v111
    s_nop 3
    s_branch L_rret_19
L_gw_2:
    v_lshrrev_b32 v2, 4, v1
    v_and_b32 v6, 1, v2
    v_lshrrev_b32 v7, 1, v2
    v_lshlrev_b32 v7, 2, v7
    v_or_b32 v6, v6, v7
    s_and_b32 s45, s40, 1
    s_lshl_b32 s45, s45, 3
    v_or_b32 v6, s45, v6
    v_and_b32 v7, 15, v1
    v_xor_b32 v6, v6, v7
    v_lshlrev_b32 v6, 4, v6
    v_lshlrev_b32 v7, 13, v2
    v_add_u32 v28, v6, v7
    v_add_u32 v29, 31744, v28
    v_lshrrev_b32 v6, 3, v1
    v_mul_u32_u24 v6, 1152, v6
    v_and_b32 v7, 7, v1
    v_xor_b32 v7, v7, v2
    v_lshlrev_b32 v7, 4, v7
    s_and_b32 s45, s40, 1
    s_lshl_b32 s45, s45, 6
    v_xor_b32 v7, s45, v7
    v_xor_b32 v5, 64, v7
    v_add_u32 v32, v6, v7
    v_add_u32 v33, v6, v5
    v_add_u32 v33, 8192, v33
    v_add_u32 v34, v6, v7
    v_add_u32 v34, 16384, v34
    v_add_u32 v35, v6, v5
    v_add_u32 v35, 24576, v35
    v_add_u32 v36, v6, v7
    v_add_u32 v36, 36864, v36
    s_lshl_b32 s63, s40, 16
    s_lshl_b32 s45, s36, 8
    s_add_u32 s63, s63, s45
    s_lshl_b32 s69, s40, 11
    s_add_u32 s69, s69, 122880
    s_mul_i32 s72, s40, 46080
    s_mul_i32 s73, s40, 5120
    s_add_u32 s73, s73, 81920
    s_lshl_b32 s45, s38, 1
    s_add_u32 s45, s45, s35
    s_sub_u32 s46, s45, 9
    s_cmp_ge_u32 s45, 9
    s_cselect_b32 s45, s46, s45
    s_lshl_b32 s62, s45, 19
    s_lshl_b32 s66, s45, 7
    s_mov_b32 s65, 0
    s_mov_b32 s68, 0
    s_mov_b32 s64, 0
    s_mov_b32 s67, 0
    s_add_u32 s74, s62, s63
    s_add_u32 s75, s65, s69
    s_mov_b32 m0, s75
    s_add_u32 s62, s62, 262144
    buffer_load_dwordx4 v28, s[12:15], s74 offen  lds
    s_cmp_eq_u32 s62, 4718592
    s_cselect_b32 s62, 0, s62
    s_add_u32 s64, s64, 1
    s_mov_b32 m0, s75
    s_add_u32 s65, s65, 8192
    buffer_load_dwordx4 v29, s[12:15], s74 offen offset:1024  lds
    s_and_b32 s65, s65, 0x7fff
    s_add_u32 s75, s63, 1024
    s_cmp_eq_u32 s64, 18
    s_cselect_b32 s63, s75, s63
    s_add_u32 s74, s62, s63
    s_add_u32 s75, s65, s69
    s_mov_b32 m0, s75
    s_add_u32 s62, s62, 262144
    buffer_load_dwordx4 v28, s[12:15], s74 offen  lds
    s_cmp_eq_u32 s62, 4718592
    s_cselect_b32 s62, 0, s62
    s_add_u32 s64, s64, 1
    s_mov_b32 m0, s75
    s_add_u32 s65, s65, 8192
    buffer_load_dwordx4 v29, s[12:15], s74 offen offset:1024  lds
    s_and_b32 s65, s65, 0x7fff
    s_add_u32 s75, s63, 1024
    s_cmp_eq_u32 s64, 18
    s_cselect_b32 s63, s75, s63
    v_lshrrev_b32 v2, 4, v1
    v_and_b32 v3, 15, v1
    s_and_b32 s45, s40, 1
    s_lshl_b32 s45, s45, 3
    v_add_u32 v4, s45, v2
    v_xor_b32 v4, v4, v3
    v_lshlrev_b32 v4, 4, v4
    v_lshlrev_b32 v5, 8, v2
    v_add_u32 v30, v4, v5
    v_lshlrev_b32 v4, 1, v2
    v_xor_b32 v4, v4, v3
    v_lshlrev_b32 v4, 4, v4
    v_add_u32 v31, v4, v5
    s_mov_b32 s79, 128
    v_lshrrev_b32 v2, 4, v1
    v_bfe_u32 v3, v1, 2, 2
    v_and_b32 v4, 3, v1
    v_lshlrev_b32 v5, 3, v2
    v_add_u32 v5, v5, v3
    v_and_b32 v6, 1, v3
    v_lshrrev_b32 v7, 1, v3
    v_lshlrev_b32 v7, 2, v7
    v_or_b32 v6, v6, v7
    v_and_b32 v7, 1, v2
    v_lshlrev_b32 v7, 3, v7
    v_or_b32 v6, v6, v7
    v_xor_b32 v6, v6, v4
    v_lshlrev_b32 v6, 4, v6
    v_lshlrev_b32 v5, 8, v5
    v_add_u32 v5, v5, v6
    v_and_b32 v6, 1, v4
    v_lshlrev_b32 v6, 3, v6
    v_add_u32 v5, v5, v6
    v_xor_b32 v5, s79, v5
    v_add_u32 v5, 122880, v5
    v_mov_b32 v20, v5
    v_xor_b32 v21, 8, v5
    v_xor_b32 v22, 64, v5
    v_xor_b32 v23, 72, v5
    v_and_b32 v6, 15, v1
    v_lshrrev_b32 v7, 1, v6
    v_xor_b32 v7, v7, v2
    v_lshlrev_b32 v7, 4, v7
    v_lshlrev_b32 v6, 7, v6
    v_add_u32 v6, v6, v7
    s_lshl_b32 s45, s39, 11
    s_add_u32 s45, s45, 81920
    v_add_u32 v10, s45, v6
    v_xor_b32 v11, 64, v10
    s_mov_b32 s78, 0
    s_mov_b32 s54, 20480
    v_mov_b64 v[160:161], 0
    v_mov_b64 v[162:163], 0
    v_mov_b64 v[164:165], 0
    v_mov_b64 v[166:167], 0
    v_mov_b64 v[168:169], 0
    v_mov_b64 v[170:171], 0
    v_mov_b64 v[172:173], 0
    v_mov_b64 v[174:175], 0
    v_mov_b64 v[176:177], 0
    v_mov_b64 v[178:179], 0
    v_mov_b64 v[180:181], 0
    v_mov_b64 v[182:183], 0
    v_mov_b64 v[184:185], 0
    v_mov_b64 v[186:187], 0
    v_mov_b64 v[188:189], 0
    v_mov_b64 v[190:191], 0
    v_mov_b64 v[192:193], 0
    v_mov_b64 v[194:195], 0
    v_mov_b64 v[196:197], 0
    v_mov_b64 v[198:199], 0
    v_mov_b64 v[200:201], 0
    v_mov_b64 v[202:203], 0
    v_mov_b64 v[204:205], 0
    v_mov_b64 v[206:207], 0
    s_waitcnt vmcnt(0)
    s_barrier
    s_add_u32 s74, s62, s63
    s_add_u32 s75, s65, s69
    s_mov_b32 m0, s75
    s_add_u32 s62, s62, 262144
    buffer_load_dwordx4 v28, s[12:15], s74 offen  lds
    s_cmp_eq_u32 s62, 4718592
    s_cselect_b32 s62, 0, s62
    s_add_u32 s64, s64, 1
    s_mov_b32 m0, s75
    s_add_u32 s65, s65, 8192
    buffer_load_dwordx4 v29, s[12:15], s74 offen offset:1024  lds
    s_and_b32 s65, s65, 0x7fff
    s_add_u32 s75, s63, 1024
    s_cmp_eq_u32 s64, 18
    s_cselect_b32 s63, s75, s63
    s_add_u32 s74, s62, s63
    s_add_u32 s75, s65, s69
    s_mov_b32 m0, s75
    s_add_u32 s62, s62, 262144
    buffer_load_dwordx4 v28, s[12:15], s74 offen  lds
    s_cmp_eq_u32 s62, 4718592
    s_cselect_b32 s62, 0, s62
    s_add_u32 s64, s64, 1
    s_mov_b32 m0, s75
    s_add_u32 s65, s65, 8192
    buffer_load_dwordx4 v29, s[12:15], s74 offen offset:1024  lds
    s_and_b32 s65, s65, 0x7fff
    s_add_u32 s75, s63, 1024
    s_cmp_eq_u32 s64, 18
    s_cselect_b32 s63, s75, s63
    ds_read_b128 v[88:91], v10 offset:0
    ds_read_b128 v[92:95], v10 offset:2048
    ds_read_b128 v[96:99], v10 offset:4096
    ds_read_b64_tr_b16 v[56:57], v20
    ds_read_b64_tr_b16 v[58:59], v20 offset:1024
    ds_read_b64_tr_b16 v[60:61], v21
    ds_read_b64_tr_b16 v[62:63], v21 offset:1024
    ds_read_b64_tr_b16 v[64:65], v22
    ds_read_b64_tr_b16 v[66:67], v22 offset:1024
    ds_read_b64_tr_b16 v[68:69], v23
    ds_read_b64_tr_b16 v[70:71], v23 offset:1024
    s_add_u32 s78, s78, 8192
    s_mov_b32 s55, 8192
    s_cmp_eq_u32 s78, 32768
    s_cselect_b32 s78, 0, s78
    s_cselect_b32 s55, 4294942720, s55
    v_add_u32 v20, s55, v20
    v_add_u32 v21, s55, v21
    v_add_u32 v22, s55, v22
    v_add_u32 v23, s55, v23
    s_waitcnt lgkmcnt(0)
    s_mov_b32 s41, 0
L_q0_40:
    s_barrier
    v_mfma_f32_16x16x32_bf16 v[160:163], v[56:59], v[88:91], v[160:163]
    ds_read_b128 v[100:103], v11 offset:0
    v_mfma_f32_16x16x32_bf16 v[176:179], v[56:59], v[92:95], v[176:179]
    ds_read_b128 v[104:107], v11 offset:2048
    v_mfma_f32_16x16x32_bf16 v[192:195], v[56:59], v[96:99], v[192:195]
    ds_read_b128 v[108:111], v11 offset:4096
    v_mfma_f32_16x16x32_bf16 v[164:167], v[60:63], v[88:91], v[164:167]
    ds_read_b64_tr_b16 v[72:73], v20
    ds_read_b64_tr_b16 v[74:75], v20 offset:1024
    s_add_u32 s74, s62, s63
    s_add_u32 s75, s65, s69
    s_mov_b32 m0, s75
    s_add_u32 s62, s62, 262144
    buffer_load_dwordx4 v28, s[12:15], s74 offen  lds
    s_cmp_eq_u32 s62, 4718592
    s_cselect_b32 s62, 0, s62
    s_add_u32 s64, s64, 1
    v_mfma_f32_16x16x32_bf16 v[180:183], v[60:63], v[92:95], v[180:183]
    ds_read_b64_tr_b16 v[76:77], v21
    ds_read_b64_tr_b16 v[78:79], v21 offset:1024
    v_mfma_f32_16x16x32_bf16 v[196:199], v[60:63], v[96:99], v[196:199]
    ds_read_b64_tr_b16 v[80:81], v22
    ds_read_b64_tr_b16 v[82:83], v22 offset:1024
    v_mfma_f32_16x16x32_bf16 v[168:171], v[64:67], v[88:91], v[168:171]
    v_mfma_f32_16x16x32_bf16 v[184:187], v[64:67], v[92:95], v[184:187]
    ds_read_b64_tr_b16 v[84:85], v23
    ds_read_b64_tr_b16 v[86:87], v23 offset:1024
    v_mfma_f32_16x16x32_bf16 v[200:203], v[64:67], v[96:99], v[200:203]
    v_mfma_f32_16x16x32_bf16 v[172:175], v[68:71], v[88:91], v[172:175]
    s_add_u32 s78, s78, 8192
    s_mov_b32 s55, 8192
    s_cmp_eq_u32 s78, 32768
    s_cselect_b32 s78, 0, s78
    s_cselect_b32 s55, 4294942720, s55
    v_add_u32 v20, s55, v20
    v_add_u32 v21, s55, v21
    s_mov_b32 m0, s75
    s_add_u32 s65, s65, 8192
    buffer_load_dwordx4 v29, s[12:15], s74 offen offset:1024  lds
    s_and_b32 s65, s65, 0x7fff
    s_add_u32 s75, s63, 1024
    s_cmp_eq_u32 s64, 18
    s_cselect_b32 s63, s75, s63
    v_mfma_f32_16x16x32_bf16 v[188:191], v[68:71], v[92:95], v[188:191]
    v_add_u32 v22, s55, v22
    v_add_u32 v23, s55, v23
    v_mfma_f32_16x16x32_bf16 v[204:207], v[68:71], v[96:99], v[204:207]
    v_add_u32 v10, s54, v10
    v_add_u32 v11, s54, v11
    s_sub_u32 s54, 0, s54
    s_waitcnt lgkmcnt(0)
    s_waitcnt vmcnt(4)
    s_barrier
    v_mfma_f32_16x16x32_bf16 v[160:163], v[72:75], v[100:103], v[160:163]
    ds_read_b128 v[88:91], v10 offset:0
    v_mfma_f32_16x16x32_bf16 v[176:179], v[72:75], v[104:107], v[176:179]
    ds_read_b128 v[92:95], v10 offset:2048
    v_mfma_f32_16x16x32_bf16 v[192:195], v[72:75], v[108:111], v[192:195]
    ds_read_b128 v[96:99], v10 offset:4096
    v_mfma_f32_16x16x32_bf16 v[164:167], v[76:79], v[100:103], v[164:167]
    ds_read_b64_tr_b16 v[56:57], v20
    ds_read_b64_tr_b16 v[58:59], v20 offset:1024
    s_add_u32 s74, s62, s63
    s_add_u32 s75, s65, s69
    s_mov_b32 m0, s75
    s_add_u32 s62, s62, 262144
    buffer_load_dwordx4 v28, s[12:15], s74 offen  lds
    s_cmp_eq_u32 s62, 4718592
    s_cselect_b32 s62, 0, s62
    s_add_u32 s64, s64, 1
    v_mfma_f32_16x16x32_bf16 v[180:183], v[76:79], v[104:107], v[180:183]
    ds_read_b64_tr_b16 v[60:61], v21
    ds_read_b64_tr_b16 v[62:63], v21 offset:1024
    v_mfma_f32_16x16x32_bf16 v[196:199], v[76:79], v[108:111], v[196:199]
    ds_read_b64_tr_b16 v[64:65], v22
    ds_read_b64_tr_b16 v[66:67], v22 offset:1024
    v_mfma_f32_16x16x32_bf16 v[168:171], v[80:83], v[100:103], v[168:171]
    v_mfma_f32_16x16x32_bf16 v[184:187], v[80:83], v[104:107], v[184:187]
    ds_read_b64_tr_b16 v[68:69], v23
    ds_read_b64_tr_b16 v[70:71], v23 offset:1024
    v_mfma_f32_16x16x32_bf16 v[200:203], v[80:83], v[108:111], v[200:203]
    v_mfma_f32_16x16x32_bf16 v[172:175], v[84:87], v[100:103], v[172:175]
    s_add_u32 s78, s78, 8192
    s_mov_b32 s55, 8192
    s_cmp_eq_u32 s78, 32768
    s_cselect_b32 s78, 0, s78
    s_cselect_b32 s55, 4294942720, s55
    s_mov_b32 m0, s75
    s_add_u32 s65, s65, 8192
    buffer_load_dwordx4 v29, s[12:15], s74 offen offset:1024  lds
    s_and_b32 s65, s65, 0x7fff
    s_add_u32 s75, s63, 1024
    s_cmp_eq_u32 s64, 18
    s_cselect_b32 s63, s75, s63
    v_mfma_f32_16x16x32_bf16 v[188:191], v[84:87], v[104:107], v[188:191]
    v_add_u32 v20, s55, v20
    v_add_u32 v21, s55, v21
    v_mfma_f32_16x16x32_bf16 v[204:207], v[84:87], v[108:111], v[204:207]
    v_add_u32 v22, s55, v22
    v_add_u32 v23, s55, v23
    s_waitcnt lgkmcnt(0)
    s_waitcnt vmcnt(4)
    s_add_u32 s41, s41, 1
    s_cmp_lt_u32 s41, 9
    s_cbranch_scc1 L_q0_40
    s_mov_b32 s67, 11
    s_mov_b32 s68, 20480
    s_add_u32 s66, s66, 256
    s_sub_u32 s45, s66, 1152
    s_cmp_ge_u32 s66, 1152
    s_cselect_b32 s66, s45, s66
    s_mov_b32 s80, 0x3e0293ee
    s_mov_b32 s81, 0x3e0293ee
    s_nop 3
    v_pk_mul_f32 v[160:161], v[160:161], s[80:81]
    v_pk_mul_f32 v[162:163], v[162:163], s[80:81]
    v_pk_mul_f32 v[164:165], v[164:165], s[80:81]
    v_pk_mul_f32 v[166:167], v[166:167], s[80:81]
    v_cvt_pk_bf16_f32 v2, v160, v161
    v_cvt_pk_bf16_f32 v3, v162, v163
    v_cvt_pk_bf16_f32 v4, v164, v165
    v_cvt_pk_bf16_f32 v5, v166, v167
    v_cndmask_b32 v112, v2, v4, s[52:53]
    v_cndmask_b32 v113, v3, v5, s[52:53]
    v_cndmask_b32 v114, v4, v2, s[52:53]
    v_cndmask_b32 v115, v5, v3, s[52:53]
    v_pk_mul_f32 v[168:169], v[168:169], s[80:81]
    v_pk_mul_f32 v[170:171], v[170:171], s[80:81]
    v_pk_mul_f32 v[172:173], v[172:173], s[80:81]
    v_pk_mul_f32 v[174:175], v[174:175], s[80:81]
    v_cvt_pk_bf16_f32 v2, v168, v169
    v_cvt_pk_bf16_f32 v3, v170, v171
    v_cvt_pk_bf16_f32 v4, v172, v173
    v_cvt_pk_bf16_f32 v5, v174, v175
    v_cndmask_b32 v116, v2, v4, s[52:53]
    v_cndmask_b32 v117, v3, v5, s[52:53]
    v_cndmask_b32 v118, v4, v2, s[52:53]
    v_cndmask_b32 v119, v5, v3, s[52:53]
    v_pk_mul_f32 v[176:177], v[176:177], s[80:81]
    v_pk_mul_f32 v[178:179], v[178:179], s[80:81]
    v_pk_mul_f32 v[180:181], v[180:181], s[80:81]
    v_pk_mul_f32 v[182:183], v[182:183], s[80:81]
    v_cvt_pk_bf16_f32 v2, v176, v177
    v_cvt_pk_bf16_f32 v3, v178, v179
    v_cvt_pk_bf16_f32 v4, v180, v181
    v_cvt_pk_bf16_f32 v5, v182, v183
    v_cndmask_b32 v120, v2, v4, s[52:53]
    v_cndmask_b32 v121, v3, v5, s[52:53]
    v_cndmask_b32 v122, v4, v2, s[52:53]
    v_cndmask_b32 v123, v5, v3, s[52:53]
    v_pk_mul_f32 v[184:185], v[184:185], s[80:81]
    v_pk_mul_f32 v[186:187], v[186:187], s[80:81]
    v_pk_mul_f32 v[188:189], v[188:189], s[80:81]
    v_pk_mul_f32 v[190:191], v[190:191], s[80:81]
    v_cvt_pk_bf16_f32 v2, v184, v185
    v_cvt_pk_bf16_f32 v3, v186, v187
    v_cvt_pk_bf16_f32 v4, v188, v189
    v_cvt_pk_bf16_f32 v5, v190, v191
    v_cndmask_b32 v124, v2, v4, s[52:53]
    v_cndmask_b32 v125, v3, v5, s[52:53]
    v_cndmask_b32 v126, v4, v2, s[52:53]
    v_cndmask_b32 v127, v5, v3, s[52:53]
    v_pk_mul_f32 v[192:193], v[192:193], s[80:81]
    v_pk_mul_f32 v[194:195], v[194:195], s[80:81]
    v_pk_mul_f32 v[196:197], v[196:197], s[80:81]
    v_pk_mul_f32 v[198:199], v[198:199], s[80:81]
    v_cvt_pk_bf16_f32 v2, v192, v193
    v_cvt_pk_bf16_f32 v3, v194, v195
    v_cvt_pk_bf16_f32 v4, v196, v197
    v_cvt_pk_bf16_f32 v5, v198, v199
    v_cndmask_b32 v128, v2, v4, s[52:53]
    v_cndmask_b32 v129, v3, v5, s[52:53]
    v_cndmask_b32 v130, v4, v2, s[52:53]
    v_cndmask_b32 v131, v5, v3, s[52:53]
    v_pk_mul_f32 v[200:201], v[200:201], s[80:81]
    v_pk_mul_f32 v[202:203], v[202:203], s[80:81]
    v_pk_mul_f32 v[204:205], v[204:205], s[80:81]
    v_pk_mul_f32 v[206:207], v[206:207], s[80:81]
    v_cvt_pk_bf16_f32 v2, v200, v201
    v_cvt_pk_bf16_f32 v3, v202, v203
    v_cvt_pk_bf16_f32 v4, v204, v205
    v_cvt_pk_bf16_f32 v5, v206, v207
    v_cndmask_b32 v132, v2, v4, s[52:53]
    v_cndmask_b32 v133, v3, v5, s[52:53]
    v_cndmask_b32 v134, v4, v2, s[52:53]
    v_cndmask_b32 v135, v5, v3, s[52:53]
    v_lshlrev_b32 v2, 4, v1
    s_lshl_b32 s45, s39, 11
    s_add_u32 s45, s45, 61440
    v_add_u32 v2, s45, v2
    ds_write_b128 v2, v[112:115] offset:0
    ds_write_b128 v2, v[116:119] offset:1024
    ds_write_b128 v2, v[120:123] offset:2048
    ds_write_b128 v2, v[124:127] offset:3072
    ds_write_b128 v2, v[128:131] offset:4096
    ds_write_b128 v2, v[132:135] offset:5120
    s_waitcnt lgkmcnt(0)
    s_barrier
    s_lshr_b32 s79, s40, 1
    s_mul_i32 s79, s79, 5
    s_and_b32 s32, s40, 1
    s_lshl_b32 s32, s32, 7
    v_lshrrev_b32 v2, 4, v1
    v_bfe_u32 v3, v1, 2, 2
    v_and_b32 v4, 3, v1
    v_lshlrev_b32 v5, 3, v2
    v_add_u32 v5, v5, v3
    v_and_b32 v6, 1, v3
    v_lshrrev_b32 v7, 1, v3
    v_lshlrev_b32 v7, 2, v7
    v_or_b32 v6, v6, v7
    v_and_b32 v7, 1, v2
    v_lshlrev_b32 v7, 3, v7
    v_or_b32 v6, v6, v7
    v_xor_b32 v6, v6, v4
    v_lshlrev_b32 v6, 4, v6
    v_lshlrev_b32 v5, 8, v5
    v_add_u32 v5, v5, v6
    v_and_b32 v6, 1, v4
    v_lshlrev_b32 v6, 3, v6
    v_add_u32 v5, v5, v6
    v_xor_b32 v5, s32, v5
    v_add_u32 v5, 139264, v5
    v_mov_b32 v20, v5
    v_xor_b32 v21, 8, v5
    v_xor_b32 v22, 64, v5
    v_xor_b32 v23, 72, v5
    v_and_b32 v6, 15, v1
    v_lshrrev_b32 v7, 1, v6
    v_xor_b32 v7, v7, v2
    v_lshlrev_b32 v7, 4, v7
    v_lshlrev_b32 v6, 7, v6
    v_add_u32 v6, v6, v7
    s_lshl_b32 s45, s79, 11
    s_add_u32 s45, s45, 102400
    v_add_u32 v10, s45, v6
    v_xor_b32 v11, 64, v10
    s_mov_b32 s78, 16384
    s_mov_b32 s54, 4294946816
    v_mov_b64 v[160:161], 0
    v_mov_b64 v[162:163], 0
    v_mov_b64 v[164:165], 0
    v_mov_b64 v[166:167], 0
    v_mov_b64 v[168:169], 0
    v_mov_b64 v[170:171], 0
    v_mov_b64 v[172:173], 0
    v_mov_b64 v[174:175], 0
    v_mov_b64 v[176:177], 0
    v_mov_b64 v[178:179], 0
    v_mov_b64 v[180:181], 0
    v_mov_b64 v[182:183], 0
    v_mov_b64 v[184:185], 0
    v_mov_b64 v[186:187], 0
    v_mov_b64 v[188:189], 0
    v_mov_b64 v[190:191], 0
    v_mov_b64 v[192:193], 0
    v_mov_b64 v[194:195], 0
    v_mov_b64 v[196:197], 0
    v_mov_b64 v[198:199], 0
    v_mov_b64 v[200:201], 0
    v_mov_b64 v[202:203], 0
    v_mov_b64 v[204:205], 0
    v_mov_b64 v[206:207], 0
    v_mov_b64 v[208:209], 0
    v_mov_b64 v[210:211], 0
    v_mov_b64 v[212:213], 0
    v_mov_b64 v[214:215], 0
    v_mov_b64 v[216:217], 0
    v_mov_b64 v[218:219], 0
    v_mov_b64 v[220:221], 0
    v_mov_b64 v[222:223], 0
    v_mov_b64 v[224:225], 0
    v_mov_b64 v[226:227], 0
    v_mov_b64 v[228:229], 0
    v_mov_b64 v[230:231], 0
    v_mov_b64 v[232:233], 0
    v_mov_b64 v[234:235], 0
    v_mov_b64 v[236:237], 0
    v_mov_b64 v[238:239], 0
    ds_read_b128 v[88:91], v10 offset:0
    ds_read_b128 v[92:95], v10 offset:2048
    ds_read_b128 v[96:99], v10 offset:4096
    ds_read_b128 v[100:103], v10 offset:6144
    ds_read_b128 v[104:107], v10 offset:8192
    ds_read_b64_tr_b16 v[56:57], v20
    ds_read_b64_tr_b16 v[58:59], v20 offset:1024
    ds_read_b64_tr_b16 v[60:61], v21
    ds_read_b64_tr_b16 v[62:63], v21 offset:1024
    ds_read_b64_tr_b16 v[64:65], v22
    ds_read_b64_tr_b16 v[66:67], v22 offset:1024
    ds_read_b64_tr_b16 v[68:69], v23
    ds_read_b64_tr_b16 v[70:71], v23 offset:1024
    s_add_u32 s78, s78, 8192
    s_mov_b32 s55, 8192
    s_cmp_eq_u32 s78, 32768
    s_cselect_b32 s78, 0, s78
    s_cselect_b32 s55, 4294942720, s55
    v_add_u32 v20, s55, v20
    v_add_u32 v21, s55, v21
    v_add_u32 v22, s55, v22
    v_add_u32 v23, s55, v23
    s_waitcnt lgkmcnt(0)
    s_mov_b32 s44, 24576
    s_mov_b32 s43, 49152
    s_barrier
    v_mfma_f32_16x16x32_bf16 v[160:163], v[56:59], v[88:91], v[160:163]
    ds_read_b128 v[108:111], v11 offset:0
    v_mfma_f32_16x16x32_bf16 v[176:179], v[56:59], v[92:95], v[176:179]
    ds_read_b128 v[112:115], v11 offset:2048
    s_add_u32 s74, s62, s63
    s_add_u32 s75, s65, s69
    s_mov_b32 m0, s75
    s_add_u32 s62, s62, 262144
    buffer_load_dwordx4 v28, s[12:15], s74 offen  lds
    s_cmp_eq_u32 s62, 4718592
    s_cselect_b32 s62, 0, s62
    s_add_u32 s64, s64, 1
    v_mfma_f32_16x16x32_bf16 v[192:195], v[56:59], v[96:99], v[192:195]
    v_mfma_f32_16x16x32_bf16 v[208:211], v[56:59], v[100:103], v[208:211]
    ds_read_b128 v[116:119], v11 offset:4096
    v_mfma_f32_16x16x32_bf16 v[224:227], v[56:59], v[104:107], v[224:227]
    ds_read_b128 v[120:123], v11 offset:6144
    v_mfma_f32_16x16x32_bf16 v[164:167], v[60:63], v[88:91], v[164:167]
    s_mov_b32 m0, s75
    s_add_u32 s65, s65, 8192
    buffer_load_dwordx4 v29, s[12:15], s74 offen offset:1024  lds
    s_and_b32 s65, s65, 0x7fff
    s_add_u32 s75, s63, 1024
    s_cmp_eq_u32 s64, 18
    s_cselect_b32 s63, s75, s63
    v_mfma_f32_16x16x32_bf16 v[180:183], v[60:63], v[92:95], v[180:183]
    ds_read_b128 v[124:127], v11 offset:8192
    v_mfma_f32_16x16x32_bf16 v[196:199], v[60:63], v[96:99], v[196:199]
    ds_read_b64_tr_b16 v[72:73], v20
    ds_read_b64_tr_b16 v[74:75], v20 offset:1024
    v_mfma_f32_16x16x32_bf16 v[212:215], v[60:63], v[100:103], v[212:215]
    s_add_u32 s60, s43, s57
    s_add_u32 s61, s44, s57
    s_mov_b32 m0, s60
    v_xor_b32 v37, 64, v30
    buffer_load_dwordx4 v30, s[16:19], s61 offen nt lds
    v_mfma_f32_16x16x32_bf16 v[228:231], v[60:63], v[104:107], v[228:231]
    ds_read_b64_tr_b16 v[76:77], v21
    ds_read_b64_tr_b16 v[78:79], v21 offset:1024
    v_mfma_f32_16x16x32_bf16 v[168:171], v[64:67], v[88:91], v[168:171]
    ds_read_b64_tr_b16 v[80:81], v22
    ds_read_b64_tr_b16 v[82:83], v22 offset:1024
    v_mfma_f32_16x16x32_bf16 v[184:187], v[64:67], v[92:95], v[184:187]
    s_mov_b32 m0, s60
    s_nop 0
    buffer_load_dwordx4 v37, s[16:19], s61 offen offset:1024 nt lds
    v_mfma_f32_16x16x32_bf16 v[200:203], v[64:67], v[96:99], v[200:203]
    ds_read_b64_tr_b16 v[84:85], v23
    ds_read_b64_tr_b16 v[86:87], v23 offset:1024
    v_mfma_f32_16x16x32_bf16 v[216:219], v[64:67], v[100:103], v[216:219]
    v_mfma_f32_16x16x32_bf16 v[232:235], v[64:67], v[104:107], v[232:235]
    v_mfma_f32_16x16x32_bf16 v[172:175], v[68:71], v[88:91], v[172:175]
    s_add_u32 s78, s78, 8192
    s_mov_b32 s55, 8192
    s_cmp_eq_u32 s78, 32768
    s_cselect_b32 s78, 0, s78
    s_cselect_b32 s55, 4294942720, s55
    s_add_u32 s60, s60, 8192
    s_mov_b32 m0, s60
    v_xor_b32 v38, 128, v31
    buffer_load_dwordx4 v31, s[20:23], s61 offen nt lds
    v_mfma_f32_16x16x32_bf16 v[188:191], v[68:71], v[92:95], v[188:191]
    v_add_u32 v20, s55, v20
    v_add_u32 v21, s55, v21
    v_mfma_f32_16x16x32_bf16 v[204:207], v[68:71], v[96:99], v[204:207]
    v_add_u32 v22, s55, v22
    v_add_u32 v23, s55, v23
    v_mfma_f32_16x16x32_bf16 v[220:223], v[68:71], v[100:103], v[220:223]
    v_add_u32 v10, s54, v10
    v_add_u32 v11, s54, v11
    s_sub_u32 s54, 0, s54
    s_mov_b32 m0, s60
    s_add_u32 s44, s44, 8192
    buffer_load_dwordx4 v38, s[20:23], s61 offen offset:1024 nt lds
    s_cmp_eq_u32 s44, 131072
    s_cselect_b32 s44, 524288, s44
    s_add_u32 s43, s43, 16384
    s_cmp_eq_u32 s43, 81920
    s_cselect_b32 s43, 0, s43
    v_mfma_f32_16x16x32_bf16 v[236:239], v[68:71], v[104:107], v[236:239]
    s_waitcnt lgkmcnt(0)
    s_waitcnt vmcnt(8)
    s_barrier
    s_mov_b32 s41, 0
L_ga_41:
    v_mfma_f32_16x16x32_bf16 v[160:163], v[72:75], v[108:111], v[160:163]
    ds_read_b128 v[88:91], v10 offset:0
    s_add_u32 s76, s66, s72
    s_add_u32 s77, s68, s73
    s_mov_b32 m0, s77
    s_add_u32 s66, s66, 128
    buffer_load_dwordx4 v32, s[8:11], s76 offen  lds
    s_cmp_eq_u32 s66, 1152
    s_cselect_b32 s66, 0, s66
    v_mfma_f32_16x16x32_bf16 v[176:179], v[72:75], v[112:115], v[176:179]
    ds_read_b128 v[92:95], v10 offset:2048
    v_mfma_f32_16x16x32_bf16 v[192:195], v[72:75], v[116:119], v[192:195]
    s_mov_b32 m0, s77
    s_nop 0
    buffer_load_dwordx4 v33, s[8:11], s76 offen offset:1024  lds
    v_mfma_f32_16x16x32_bf16 v[208:211], v[72:75], v[120:123], v[208:211]
    ds_read_b128 v[96:99], v10 offset:4096
    v_mfma_f32_16x16x32_bf16 v[224:227], v[72:75], v[124:127], v[224:227]
    ds_read_b128 v[100:103], v10 offset:6144
    s_mov_b32 m0, s77
    s_nop 0
    buffer_load_dwordx4 v34, s[8:11], s76 offen offset:2048  lds
    v_mfma_f32_16x16x32_bf16 v[164:167], v[76:79], v[108:111], v[164:167]
    v_mfma_f32_16x16x32_bf16 v[180:183], v[76:79], v[112:115], v[180:183]
    ds_read_b128 v[104:107], v10 offset:8192
    s_mov_b32 m0, s77
    s_nop 0
    buffer_load_dwordx4 v35, s[8:11], s76 offen offset:3072  lds
    v_mfma_f32_16x16x32_bf16 v[196:199], v[76:79], v[116:119], v[196:199]
    ds_read_b64_tr_b16 v[56:57], v20
    ds_read_b64_tr_b16 v[58:59], v20 offset:1024
    v_mfma_f32_16x16x32_bf16 v[212:215], v[76:79], v[120:123], v[212:215]
    s_add_u32 s77, s77, 4096
    s_mov_b32 m0, s77
    s_sub_u32 s68, 20480, s68
    buffer_load_dwordx4 v36, s[8:11], s76 offen  lds
    v_mfma_f32_16x16x32_bf16 v[228:231], v[76:79], v[124:127], v[228:231]
    ds_read_b64_tr_b16 v[60:61], v21
    ds_read_b64_tr_b16 v[62:63], v21 offset:1024
    v_mfma_f32_16x16x32_bf16 v[168:171], v[80:83], v[108:111], v[168:171]
    ds_read_b64_tr_b16 v[64:65], v22
    ds_read_b64_tr_b16 v[66:67], v22 offset:1024
    s_add_u32 s74, s62, s63
    s_add_u32 s75, s65, s69
    s_mov_b32 m0, s75
    s_add_u32 s62, s62, 262144
    buffer_load_dwordx4 v28, s[12:15], s74 offen  lds
    s_cmp_eq_u32 s62, 4718592
    s_cselect_b32 s62, 0, s62
    s_add_u32 s64, s64, 1
    v_mfma_f32_16x16x32_bf16 v[184:187], v[80:83], v[112:115], v[184:187]
    s_mov_b32 m0, s75
    s_add_u32 s65, s65, 8192
    buffer_load_dwordx4 v29, s[12:15], s74 offen offset:1024  lds
    s_and_b32 s65, s65, 0x7fff
    s_add_u32 s75, s63, 1024
    s_cmp_eq_u32 s64, 18
    s_cselect_b32 s63, s75, s63
    v_mfma_f32_16x16x32_bf16 v[200:203], v[80:83], v[116:119], v[200:203]
    ds_read_b64_tr_b16 v[68:69], v23
    ds_read_b64_tr_b16 v[70:71], v23 offset:1024
    v_mfma_f32_16x16x32_bf16 v[216:219], v[80:83], v[120:123], v[216:219]
    s_add_u32 s60, s43, s57
    s_add_u32 s61, s44, s57
    s_mov_b32 m0, s60
    v_xor_b32 v37, 64, v30
    buffer_load_dwordx4 v30, s[16:19], s61 offen nt lds
    v_mfma_f32_16x16x32_bf16 v[232:235], v[80:83], v[124:127], v[232:235]
    v_mfma_f32_16x16x32_bf16 v[172:175], v[84:87], v[108:111], v[172:175]
    s_add_u32 s78, s78, 8192
    s_mov_b32 s55, 8192
    s_cmp_eq_u32 s78, 32768
    s_cselect_b32 s78, 0, s78
    s_cselect_b32 s55, 4294942720, s55
    s_mov_b32 m0, s60
    s_nop 0
    buffer_load_dwordx4 v37, s[16:19], s61 offen offset:1024 nt lds
    v_mfma_f32_16x16x32_bf16 v[188:191], v[84:87], v[112:115], v[188:191]
    v_add_u32 v20, s55, v20
    v_add_u32 v21, s55, v21
    v_mfma_f32_16x16x32_bf16 v[204:207], v[84:87], v[116:119], v[204:207]
    s_add_u32 s60, s60, 8192
    s_mov_b32 m0, s60
    v_xor_b32 v38, 128, v31
    buffer_load_dwordx4 v31, s[20:23], s61 offen nt lds
    v_mfma_f32_16x16x32_bf16 v[220:223], v[84:87], v[120:123], v[220:223]
    v_add_u32 v22, s55, v22
    v_add_u32 v23, s55, v23
    v_mfma_f32_16x16x32_bf16 v[236:239], v[84:87], v[124:127], v[236:239]
    s_mov_b32 m0, s60
    s_add_u32 s44, s44, 8192
    buffer_load_dwordx4 v38, s[20:23], s61 offen offset:1024 nt lds
    s_cmp_eq_u32 s44, 131072
    s_cselect_b32 s44, 524288, s44
    s_add_u32 s43, s43, 16384
    s_cmp_eq_u32 s43, 81920
    s_cselect_b32 s43, 0, s43
    s_waitcnt lgkmcnt(0)
    s_waitcnt vmcnt(17)
    s_barrier
    v_mfma_f32_16x16x32_bf16 v[160:163], v[56:59], v[88:91], v[160:163]
    ds_read_b128 v[108:111], v11 offset:0
    v_mfma_f32_16x16x32_bf16 v[176:179], v[56:59], v[92:95], v[176:179]
    ds_read_b128 v[112:115], v11 offset:2048
    s_add_u32 s74, s62, s63
    s_add_u32 s75, s65, s69
    s_mov_b32 m0, s75
    s_add_u32 s62, s62, 262144
    buffer_load_dwordx4 v28, s[12:15], s74 offen  lds
    s_cmp_eq_u32 s62, 4718592
    s_cselect_b32 s62, 0, s62
    s_add_u32 s64, s64, 1
    v_mfma_f32_16x16x32_bf16 v[192:195], v[56:59], v[96:99], v[192:195]
    v_mfma_f32_16x16x32_bf16 v[208:211], v[56:59], v[100:103], v[208:211]
    ds_read_b128 v[116:119], v11 offset:4096
    v_mfma_f32_16x16x32_bf16 v[224:227], v[56:59], v[104:107], v[224:227]
    ds_read_b128 v[120:123], v11 offset:6144
    v_mfma_f32_16x16x32_bf16 v[164:167], v[60:63], v[88:91], v[164:167]
    s_mov_b32 m0, s75
    s_add_u32 s65, s65, 8192
    buffer_load_dwordx4 v29, s[12:15], s74 offen offset:1024  lds
    s_and_b32 s65, s65, 0x7fff
    s_add_u32 s75, s63, 1024
    s_cmp_eq_u32 s64, 18
    s_cselect_b32 s63, s75, s63
    v_mfma_f32_16x16x32_bf16 v[180:183], v[60:63], v[92:95], v[180:183]
    ds_read_b128 v[124:127], v11 offset:8192
    v_mfma_f32_16x16x32_bf16 v[196:199], v[60:63], v[96:99], v[196:199]
    ds_read_b64_tr_b16 v[72:73], v20
    ds_read_b64_tr_b16 v[74:75], v20 offset:1024
    v_mfma_f32_16x16x32_bf16 v[212:215], v[60:63], v[100:103], v[212:215]
    s_add_u32 s60, s43, s57
    s_add_u32 s61, s44, s57
    s_mov_b32 m0, s60
    v_xor_b32 v37, 64, v30
    buffer_load_dwordx4 v30, s[16:19], s61 offen nt lds
    v_mfma_f32_16x16x32_bf16 v[228:231], v[60:63], v[104:107], v[228:231]
    ds_read_b64_tr_b16 v[76:77], v21
    ds_read_b64_tr_b16 v[78:79], v21 offset:1024
    v_mfma_f32_16x16x32_bf16 v[168:171], v[64:67], v[88:91], v[168:171]
    ds_read_b64_tr_b16 v[80:81], v22
    ds_read_b64_tr_b16 v[82:83], v22 offset:1024
    v_mfma_f32_16x16x32_bf16 v[184:187], v[64:67], v[92:95], v[184:187]
    s_mov_b32 m0, s60
    s_nop 0
    buffer_load_dwordx4 v37, s[16:19], s61 offen offset:1024 nt lds
    v_mfma_f32_16x16x32_bf16 v[200:203], v[64:67], v[96:99], v[200:203]
    ds_read_b64_tr_b16 v[84:85], v23
    ds_read_b64_tr_b16 v[86:87], v23 offset:1024
    v_mfma_f32_16x16x32_bf16 v[216:219], v[64:67], v[100:103], v[216:219]
    v_mfma_f32_16x16x32_bf16 v[232:235], v[64:67], v[104:107], v[232:235]
    v_mfma_f32_16x16x32_bf16 v[172:175], v[68:71], v[88:91], v[172:175]
    s_add_u32 s78, s78, 8192
    s_mov_b32 s55, 8192
    s_cmp_eq_u32 s78, 32768
    s_cselect_b32 s78, 0, s78
    s_cselect_b32 s55, 4294942720, s55
    s_add_u32 s60, s60, 8192
    s_mov_b32 m0, s60
    v_xor_b32 v38, 128, v31
    buffer_load_dwordx4 v31, s[20:23], s61 offen nt lds
    v_mfma_f32_16x16x32_bf16 v[188:191], v[68:71], v[92:95], v[188:191]
    v_add_u32 v20, s55, v20
    v_add_u32 v21, s55, v21
    v_mfma_f32_16x16x32_bf16 v[204:207], v[68:71], v[96:99], v[204:207]
    v_add_u32 v22, s55, v22
    v_add_u32 v23, s55, v23
    v_mfma_f32_16x16x32_bf16 v[220:223], v[68:71], v[100:103], v[220:223]
    v_add_u32 v10, s54, v10
    v_add_u32 v11, s54, v11
    s_sub_u32 s54, 0, s54
    s_mov_b32 m0, s60
    s_add_u32 s44, s44, 8192
    buffer_load_dwordx4 v38, s[20:23], s61 offen offset:1024 nt lds
    s_cmp_eq_u32 s44, 131072
    s_cselect_b32 s44, 524288, s44
    s_add_u32 s43, s43, 16384
    s_cmp_eq_u32 s43, 81920
    s_cselect_b32 s43, 0, s43
    v_mfma_f32_16x16x32_bf16 v[236:239], v[68:71], v[104:107], v[236:239]
    s_cmp_lg_u32 s41, 99
    s_cbranch_scc1 L_wopf_42
    v_lshlrev_b32 v2, 7, v1
    s_lshl_b32 s45, s38, 3
    s_add_u32 s45, s45, s35
    s_mul_i32 s45, s45, 36864
    s_mul_i32 s46, s37, 1179648
    s_add_u32 s45, s45, s46
    s_mul_i32 s47, s40, 9216
    s_add_u32 s47, s47, s45
    buffer_load_dword v132, v2, s[24:27], s47 offen
    s_add_u32 s47, s47, 1024
    buffer_load_dword v132, v2, s[24:27], s47 offen
L_wopf_42:
    s_cmp_lg_u32 s33, 4
    s_cbranch_scc1 L_fc2_44
    s_cmp_lg_u32 s41, 4
    s_cbranch_scc1 L_fc_43
    s_lshl_b32 s45, s59, 2
    v_mov_b32 v130, s45
    s_lshl_b32 s45, s48, 2
    v_mov_b32 v131, s45
    global_load_dword v128, v130, s[4:5] sc1
    global_load_dword v129, v131, s[4:5] sc1
L_fc_43:
    s_cmp_lg_u32 s41, 8
    s_cbranch_scc1 L_fc2_44
    s_mov_b32 s46, 0
    s_branch L_fchk1_47
L_fchk_45:
    s_lshl_b32 s45, s59, 2
    v_mov_b32 v130, s45
    s_lshl_b32 s45, s48, 2
    v_mov_b32 v131, s45
    global_load_dword v128, v130, s[4:5] sc1
    global_load_dword v129, v131, s[4:5] sc1
    s_waitcnt vmcnt(0)
L_fchk1_47:
    v_and_b32 v128, 0xffff, v128
    v_lshrrev_b32 v129, 16, v129
    v_min_u32 v128, v128, v129
    s_nop 0
    v_readfirstlane_b32 s47, v128
    s_add_u32 s46, s46, 1
    s_cmp_ge_u32 s47, 4
    s_cbranch_scc1 L_fchkd_46
    s_cmp_ge_u32 s46, 100000
    s_cbranch_scc1 L_fchkd_46
    s_sleep 8
    s_branch L_fchk_45
L_fchkd_46:
L_fc2_44:
    s_waitcnt lgkmcnt(0)
    s_waitcnt vmcnt(12)
    s_barrier
    s_add_u32 s41, s41, 2
    s_cmp_lt_u32 s41, 12
    s_cbranch_scc1 L_ga_41
    v_mfma_f32_16x16x32_bf16 v[160:163], v[72:75], v[108:111], v[160:163]
    ds_read_b128 v[88:91], v10 offset:0
    s_add_u32 s76, s66, s72
    s_add_u32 s77, s68, s73
    s_mov_b32 m0, s77
    s_add_u32 s66, s66, 128
    buffer_load_dwordx4 v32, s[8:11], s76 offen  lds
    s_cmp_eq_u32 s66, 1152
    s_cselect_b32 s66, 0, s66
    v_mfma_f32_16x16x32_bf16 v[176:179], v[72:75], v[112:115], v[176:179]
    ds_read_b128 v[92:95], v10 offset:2048
    v_mfma_f32_16x16x32_bf16 v[192:195], v[72:75], v[116:119], v[192:195]
    s_mov_b32 m0, s77
    s_nop 0
    buffer_load_dwordx4 v33, s[8:11], s76 offen offset:1024  lds
    v_mfma_f32_16x16x32_bf16 v[208:211], v[72:75], v[120:123], v[208:211]
    ds_read_b128 v[96:99], v10 offset:4096
    v_mfma_f32_16x16x32_bf16 v[224:227], v[72:75], v[124:127], v[224:227]
    ds_read_b128 v[100:103], v10 offset:6144
    s_mov_b32 m0, s77
    s_nop 0
    buffer_load_dwordx4 v34, s[8:11], s76 offen offset:2048  lds
    v_mfma_f32_16x16x32_bf16 v[164:167], v[76:79], v[108:111], v[164:167]
    v_mfma_f32_16x16x32_bf16 v[180:183], v[76:79], v[112:115], v[180:183]
    ds_read_b128 v[104:107], v10 offset:8192
    s_mov_b32 m0, s77
    s_nop 0
    buffer_load_dwordx4 v35, s[8:11], s76 offen offset:3072  lds
    v_mfma_f32_16x16x32_bf16 v[196:199], v[76:79], v[116:119], v[196:199]
    ds_read_b64_tr_b16 v[56:57], v20
    ds_read_b64_tr_b16 v[58:59], v20 offset:1024
    v_mfma_f32_16x16x32_bf16 v[212:215], v[76:79], v[120:123], v[212:215]
    s_add_u32 s77, s77, 4096
    s_mov_b32 m0, s77
    s_sub_u32 s68, 20480, s68
    buffer_load_dwordx4 v36, s[8:11], s76 offen  lds
    v_mfma_f32_16x16x32_bf16 v[228:231], v[76:79], v[124:127], v[228:231]
    ds_read_b64_tr_b16 v[60:61], v21
    ds_read_b64_tr_b16 v[62:63], v21 offset:1024
    v_mfma_f32_16x16x32_bf16 v[168:171], v[80:83], v[108:111], v[168:171]
    ds_read_b64_tr_b16 v[64:65], v22
    ds_read_b64_tr_b16 v[66:67], v22 offset:1024
    s_add_u32 s74, s62, s63
    s_add_u32 s75, s65, s69
    s_mov_b32 m0, s75
    s_add_u32 s62, s62, 262144
    buffer_load_dwordx4 v28, s[12:15], s74 offen  lds
    s_cmp_eq_u32 s62, 4718592
    s_cselect_b32 s62, 0, s62
    s_add_u32 s64, s64, 1
    v_mfma_f32_16x16x32_bf16 v[184:187], v[80:83], v[112:115], v[184:187]
    s_mov_b32 m0, s75
    s_add_u32 s65, s65, 8192
    buffer_load_dwordx4 v29, s[12:15], s74 offen offset:1024  lds
    s_and_b32 s65, s65, 0x7fff
    s_add_u32 s75, s63, 1024
    s_cmp_eq_u32 s64, 18
    s_cselect_b32 s63, s75, s63
    v_mfma_f32_16x16x32_bf16 v[200:203], v[80:83], v[116:119], v[200:203]
    ds_read_b64_tr_b16 v[68:69], v23
    ds_read_b64_tr_b16 v[70:71], v23 offset:1024
    v_mfma_f32_16x16x32_bf16 v[216:219], v[80:83], v[120:123], v[216:219]
    s_add_u32 s60, s43, s57
    s_add_u32 s61, s44, s57
    s_mov_b32 m0, s60
    v_xor_b32 v37, 64, v30
    buffer_load_dwordx4 v30, s[16:19], s61 offen nt lds
    v_mfma_f32_16x16x32_bf16 v[232:235], v[80:83], v[124:127], v[232:235]
    v_mfma_f32_16x16x32_bf16 v[172:175], v[84:87], v[108:111], v[172:175]
    s_add_u32 s78, s78, 8192
    s_mov_b32 s55, 8192
    s_cmp_eq_u32 s78, 32768
    s_cselect_b32 s78, 0, s78
    s_cselect_b32 s55, 4294942720, s55
    s_mov_b32 m0, s60
    s_nop 0
    buffer_load_dwordx4 v37, s[16:19], s61 offen offset:1024 nt lds
    v_mfma_f32_16x16x32_bf16 v[188:191], v[84:87], v[112:115], v[188:191]
    v_add_u32 v20, s55, v20
    v_add_u32 v21, s55, v21
    v_mfma_f32_16x16x32_bf16 v[204:207], v[84:87], v[116:119], v[204:207]
    s_add_u32 s60, s60, 8192
    s_mov_b32 m0, s60
    v_xor_b32 v38, 128, v31
    buffer_load_dwordx4 v31, s[20:23], s61 offen nt lds
    v_mfma_f32_16x16x32_bf16 v[220:223], v[84:87], v[120:123], v[220:223]
    v_add_u32 v22, s55, v22
    v_add_u32 v23, s55, v23
    v_mfma_f32_16x16x32_bf16 v[236:239], v[84:87], v[124:127], v[236:239]
    s_mov_b32 m0, s60
    s_add_u32 s44, s44, 8192
    buffer_load_dwordx4 v38, s[20:23], s61 offen offset:1024 nt lds
    s_cmp_eq_u32 s44, 131072
    s_cselect_b32 s44, 524288, s44
    s_add_u32 s43, s43, 16384
    s_cmp_eq_u32 s43, 81920
    s_cselect_b32 s43, 0, s43
    s_waitcnt lgkmcnt(0)
    s_waitcnt vmcnt(17)
    s_barrier
    v_mfma_f32_16x16x32_bf16 v[160:163], v[56:59], v[88:91], v[160:163]
    ds_read_b128 v[108:111], v11 offset:0
    v_mfma_f32_16x16x32_bf16 v[176:179], v[56:59], v[92:95], v[176:179]
    ds_read_b128 v[112:115], v11 offset:2048
    v_mfma_f32_16x16x32_bf16 v[192:195], v[56:59], v[96:99], v[192:195]
    s_add_u32 s60, s43, s57
    s_add_u32 s61, s44, s57
    s_mov_b32 m0, s60
    v_xor_b32 v37, 64, v30
    buffer_load_dwordx4 v30, s[16:19], s61 offen nt lds
    v_mfma_f32_16x16x32_bf16 v[208:211], v[56:59], v[100:103], v[208:211]
    ds_read_b128 v[116:119], v11 offset:4096
    v_mfma_f32_16x16x32_bf16 v[224:227], v[56:59], v[104:107], v[224:227]
    ds_read_b128 v[120:123], v11 offset:6144
    v_mfma_f32_16x16x32_bf16 v[164:167], v[60:63], v[88:91], v[164:167]
    v_mfma_f32_16x16x32_bf16 v[180:183], v[60:63], v[92:95], v[180:183]
    ds_read_b128 v[124:127], v11 offset:8192
    v_mfma_f32_16x16x32_bf16 v[196:199], v[60:63], v[96:99], v[196:199]
    ds_read_b64_tr_b16 v[72:73], v20
    ds_read_b64_tr_b16 v[74:75], v20 offset:1024
    s_mov_b32 m0, s60
    s_nop 0
    buffer_load_dwordx4 v37, s[16:19], s61 offen offset:1024 nt lds
    v_mfma_f32_16x16x32_bf16 v[212:215], v[60:63], v[100:103], v[212:215]
    v_mfma_f32_16x16x32_bf16 v[228:231], v[60:63], v[104:107], v[228:231]
    ds_read_b64_tr_b16 v[76:77], v21
    ds_read_b64_tr_b16 v[78:79], v21 offset:1024
    v_mfma_f32_16x16x32_bf16 v[168:171], v[64:67], v[88:91], v[168:171]
    ds_read_b64_tr_b16 v[80:81], v22
    ds_read_b64_tr_b16 v[82:83], v22 offset:1024
    v_mfma_f32_16x16x32_bf16 v[184:187], v[64:67], v[92:95], v[184:187]
    v_mfma_f32_16x16x32_bf16 v[200:203], v[64:67], v[96:99], v[200:203]
    ds_read_b64_tr_b16 v[84:85], v23
    ds_read_b64_tr_b16 v[86:87], v23 offset:1024
    s_add_u32 s60, s60, 8192
    s_mov_b32 m0, s60
    v_xor_b32 v38, 128, v31
    buffer_load_dwordx4 v31, s[20:23], s61 offen nt lds
    v_mfma_f32_16x16x32_bf16 v[216:219], v[64:67], v[100:103], v[216:219]
    v_mfma_f32_16x16x32_bf16 v[232:235], v[64:67], v[104:107], v[232:235]
    v_mfma_f32_16x16x32_bf16 v[172:175], v[68:71], v[88:91], v[172:175]
    s_add_u32 s78, s78, 8192
    s_mov_b32 s55, 8192
    s_cmp_eq_u32 s78, 32768
    s_cselect_b32 s78, 0, s78
    s_cselect_b32 s55, 4294942720, s55
    v_mfma_f32_16x16x32_bf16 v[188:191], v[68:71], v[92:95], v[188:191]
    v_add_u32 v20, s55, v20
    v_add_u32 v21, s55, v21
    v_mfma_f32_16x16x32_bf16 v[204:207], v[68:71], v[96:99], v[204:207]
    v_add_u32 v22, s55, v22
    v_add_u32 v23, s55, v23
    s_mov_b32 m0, s60
    s_add_u32 s44, s44, 8192
    buffer_load_dwordx4 v38, s[20:23], s61 offen offset:1024 nt lds
    s_cmp_eq_u32 s44, 131072
    s_cselect_b32 s44, 524288, s44
    s_add_u32 s43, s43, 16384
    s_cmp_eq_u32 s43, 81920
    s_cselect_b32 s43, 0, s43
    v_mfma_f32_16x16x32_bf16 v[220:223], v[68:71], v[100:103], v[220:223]
    v_add_u32 v10, s54, v10
    v_add_u32 v11, s54, v11
    s_sub_u32 s54, 0, s54
    v_mfma_f32_16x16x32_bf16 v[236:239], v[68:71], v[104:107], v[236:239]
    s_waitcnt lgkmcnt(0)
    s_waitcnt vmcnt(10)
    s_barrier
    v_mfma_f32_16x16x32_bf16 v[160:163], v[72:75], v[108:111], v[160:163]
    ds_read_b128 v[88:91], v10 offset:0
    v_mfma_f32_16x16x32_bf16 v[176:179], v[72:75], v[112:115], v[176:179]
    ds_read_b128 v[92:95], v10 offset:2048
    v_mfma_f32_16x16x32_bf16 v[192:195], v[72:75], v[116:119], v[192:195]
    s_add_u32 s60, s43, s57
    s_add_u32 s61, s44, s57
    s_mov_b32 m0, s60
    v_xor_b32 v37, 64, v30
    buffer_load_dwordx4 v30, s[16:19], s61 offen nt lds
    v_mfma_f32_16x16x32_bf16 v[208:211], v[72:75], v[120:123], v[208:211]
    ds_read_b128 v[96:99], v10 offset:4096
    v_mfma_f32_16x16x32_bf16 v[224:227], v[72:75], v[124:127], v[224:227]
    ds_read_b128 v[100:103], v10 offset:6144
    v_mfma_f32_16x16x32_bf16 v[164:167], v[76:79], v[108:111], v[164:167]
    v_mfma_f32_16x16x32_bf16 v[180:183], v[76:79], v[112:115], v[180:183]
    ds_read_b128 v[104:107], v10 offset:8192
    v_mfma_f32_16x16x32_bf16 v[196:199], v[76:79], v[116:119], v[196:199]
    ds_read_b64_tr_b16 v[56:57], v20
    ds_read_b64_tr_b16 v[58:59], v20 offset:1024
    s_mov_b32 m0, s60
    s_nop 0
    buffer_load_dwordx4 v37, s[16:19], s61 offen offset:1024 nt lds
    v_mfma_f32_16x16x32_bf16 v[212:215], v[76:79], v[120:123], v[212:215]
    v_mfma_f32_16x16x32_bf16 v[228:231], v[76:79], v[124:127], v[228:231]
    ds_read_b64_tr_b16 v[60:61], v21
    ds_read_b64_tr_b16 v[62:63], v21 offset:1024
    v_mfma_f32_16x16x32_bf16 v[168:171], v[80:83], v[108:111], v[168:171]
    ds_read_b64_tr_b16 v[64:65], v22
    ds_read_b64_tr_b16 v[66:67], v22 offset:1024
    v_mfma_f32_16x16x32_bf16 v[184:187], v[80:83], v[112:115], v[184:187]
    v_mfma_f32_16x16x32_bf16 v[200:203], v[80:83], v[116:119], v[200:203]
    ds_read_b64_tr_b16 v[68:69], v23
    ds_read_b64_tr_b16 v[70:71], v23 offset:1024
    s_add_u32 s60, s60, 8192
    s_mov_b32 m0, s60
    v_xor_b32 v38, 128, v31
    buffer_load_dwordx4 v31, s[20:23], s61 offen nt lds
    v_mfma_f32_16x16x32_bf16 v[216:219], v[80:83], v[120:123], v[216:219]
    v_mfma_f32_16x16x32_bf16 v[232:235], v[80:83], v[124:127], v[232:235]
    v_mfma_f32_16x16x32_bf16 v[172:175], v[84:87], v[108:111], v[172:175]
    s_add_u32 s78, s78, 8192
    s_mov_b32 s55, 8192
    s_cmp_eq_u32 s78, 32768
    s_cselect_b32 s78, 0, s78
    s_cselect_b32 s55, 4294942720, s55
    v_mfma_f32_16x16x32_bf16 v[188:191], v[84:87], v[112:115], v[188:191]
    v_add_u32 v20, s55, v20
    v_add_u32 v21, s55, v21
    v_mfma_f32_16x16x32_bf16 v[204:207], v[84:87], v[116:119], v[204:207]
    s_mov_b32 m0, s60
    s_add_u32 s44, s44, 8192
    buffer_load_dwordx4 v38, s[20:23], s61 offen offset:1024 nt lds
    s_cmp_eq_u32 s44, 131072
    s_cselect_b32 s44, 524288, s44
    s_add_u32 s43, s43, 16384
    s_cmp_eq_u32 s43, 81920
    s_cselect_b32 s43, 0, s43
    v_mfma_f32_16x16x32_bf16 v[220:223], v[84:87], v[120:123], v[220:223]
    v_add_u32 v22, s55, v22
    v_add_u32 v23, s55, v23
    v_mfma_f32_16x16x32_bf16 v[236:239], v[84:87], v[124:127], v[236:239]
    s_waitcnt lgkmcnt(0)
    s_waitcnt vmcnt(8)
    s_barrier
    v_mfma_f32_16x16x32_bf16 v[160:163], v[56:59], v[88:91], v[160:163]
    ds_read_b128 v[108:111], v11 offset:0
    v_mfma_f32_16x16x32_bf16 v[176:179], v[56:59], v[92:95], v[176:179]
    ds_read_b128 v[112:115], v11 offset:2048
    v_mfma_f32_16x16x32_bf16 v[192:195], v[56:59], v[96:99], v[192:195]
    s_add_u32 s60, s43, s57
    s_add_u32 s61, s44, s57
    s_mov_b32 m0, s60
    v_xor_b32 v37, 64, v30
    buffer_load_dwordx4 v30, s[16:19], s61 offen nt lds
    v_mfma_f32_16x16x32_bf16 v[208:211], v[56:59], v[100:103], v[208:211]
    ds_read_b128 v[116:119], v11 offset:4096
    v_mfma_f32_16x16x32_bf16 v[224:227], v[56:59], v[104:107], v[224:227]
    ds_read_b128 v[120:123], v11 offset:6144
    v_mfma_f32_16x16x32_bf16 v[164:167], v[60:63], v[88:91], v[164:167]
    v_mfma_f32_16x16x32_bf16 v[180:183], v[60:63], v[92:95], v[180:183]
    ds_read_b128 v[124:127], v11 offset:8192
    v_mfma_f32_16x16x32_bf16 v[196:199], v[60:63], v[96:99], v[196:199]
    ds_read_b64_tr_b16 v[72:73], v20
    ds_read_b64_tr_b16 v[74:75], v20 offset:1024
    s_mov_b32 m0, s60
    s_nop 0
    buffer_load_dwordx4 v37, s[16:19], s61 offen offset:1024 nt lds
    v_mfma_f32_16x16x32_bf16 v[212:215], v[60:63], v[100:103], v[212:215]
    v_mfma_f32_16x16x32_bf16 v[228:231], v[60:63], v[104:107], v[228:231]
    ds_read_b64_tr_b16 v[76:77], v21
    ds_read_b64_tr_b16 v[78:79], v21 offset:1024
    v_mfma_f32_16x16x32_bf16 v[168:171], v[64:67], v[88:91], v[168:171]
    ds_read_b64_tr_b16 v[80:81], v22
    ds_read_b64_tr_b16 v[82:83], v22 offset:1024
    v_mfma_f32_16x16x32_bf16 v[184:187], v[64:67], v[92:95], v[184:187]
    v_mfma_f32_16x16x32_bf16 v[200:203], v[64:67], v[96:99], v[200:203]
    ds_read_b64_tr_b16 v[84:85], v23
    ds_read_b64_tr_b16 v[86:87], v23 offset:1024
    s_add_u32 s60, s60, 8192
    s_mov_b32 m0, s60
    v_xor_b32 v38, 128, v31
    buffer_load_dwordx4 v31, s[20:23], s61 offen nt lds
    v_mfma_f32_16x16x32_bf16 v[216:219], v[64:67], v[100:103], v[216:219]
    v_mfma_f32_16x16x32_bf16 v[232:235], v[64:67], v[104:107], v[232:235]
    v_mfma_f32_16x16x32_bf16 v[172:175], v[68:71], v[88:91], v[172:175]
    s_add_u32 s78, s78, 8192
    s_mov_b32 s55, 8192
    s_cmp_eq_u32 s78, 32768
    s_cselect_b32 s78, 0, s78
    s_cselect_b32 s55, 4294942720, s55
    v_mfma_f32_16x16x32_bf16 v[188:191], v[68:71], v[92:95], v[188:191]
    v_add_u32 v20, s55, v20
    v_add_u32 v21, s55, v21
    v_mfma_f32_16x16x32_bf16 v[204:207], v[68:71], v[96:99], v[204:207]
    v_add_u32 v22, s55, v22
    v_add_u32 v23, s55, v23
    s_mov_b32 m0, s60
    s_add_u32 s44, s44, 8192
    buffer_load_dwordx4 v38, s[20:23], s61 offen offset:1024 nt lds
    s_cmp_eq_u32 s44, 131072
    s_cselect_b32 s44, 524288, s44
    s_add_u32 s43, s43, 16384
    s_cmp_eq_u32 s43, 81920
    s_cselect_b32 s43, 0, s43
    v_mfma_f32_16x16x32_bf16 v[220:223], v[68:71], v[100:103], v[220:223]
    v_add_u32 v10, s54, v10
    v_add_u32 v11, s54, v11
    s_sub_u32 s54, 0, s54
    v_mfma_f32_16x16x32_bf16 v[236:239], v[68:71], v[104:107], v[236:239]
    s_waitcnt lgkmcnt(0)
    s_waitcnt vmcnt(8)
    s_barrier
    v_mfma_f32_16x16x32_bf16 v[160:163], v[72:75], v[108:111], v[160:163]
    v_mfma_f32_16x16x32_bf16 v[176:179], v[72:75], v[112:115], v[176:179]
    v_mfma_f32_16x16x32_bf16 v[192:195], v[72:75], v[116:119], v[192:195]
    v_mfma_f32_16x16x32_bf16 v[208:211], v[72:75], v[120:123], v[208:211]
    v_mfma_f32_16x16x32_bf16 v[224:227], v[72:75], v[124:127], v[224:227]
    v_mfma_f32_16x16x32_bf16 v[164:167], v[76:79], v[108:111], v[164:167]
    v_mfma_f32_16x16x32_bf16 v[180:183], v[76:79], v[112:115], v[180:183]
    v_mfma_f32_16x16x32_bf16 v[196:199], v[76:79], v[116:119], v[196:199]
    v_mfma_f32_16x16x32_bf16 v[212:215], v[76:79], v[120:123], v[212:215]
    v_mfma_f32_16x16x32_bf16 v[228:231], v[76:79], v[124:127], v[228:231]
    v_mfma_f32_16x16x32_bf16 v[168:171], v[80:83], v[108:111], v[168:171]
    v_mfma_f32_16x16x32_bf16 v[184:187], v[80:83], v[112:115], v[184:187]
    v_mfma_f32_16x16x32_bf16 v[200:203], v[80:83], v[116:119], v[200:203]
    v_mfma_f32_16x16x32_bf16 v[216:219], v[80:83], v[120:123], v[216:219]
    v_mfma_f32_16x16x32_bf16 v[232:235], v[80:83], v[124:127], v[232:235]
    v_mfma_f32_16x16x32_bf16 v[172:175], v[84:87], v[108:111], v[172:175]
    v_mfma_f32_16x16x32_bf16 v[188:191], v[84:87], v[112:115], v[188:191]
    v_mfma_f32_16x16x32_bf16 v[204:207], v[84:87], v[116:119], v[204:207]
    v_mfma_f32_16x16x32_bf16 v[220:223], v[84:87], v[120:123], v[220:223]
    v_mfma_f32_16x16x32_bf16 v[236:239], v[84:87], v[124:127], v[236:239]
    s_mov_b32 s80, 0x3e0293ee
    s_mov_b32 s81, 0x3e0293ee
    s_nop 3
    v_pk_mul_f32 v[160:161], v[160:161], s[80:81]
    v_pk_mul_f32 v[162:163], v[162:163], s[80:81]
    v_pk_mul_f32 v[164:165], v[164:165], s[80:81]
    v_pk_mul_f32 v[166:167], v[166:167], s[80:81]
    v_cvt_pk_bf16_f32 v2, v160, v161
    v_cvt_pk_bf16_f32 v3, v162, v163
    v_cvt_pk_bf16_f32 v4, v164, v165
    v_cvt_pk_bf16_f32 v5, v166, v167
    v_cndmask_b32 v112, v2, v4, s[52:53]
    v_cndmask_b32 v113, v3, v5, s[52:53]
    v_cndmask_b32 v114, v4, v2, s[52:53]
    v_cndmask_b32 v115, v5, v3, s[52:53]
    v_pk_mul_f32 v[168:169], v[168:169], s[80:81]
    v_pk_mul_f32 v[170:171], v[170:171], s[80:81]
    v_pk_mul_f32 v[172:173], v[172:173], s[80:81]
    v_pk_mul_f32 v[174:175], v[174:175], s[80:81]
    v_cvt_pk_bf16_f32 v2, v168, v169
    v_cvt_pk_bf16_f32 v3, v170, v171
    v_cvt_pk_bf16_f32 v4, v172, v173
    v_cvt_pk_bf16_f32 v5, v174, v175
    v_cndmask_b32 v116, v2, v4, s[52:53]
    v_cndmask_b32 v117, v3, v5, s[52:53]
    v_cndmask_b32 v118, v4, v2, s[52:53]
    v_cndmask_b32 v119, v5, v3, s[52:53]
    v_pk_mul_f32 v[176:177], v[176:177], s[80:81]
    v_pk_mul_f32 v[178:179], v[178:179], s[80:81]
    v_pk_mul_f32 v[180:181], v[180:181], s[80:81]
    v_pk_mul_f32 v[182:183], v[182:183], s[80:81]
    v_cvt_pk_bf16_f32 v2, v176, v177
    v_cvt_pk_bf16_f32 v3, v178, v179
    v_cvt_pk_bf16_f32 v4, v180, v181
    v_cvt_pk_bf16_f32 v5, v182, v183
    v_cndmask_b32 v120, v2, v4, s[52:53]
    v_cndmask_b32 v121, v3, v5, s[52:53]
    v_cndmask_b32 v122, v4, v2, s[52:53]
    v_cndmask_b32 v123, v5, v3, s[52:53]
    v_pk_mul_f32 v[184:185], v[184:185], s[80:81]
    v_pk_mul_f32 v[186:187], v[186:187], s[80:81]
    v_pk_mul_f32 v[188:189], v[188:189], s[80:81]
    v_pk_mul_f32 v[190:191], v[190:191], s[80:81]
    v_cvt_pk_bf16_f32 v2, v184, v185
    v_cvt_pk_bf16_f32 v3, v186, v187
    v_cvt_pk_bf16_f32 v4, v188, v189
    v_cvt_pk_bf16_f32 v5, v190, v191
    v_cndmask_b32 v124, v2, v4, s[52:53]
    v_cndmask_b32 v125, v3, v5, s[52:53]
    v_cndmask_b32 v126, v4, v2, s[52:53]
    v_cndmask_b32 v127, v5, v3, s[52:53]
    v_pk_mul_f32 v[192:193], v[192:193], s[80:81]
    v_pk_mul_f32 v[194:195], v[194:195], s[80:81]
    v_pk_mul_f32 v[196:197], v[196:197], s[80:81]
    v_pk_mul_f32 v[198:199], v[198:199], s[80:81]
    v_cvt_pk_bf16_f32 v2, v192, v193
    v_cvt_pk_bf16_f32 v3, v194, v195
    v_cvt_pk_bf16_f32 v4, v196, v197
    v_cvt_pk_bf16_f32 v5, v198, v199
    v_cndmask_b32 v128, v2, v4, s[52:53]
    v_cndmask_b32 v129, v3, v5, s[52:53]
    v_cndmask_b32 v130, v4, v2, s[52:53]
    v_cndmask_b32 v131, v5, v3, s[52:53]
    v_pk_mul_f32 v[200:201], v[200:201], s[80:81]
    v_pk_mul_f32 v[202:203], v[202:203], s[80:81]
    v_pk_mul_f32 v[204:205], v[204:205], s[80:81]
    v_pk_mul_f32 v[206:207], v[206:207], s[80:81]
    v_cvt_pk_bf16_f32 v2, v200, v201
    v_cvt_pk_bf16_f32 v3, v202, v203
    v_cvt_pk_bf16_f32 v4, v204, v205
    v_cvt_pk_bf16_f32 v5, v206, v207
    v_cndmask_b32 v132, v2, v4, s[52:53]
    v_cndmask_b32 v133, v3, v5, s[52:53]
    v_cndmask_b32 v134, v4, v2, s[52:53]
    v_cndmask_b32 v135, v5, v3, s[52:53]
    v_pk_mul_f32 v[208:209], v[208:209], s[80:81]
    v_pk_mul_f32 v[210:211], v[210:211], s[80:81]
    v_pk_mul_f32 v[212:213], v[212:213], s[80:81]
    v_pk_mul_f32 v[214:215], v[214:215], s[80:81]
    v_cvt_pk_bf16_f32 v2, v208, v209
    v_cvt_pk_bf16_f32 v3, v210, v211
    v_cvt_pk_bf16_f32 v4, v212, v213
    v_cvt_pk_bf16_f32 v5, v214, v215
    v_cndmask_b32 v136, v2, v4, s[52:53]
    v_cndmask_b32 v137, v3, v5, s[52:53]
    v_cndmask_b32 v138, v4, v2, s[52:53]
    v_cndmask_b32 v139, v5, v3, s[52:53]
    v_pk_mul_f32 v[216:217], v[216:217], s[80:81]
    v_pk_mul_f32 v[218:219], v[218:219], s[80:81]
    v_pk_mul_f32 v[220:221], v[220:221], s[80:81]
    v_pk_mul_f32 v[222:223], v[222:223], s[80:81]
    v_cvt_pk_bf16_f32 v2, v216, v217
    v_cvt_pk_bf16_f32 v3, v218, v219
    v_cvt_pk_bf16_f32 v4, v220, v221
    v_cvt_pk_bf16_f32 v5, v222, v223
    v_cndmask_b32 v140, v2, v4, s[52:53]
    v_cndmask_b32 v141, v3, v5, s[52:53]
    v_cndmask_b32 v142, v4, v2, s[52:53]
    v_cndmask_b32 v143, v5, v3, s[52:53]
    v_pk_mul_f32 v[224:225], v[224:225], s[80:81]
    v_pk_mul_f32 v[226:227], v[226:227], s[80:81]
    v_pk_mul_f32 v[228:229], v[228:229], s[80:81]
    v_pk_mul_f32 v[230:231], v[230:231], s[80:81]
    v_cvt_pk_bf16_f32 v2, v224, v225
    v_cvt_pk_bf16_f32 v3, v226, v227
    v_cvt_pk_bf16_f32 v4, v228, v229
    v_cvt_pk_bf16_f32 v5, v230, v231
    v_cndmask_b32 v144, v2, v4, s[52:53]
    v_cndmask_b32 v145, v3, v5, s[52:53]
    v_cndmask_b32 v146, v4, v2, s[52:53]
    v_cndmask_b32 v147, v5, v3, s[52:53]
    v_pk_mul_f32 v[232:233], v[232:233], s[80:81]
    v_pk_mul_f32 v[234:235], v[234:235], s[80:81]
    v_pk_mul_f32 v[236:237], v[236:237], s[80:81]
    v_pk_mul_f32 v[238:239], v[238:239], s[80:81]
    v_cvt_pk_bf16_f32 v2, v232, v233
    v_cvt_pk_bf16_f32 v3, v234, v235
    v_cvt_pk_bf16_f32 v4, v236, v237
    v_cvt_pk_bf16_f32 v5, v238, v239
    v_cndmask_b32 v148, v2, v4, s[52:53]
    v_cndmask_b32 v149, v3, v5, s[52:53]
    v_cndmask_b32 v150, v4, v2, s[52:53]
    v_cndmask_b32 v151, v5, v3, s[52:53]
    v_lshlrev_b32 v2, 4, v1
    s_lshl_b32 s45, s79, 12
    s_lshl_b32 s46, s32, 4
    s_add_u32 s45, s45, s46
    s_add_u32 s45, s45, 81920
    v_add_u32 v2, s45, v2
    ds_write_b128 v2, v[112:115] offset:0
    ds_write_b128 v2, v[116:119] offset:1024
    ds_write_b128 v2, v[120:123] offset:4096
    ds_write_b128 v2, v[124:127] offset:5120
    ds_write_b128 v2, v[128:131] offset:8192
    ds_write_b128 v2, v[132:135] offset:9216
    ds_write_b128 v2, v[136:139] offset:12288
    ds_write_b128 v2, v[140:143] offset:13312
    ds_write_b128 v2, v[144:147] offset:16384
    ds_write_b128 v2, v[148:151] offset:17408
    s_waitcnt lgkmcnt(0)
    s_barrier
    v_lshlrev_b32 v26, 4, v1
    s_mul_i32 s45, s37, 1179648
    s_add_u32 s24, s24, s45
    s_addc_u32 s25, s25, 0
    s_mov_b32 s26, 1179648
    s_lshl_b32 s45, s34, 3
    s_add_u32 s45, s45, s35
    s_lshl_b32 s45, s45, 5
    s_lshl_b32 s46, s37, 3
    s_add_u32 s45, s45, s46
    s_mul_i32 s45, s45, 40960
    s_add_u32 s8, s6, s45
    s_addc_u32 s9, s7, 0
    s_mov_b32 s10, 327680
    s_mov_b32 s11, 0x20000
    s_mov_b32 s76, 81920
    s_and_b32 s47, s40, 1
    s_mul_i32 s62, s47, 5120
    s_add_u32 s63, s62, 4096
    v_add_u32 v17, s62, v26
    s_mov_b32 s75, 4294957056
    s_add_u32 s60, s43, s57
    s_add_u32 s61, s44, s57
    s_mov_b32 m0, s60
    v_xor_b32 v37, 64, v30
    buffer_load_dwordx4 v30, s[16:19], s61 offen nt lds
    s_mov_b32 m0, s60
    s_nop 0
    buffer_load_dwordx4 v37, s[16:19], s61 offen offset:1024 nt lds
    s_add_u32 s60, s60, 8192
    s_mov_b32 m0, s60
    v_xor_b32 v38, 128, v31
    buffer_load_dwordx4 v31, s[20:23], s61 offen nt lds
    s_mov_b32 m0, s60
    s_add_u32 s44, s44, 8192
    buffer_load_dwordx4 v38, s[20:23], s61 offen offset:1024 nt lds
    s_cmp_eq_u32 s44, 131072
    s_cselect_b32 s44, 524288, s44
    s_add_u32 s43, s43, 16384
    s_cmp_eq_u32 s43, 81920
    s_cselect_b32 s43, 0, s43
    s_waitcnt vmcnt(8)
    s_barrier
    s_add_u32 s60, s43, s57
    s_add_u32 s61, s44, s57
    s_mov_b32 m0, s60
    v_xor_b32 v37, 64, v30
    buffer_load_dwordx4 v30, s[16:19], s61 offen nt lds
    s_mov_b32 m0, s60
    s_nop 0
    buffer_load_dwordx4 v37, s[16:19], s61 offen offset:1024 nt lds
    s_add_u32 s60, s60, 8192
    s_mov_b32 m0, s60
    v_xor_b32 v38, 128, v31
    buffer_load_dwordx4 v31, s[20:23], s61 offen nt lds
    s_mov_b32 m0, s60
    s_add_u32 s44, s44, 8192
    buffer_load_dwordx4 v38, s[20:23], s61 offen offset:1024 nt lds
    s_cmp_eq_u32 s44, 131072
    s_cselect_b32 s44, 524288, s44
    s_add_u32 s43, s43, 16384
    s_cmp_eq_u32 s43, 81920
    s_cselect_b32 s43, 0, s43
    s_waitcnt vmcnt(8)
    s_barrier
    s_add_u32 s60, s43, s57
    s_add_u32 s61, s44, s57
    s_mov_b32 m0, s60
    v_xor_b32 v37, 64, v30
    buffer_load_dwordx4 v30, s[16:19], s61 offen nt lds
    s_mov_b32 m0, s60
    s_nop 0
    buffer_load_dwordx4 v37, s[16:19], s61 offen offset:1024 nt lds
    s_add_u32 s60, s60, 8192
    s_mov_b32 m0, s60
    v_xor_b32 v38, 128, v31
    buffer_load_dwordx4 v31, s[20:23], s61 offen nt lds
    s_mov_b32 m0, s60
    s_add_u32 s44, s44, 8192
    buffer_load_dwordx4 v38, s[20:23], s61 offen offset:1024 nt lds
    s_cmp_eq_u32 s44, 131072
    s_cselect_b32 s44, 524288, s44
    s_add_u32 s43, s43, 16384
    s_cmp_eq_u32 s43, 81920
    s_cselect_b32 s43, 0, s43
    s_waitcnt vmcnt(8)
    s_barrier
    s_add_u32 s60, s43, s57
    s_add_u32 s61, s44, s57
    s_mov_b32 m0, s60
    v_xor_b32 v37, 64, v30
    buffer_load_dwordx4 v30, s[16:19], s61 offen nt lds
    s_mov_b32 m0, s60
    s_nop 0
    buffer_load_dwordx4 v37, s[16:19], s61 offen offset:1024 nt lds
    s_add_u32 s60, s60, 8192
    s_mov_b32 m0, s60
    v_xor_b32 v38, 128, v31
    buffer_load_dwordx4 v31, s[20:23], s61 offen nt lds
    s_mov_b32 m0, s60
    s_add_u32 s44, s44, 8192
    buffer_load_dwordx4 v38, s[20:23], s61 offen offset:1024 nt lds
    s_cmp_eq_u32 s44, 131072
    s_cselect_b32 s44, 524288, s44
    s_add_u32 s43, s43, 16384
    s_cmp_eq_u32 s43, 81920
    s_cselect_b32 s43, 0, s43
    s_waitcnt vmcnt(8)
    s_barrier
    s_add_u32 s60, s43, s57
    s_add_u32 s61, s44, s57
    s_mov_b32 m0, s60
    v_xor_b32 v37, 64, v30
    buffer_load_dwordx4 v30, s[16:19], s61 offen nt lds
    s_mov_b32 m0, s60
    s_nop 0
    buffer_load_dwordx4 v37, s[16:19], s61 offen offset:1024 nt lds
    s_add_u32 s60, s60, 8192
    s_mov_b32 m0, s60
    v_xor_b32 v38, 128, v31
    buffer_load_dwordx4 v31, s[20:23], s61 offen nt lds
    s_mov_b32 m0, s60
    s_add_u32 s44, s44, 8192
    buffer_load_dwordx4 v38, s[20:23], s61 offen offset:1024 nt lds
    s_cmp_eq_u32 s44, 131072
    s_cselect_b32 s44, 524288, s44
    s_add_u32 s43, s43, 16384
    s_cmp_eq_u32 s43, 81920
    s_cselect_b32 s43, 0, s43
    s_waitcnt vmcnt(8)
    s_barrier
    s_add_u32 s60, s43, s57
    s_add_u32 s61, s44, s57
    s_mov_b32 m0, s60
    v_xor_b32 v37, 64, v30
    buffer_load_dwordx4 v30, s[16:19], s61 offen nt lds
    s_mov_b32 m0, s60
    s_nop 0
    buffer_load_dwordx4 v37, s[16:19], s61 offen offset:1024 nt lds
    s_add_u32 s60, s60, 8192
    s_mov_b32 m0, s60
    v_xor_b32 v38, 128, v31
    buffer_load_dwordx4 v31, s[20:23], s61 offen nt lds
    s_mov_b32 m0, s60
    s_add_u32 s44, s44, 8192
    buffer_load_dwordx4 v38, s[20:23], s61 offen offset:1024 nt lds
    s_cmp_eq_u32 s44, 131072
    s_cselect_b32 s44, 524288, s44
    s_add_u32 s43, s43, 16384
    s_cmp_eq_u32 s43, 81920
    s_cselect_b32 s43, 0, s43
    s_waitcnt vmcnt(8)
    s_barrier
    s_add_u32 s60, s43, s57
    s_add_u32 s61, s44, s57
    s_mov_b32 m0, s60
    v_xor_b32 v37, 64, v30
    buffer_load_dwordx4 v30, s[16:19], s61 offen nt lds
    s_mov_b32 m0, s60
    s_nop 0
    buffer_load_dwordx4 v37, s[16:19], s61 offen offset:1024 nt lds
    s_add_u32 s60, s60, 8192
    s_mov_b32 m0, s60
    v_xor_b32 v38, 128, v31
    buffer_load_dwordx4 v31, s[20:23], s61 offen nt lds
    s_mov_b32 m0, s60
    s_add_u32 s44, s44, 8192
    buffer_load_dwordx4 v38, s[20:23], s61 offen offset:1024 nt lds
    s_cmp_eq_u32 s44, 131072
    s_cselect_b32 s44, 524288, s44
    s_add_u32 s43, s43, 16384
    s_cmp_eq_u32 s43, 81920
    s_cselect_b32 s43, 0, s43
    s_waitcnt vmcnt(8)
    s_barrier
    s_add_u32 s60, s43, s57
    s_add_u32 s61, s44, s57
    s_mov_b32 m0, s60
    v_xor_b32 v37, 64, v30
    buffer_load_dwordx4 v30, s[16:19], s61 offen nt lds
    s_mov_b32 m0, s60
    s_nop 0
    buffer_load_dwordx4 v37, s[16:19], s61 offen offset:1024 nt lds
    s_add_u32 s60, s60, 8192
    s_mov_b32 m0, s60
    v_xor_b32 v38, 128, v31
    buffer_load_dwordx4 v31, s[20:23], s61 offen nt lds
    s_mov_b32 m0, s60
    s_add_u32 s44, s44, 8192
    buffer_load_dwordx4 v38, s[20:23], s61 offen offset:1024 nt lds
    s_cmp_eq_u32 s44, 131072
    s_cselect_b32 s44, 524288, s44
    s_add_u32 s43, s43, 16384
    s_cmp_eq_u32 s43, 81920
    s_cselect_b32 s43, 0, s43
    s_waitcnt vmcnt(8)
    s_barrier
    s_cmp_lg_u32 s33, 4
    s_cbranch_scc1 L_polld_49
    s_and_b32 s45, s49, 0xffffff00
    v_mov_b32 v2, 0
    s_mov_b32 s46, 0
L_poll_48:
    buffer_load_dwordx4 v[4:7], v2, s[28:31], s45 offen sc0 sc1
    s_waitcnt vmcnt(0)
    v_and_b32 v4, v4, v5
    v_and_b32 v6, v6, v7
    v_and_b32 v4, v4, v6
    s_nop 0
    v_readfirstlane_b32 s47, v4
    s_add_u32 s46, s46, 1
    s_and_b32 s47, s47, 1
    s_cmp_eq_u32 s47, 1
    s_cbranch_scc1 L_polld_49
    s_sleep 2
    s_cmp_lt_u32 s46, 200000
    s_cbranch_scc1 L_poll_48
L_polld_49:
    s_add_u32 s60, s43, s57
    s_add_u32 s61, s44, s57
    s_mov_b32 m0, s60
    v_xor_b32 v37, 64, v30
    buffer_load_dwordx4 v30, s[16:19], s61 offen nt lds
    s_mov_b32 m0, s60
    s_nop 0
    buffer_load_dwordx4 v37, s[16:19], s61 offen offset:1024 nt lds
    s_add_u32 s60, s60, 8192
    s_mov_b32 m0, s60
    v_xor_b32 v38, 128, v31
    buffer_load_dwordx4 v31, s[20:23], s61 offen nt lds
    s_mov_b32 m0, s60
    s_add_u32 s44, s44, 8192
    buffer_load_dwordx4 v38, s[20:23], s61 offen offset:1024 nt lds
    s_cmp_eq_u32 s44, 131072
    s_cselect_b32 s44, 524288, s44
    s_add_u32 s43, s43, 16384
    s_cmp_eq_u32 s43, 81920
    s_cselect_b32 s43, 0, s43
    s_waitcnt vmcnt(8)
    s_barrier
    s_add_u32 s60, s43, s57
    s_add_u32 s61, s44, s57
    s_mov_b32 m0, s60
    v_xor_b32 v37, 64, v30
    buffer_load_dwordx4 v30, s[16:19], s61 offen nt lds
    s_mov_b32 m0, s60
    s_nop 0
    buffer_load_dwordx4 v37, s[16:19], s61 offen offset:1024 nt lds
    s_add_u32 s60, s60, 8192
    s_mov_b32 m0, s60
    v_xor_b32 v38, 128, v31
    buffer_load_dwordx4 v31, s[20:23], s61 offen nt lds
    s_mov_b32 m0, s60
    s_add_u32 s44, s44, 8192
    buffer_load_dwordx4 v38, s[20:23], s61 offen offset:1024 nt lds
    s_cmp_eq_u32 s44, 131072
    s_cselect_b32 s44, 524288, s44
    s_add_u32 s43, s43, 16384
    s_cmp_eq_u32 s43, 81920
    s_cselect_b32 s43, 0, s43
    s_add_u32 m0, s76, s62
    s_add_u32 s75, s75, 10240
    buffer_load_dwordx4 v17, s[8:11], s75 offen sc1 lds
    buffer_load_dwordx4 v17, s[8:11], s75 offen offset:1024 sc1 lds
    buffer_load_dwordx4 v17, s[8:11], s75 offen offset:2048 sc1 lds
    buffer_load_dwordx4 v17, s[8:11], s75 offen offset:3072 sc1 lds
    s_add_u32 m0, s76, s63
    s_add_u32 s78, s75, 4096
    buffer_load_dwordx4 v17, s[8:11], s78 offen sc1 lds
    s_add_u32 s76, s76, 20480
    s_cmp_eq_u32 s76, 163840
    s_cselect_b32 s76, 0, s76
    s_waitcnt vmcnt(13)
    s_barrier
    s_add_u32 s60, s43, s57
    s_add_u32 s61, s44, s57
    s_mov_b32 m0, s60
    v_xor_b32 v37, 64, v30
    buffer_load_dwordx4 v30, s[16:19], s61 offen nt lds
    s_mov_b32 m0, s60
    s_nop 0
    buffer_load_dwordx4 v37, s[16:19], s61 offen offset:1024 nt lds
    s_add_u32 s60, s60, 8192
    s_mov_b32 m0, s60
    v_xor_b32 v38, 128, v31
    buffer_load_dwordx4 v31, s[20:23], s61 offen nt lds
    s_mov_b32 m0, s60
    s_add_u32 s44, s44, 8192
    buffer_load_dwordx4 v38, s[20:23], s61 offen offset:1024 nt lds
    s_cmp_eq_u32 s44, 131072
    s_cselect_b32 s44, 524288, s44
    s_add_u32 s43, s43, 16384
    s_cmp_eq_u32 s43, 81920
    s_cselect_b32 s43, 0, s43
    s_add_u32 m0, s76, s62
    s_add_u32 s75, s75, 10240
    buffer_load_dwordx4 v17, s[8:11], s75 offen sc1 lds
    buffer_load_dwordx4 v17, s[8:11], s75 offen offset:1024 sc1 lds
    buffer_load_dwordx4 v17, s[8:11], s75 offen offset:2048 sc1 lds
    buffer_load_dwordx4 v17, s[8:11], s75 offen offset:3072 sc1 lds
    s_add_u32 m0, s76, s63
    s_add_u32 s78, s75, 4096
    buffer_load_dwordx4 v17, s[8:11], s78 offen sc1 lds
    s_add_u32 s76, s76, 20480
    s_cmp_eq_u32 s76, 163840
    s_cselect_b32 s76, 0, s76
    s_waitcnt vmcnt(18)
    s_barrier
    s_add_u32 s60, s43, s57
    s_add_u32 s61, s44, s57
    s_mov_b32 m0, s60
    v_xor_b32 v37, 64, v30
    buffer_load_dwordx4 v30, s[16:19], s61 offen nt lds
    s_mov_b32 m0, s60
    s_nop 0
    buffer_load_dwordx4 v37, s[16:19], s61 offen offset:1024 nt lds
    s_add_u32 s60, s60, 8192
    s_mov_b32 m0, s60
    v_xor_b32 v38, 128, v31
    buffer_load_dwordx4 v31, s[20:23], s61 offen nt lds
    s_mov_b32 m0, s60
    s_add_u32 s44, s44, 8192
    buffer_load_dwordx4 v38, s[20:23], s61 offen offset:1024 nt lds
    s_cmp_eq_u32 s44, 131072
    s_cselect_b32 s44, 524288, s44
    s_add_u32 s43, s43, 16384
    s_cmp_eq_u32 s43, 81920
    s_cselect_b32 s43, 0, s43
    s_add_u32 m0, s76, s62
    s_add_u32 s75, s75, 10240
    buffer_load_dwordx4 v17, s[8:11], s75 offen sc1 lds
    buffer_load_dwordx4 v17, s[8:11], s75 offen offset:1024 sc1 lds
    buffer_load_dwordx4 v17, s[8:11], s75 offen offset:2048 sc1 lds
    buffer_load_dwordx4 v17, s[8:11], s75 offen offset:3072 sc1 lds
    s_add_u32 m0, s76, s63
    s_add_u32 s78, s75, 4096
    buffer_load_dwordx4 v17, s[8:11], s78 offen sc1 lds
    s_add_u32 s76, s76, 20480
    s_cmp_eq_u32 s76, 163840
    s_cselect_b32 s76, 0, s76
    s_waitcnt vmcnt(23)
    s_barrier
    s_add_u32 s60, s43, s57
    s_add_u32 s61, s44, s57
    s_mov_b32 m0, s60
    v_xor_b32 v37, 64, v30
    buffer_load_dwordx4 v30, s[16:19], s61 offen nt lds
    s_mov_b32 m0, s60
    s_nop 0
    buffer_load_dwordx4 v37, s[16:19], s61 offen offset:1024 nt lds
    s_add_u32 s60, s60, 8192
    s_mov_b32 m0, s60
    v_xor_b32 v38, 128, v31
    buffer_load_dwordx4 v31, s[20:23], s61 offen nt lds
    s_mov_b32 m0, s60
    s_add_u32 s44, s44, 8192
    buffer_load_dwordx4 v38, s[20:23], s61 offen offset:1024 nt lds
    s_cmp_eq_u32 s44, 131072
    s_cselect_b32 s44, 524288, s44
    s_add_u32 s43, s43, 16384
    s_cmp_eq_u32 s43, 81920
    s_cselect_b32 s43, 0, s43
    s_add_u32 m0, s76, s62
    s_add_u32 s75, s75, 10240
    buffer_load_dwordx4 v17, s[8:11], s75 offen sc1 lds
    buffer_load_dwordx4 v17, s[8:11], s75 offen offset:1024 sc1 lds
    buffer_load_dwordx4 v17, s[8:11], s75 offen offset:2048 sc1 lds
    buffer_load_dwordx4 v17, s[8:11], s75 offen offset:3072 sc1 lds
    s_add_u32 m0, s76, s63
    s_add_u32 s78, s75, 4096
    buffer_load_dwordx4 v17, s[8:11], s78 offen sc1 lds
    s_add_u32 s76, s76, 20480
    s_cmp_eq_u32 s76, 163840
    s_cselect_b32 s76, 0, s76
    s_waitcnt vmcnt(23)
    s_barrier
    s_add_u32 s60, s43, s57
    s_add_u32 s61, s44, s57
    s_mov_b32 m0, s60
    v_xor_b32 v37, 64, v30
    buffer_load_dwordx4 v30, s[16:19], s61 offen nt lds
    s_mov_b32 m0, s60
    s_nop 0
    buffer_load_dwordx4 v37, s[16:19], s61 offen offset:1024 nt lds
    s_add_u32 s60, s60, 8192
    s_mov_b32 m0, s60
    v_xor_b32 v38, 128, v31
    buffer_load_dwordx4 v31, s[20:23], s61 offen nt lds
    s_mov_b32 m0, s60
    s_add_u32 s44, s44, 8192
    buffer_load_dwordx4 v38, s[20:23], s61 offen offset:1024 nt lds
    s_cmp_eq_u32 s44, 131072
    s_cselect_b32 s44, 524288, s44
    s_add_u32 s43, s43, 16384
    s_cmp_eq_u32 s43, 81920
    s_cselect_b32 s43, 0, s43
    s_waitcnt vmcnt(18)
    s_barrier
    s_add_u32 s60, s43, s57
    s_add_u32 s61, s44, s57
    s_mov_b32 m0, s60
    v_xor_b32 v37, 64, v30
    buffer_load_dwordx4 v30, s[16:19], s61 offen nt lds
    s_mov_b32 m0, s60
    s_nop 0
    buffer_load_dwordx4 v37, s[16:19], s61 offen offset:1024 nt lds
    s_add_u32 s60, s60, 8192
    s_mov_b32 m0, s60
    v_xor_b32 v38, 128, v31
    buffer_load_dwordx4 v31, s[20:23], s61 offen nt lds
    s_mov_b32 m0, s60
    s_add_u32 s44, s44, 8192
    buffer_load_dwordx4 v38, s[20:23], s61 offen offset:1024 nt lds
    s_cmp_eq_u32 s44, 131072
    s_cselect_b32 s44, 524288, s44
    s_add_u32 s43, s43, 16384
    s_cmp_eq_u32 s43, 81920
    s_cselect_b32 s43, 0, s43
    s_waitcnt vmcnt(13)
    s_barrier
    s_add_u32 s60, s43, s57
    s_add_u32 s61, s44, s57
    s_mov_b32 m0, s60
    v_xor_b32 v37, 64, v30
    buffer_load_dwordx4 v30, s[16:19], s61 offen nt lds
    s_mov_b32 m0, s60
    s_nop 0
    buffer_load_dwordx4 v37, s[16:19], s61 offen offset:1024 nt lds
    s_add_u32 s60, s60, 8192
    s_mov_b32 m0, s60
    v_xor_b32 v38, 128, v31
    buffer_load_dwordx4 v31, s[20:23], s61 offen nt lds
    s_mov_b32 m0, s60
    s_add_u32 s44, s44, 8192
    buffer_load_dwordx4 v38, s[20:23], s61 offen offset:1024 nt lds
    s_cmp_eq_u32 s44, 131072
    s_cselect_b32 s44, 524288, s44
    s_add_u32 s43, s43, 16384
    s_cmp_eq_u32 s43, 81920
    s_cselect_b32 s43, 0, s43
    s_waitcnt vmcnt(8)
    s_barrier
    s_mov_b32 s79, 0
    s_waitcnt vmcnt(0)
    s_barrier
    s_add_u32 m0, s76, s62
    s_add_u32 s75, s75, 10240
    buffer_load_dwordx4 v17, s[8:11], s75 offen sc1 lds
    buffer_load_dwordx4 v17, s[8:11], s75 offen offset:1024 sc1 lds
    buffer_load_dwordx4 v17, s[8:11], s75 offen offset:2048 sc1 lds
    buffer_load_dwordx4 v17, s[8:11], s75 offen offset:3072 sc1 lds
    s_add_u32 m0, s76, s63
    s_add_u32 s78, s75, 4096
    buffer_load_dwordx4 v17, s[8:11], s78 offen sc1 lds
    s_add_u32 s76, s76, 20480
    s_cmp_eq_u32 s76, 163840
    s_cselect_b32 s76, 0, s76
    s_add_u32 m0, s76, s62
    s_add_u32 s75, s75, 10240
    buffer_load_dwordx4 v17, s[8:11], s75 offen sc1 lds
    buffer_load_dwordx4 v17, s[8:11], s75 offen offset:1024 sc1 lds
    buffer_load_dwordx4 v17, s[8:11], s75 offen offset:2048 sc1 lds
    buffer_load_dwordx4 v17, s[8:11], s75 offen offset:3072 sc1 lds
    s_add_u32 m0, s76, s63
    s_add_u32 s78, s75, 4096
    buffer_load_dwordx4 v17, s[8:11], s78 offen sc1 lds
    s_add_u32 s76, s76, 20480
    s_cmp_eq_u32 s76, 163840
    s_cselect_b32 s76, 0, s76
    v_lshrrev_b32 v2, 4, v1
    v_bfe_u32 v3, v1, 2, 2
    v_lshlrev_b32 v2, 2, v2
    v_add_u32 v2, v2, v3
    v_mul_u32_u24 v2, 288, v2
    v_and_b32 v3, 3, v1
    v_lshlrev_b32 v3, 3, v3
    v_add_u32 v2, v2, v3
    v_add_u32 v24, 10400, v2
    s_lshl_b32 s45, s39, 10
    v_add_u32 v25, s45, v26
    v_mov_b64 v[160:161], 0
    v_mov_b64 v[162:163], 0
    v_mov_b64 v[164:165], 0
    v_mov_b64 v[166:167], 0
    v_mov_b64 v[168:169], 0
    v_mov_b64 v[170:171], 0
    v_mov_b64 v[172:173], 0
    v_mov_b64 v[174:175], 0
    v_mov_b64 v[176:177], 0
    v_mov_b64 v[178:179], 0
    v_mov_b64 v[180:181], 0
    v_mov_b64 v[182:183], 0
    v_mov_b64 v[184:185], 0
    v_mov_b64 v[186:187], 0
    v_mov_b64 v[188:189], 0
    v_mov_b64 v[190:191], 0
    v_mov_b64 v[192:193], 0
    v_mov_b64 v[194:195], 0
    v_mov_b64 v[196:197], 0
    v_mov_b64 v[198:199], 0
    v_mov_b64 v[200:201], 0
    v_mov_b64 v[202:203], 0
    v_mov_b64 v[204:205], 0
    v_mov_b64 v[206:207], 0
    s_mov_b32 s77, 81920
    v_add_u32 v2, s77, v24
    v_add_u32 v3, s77, v25
    s_add_u32 s77, s77, 20480
    s_cmp_eq_u32 s77, 163840
    s_cselect_b32 s77, 0, s77
    ds_read_b128 v[56:59], v3 offset:0
    ds_read_b128 v[60:63], v3 offset:1024
    ds_read_b128 v[64:67], v3 offset:2048
    ds_read_b64_tr_b16 v[80:81], v2 offset:0
    ds_read_b64_tr_b16 v[82:83], v2 offset:4608
    ds_read_b64_tr_b16 v[84:85], v2 offset:32
    ds_read_b64_tr_b16 v[86:87], v2 offset:4640
    ds_read_b64_tr_b16 v[88:89], v2 offset:64
    ds_read_b64_tr_b16 v[90:91], v2 offset:4672
    ds_read_b64_tr_b16 v[92:93], v2 offset:96
    ds_read_b64_tr_b16 v[94:95], v2 offset:4704
    s_waitcnt lgkmcnt(0)
    s_barrier
    v_mfma_f32_16x16x32_bf16 v[160:163], v[80:83], v[56:59], v[160:163]
    v_add_u32 v4, s77, v24
    v_add_u32 v5, s77, v25
    s_add_u32 s77, s77, 20480
    s_cmp_eq_u32 s77, 163840
    s_cselect_b32 s77, 0, s77
    v_mfma_f32_16x16x32_bf16 v[176:179], v[80:83], v[60:63], v[176:179]
    ds_read_b128 v[68:71], v5 offset:0
    s_add_u32 m0, s76, s62
    s_add_u32 s75, s75, 10240
    buffer_load_dwordx4 v17, s[8:11], s75 offen sc1 lds
    v_mfma_f32_16x16x32_bf16 v[192:195], v[80:83], v[64:67], v[192:195]
    ds_read_b128 v[72:75], v5 offset:1024
    v_mfma_f32_16x16x32_bf16 v[164:167], v[84:87], v[56:59], v[164:167]
    ds_read_b128 v[76:79], v5 offset:2048
    buffer_load_dwordx4 v17, s[8:11], s75 offen offset:1024 sc1 lds
    v_mfma_f32_16x16x32_bf16 v[180:183], v[84:87], v[60:63], v[180:183]
    ds_read_b64_tr_b16 v[220:221], v4 offset:0
    ds_read_b64_tr_b16 v[222:223], v4 offset:4608
    v_mfma_f32_16x16x32_bf16 v[196:199], v[84:87], v[64:67], v[196:199]
    ds_read_b64_tr_b16 v[224:225], v4 offset:32
    ds_read_b64_tr_b16 v[226:227], v4 offset:4640
    v_mfma_f32_16x16x32_bf16 v[168:171], v[88:91], v[56:59], v[168:171]
    ds_read_b64_tr_b16 v[228:229], v4 offset:64
    ds_read_b64_tr_b16 v[230:231], v4 offset:4672
    buffer_load_dwordx4 v17, s[8:11], s75 offen offset:2048 sc1 lds
    v_mfma_f32_16x16x32_bf16 v[184:187], v[88:91], v[60:63], v[184:187]
    ds_read_b64_tr_b16 v[232:233], v4 offset:96
    ds_read_b64_tr_b16 v[234:235], v4 offset:4704
    v_mfma_f32_16x16x32_bf16 v[200:203], v[88:91], v[64:67], v[200:203]
    buffer_load_dwordx4 v17, s[8:11], s75 offen offset:3072 sc1 lds
    v_mfma_f32_16x16x32_bf16 v[172:175], v[92:95], v[56:59], v[172:175]
    v_mfma_f32_16x16x32_bf16 v[188:191], v[92:95], v[60:63], v[188:191]
    v_mfma_f32_16x16x32_bf16 v[204:207], v[92:95], v[64:67], v[204:207]
    s_add_u32 m0, s76, s63
    s_add_u32 s78, s75, 4096
    buffer_load_dwordx4 v17, s[8:11], s78 offen sc1 lds
    s_add_u32 s76, s76, 20480
    s_cmp_eq_u32 s76, 163840
    s_cselect_b32 s76, 0, s76
    s_waitcnt lgkmcnt(6)
    v_mfma_f32_16x16x32_bf16 v[160:163], v[220:223], v[68:71], v[160:163]
    v_add_u32 v2, s77, v24
    v_add_u32 v3, s77, v25
    s_add_u32 s77, s77, 20480
    s_cmp_eq_u32 s77, 163840
    s_cselect_b32 s77, 0, s77
    v_mfma_f32_16x16x32_bf16 v[176:179], v[220:223], v[72:75], v[176:179]
    ds_read_b128 v[56:59], v3 offset:0
    s_add_u32 m0, s76, s62
    s_add_u32 s75, s75, 10240
    buffer_load_dwordx4 v17, s[8:11], s75 offen sc1 lds
    v_mfma_f32_16x16x32_bf16 v[192:195], v[220:223], v[76:79], v[192:195]
    ds_read_b128 v[60:63], v3 offset:1024
    s_waitcnt lgkmcnt(6)
    v_mfma_f32_16x16x32_bf16 v[164:167], v[224:227], v[68:71], v[164:167]
    ds_read_b128 v[64:67], v3 offset:2048
    buffer_load_dwordx4 v17, s[8:11], s75 offen offset:1024 sc1 lds
    v_mfma_f32_16x16x32_bf16 v[180:183], v[224:227], v[72:75], v[180:183]
    ds_read_b64_tr_b16 v[80:81], v2 offset:0
    ds_read_b64_tr_b16 v[82:83], v2 offset:4608
    v_mfma_f32_16x16x32_bf16 v[196:199], v[224:227], v[76:79], v[196:199]
    ds_read_b64_tr_b16 v[84:85], v2 offset:32
    ds_read_b64_tr_b16 v[86:87], v2 offset:4640
    s_waitcnt lgkmcnt(9)
    v_mfma_f32_16x16x32_bf16 v[168:171], v[228:231], v[68:71], v[168:171]
    ds_read_b64_tr_b16 v[88:89], v2 offset:64
    ds_read_b64_tr_b16 v[90:91], v2 offset:4672
    buffer_load_dwordx4 v17, s[8:11], s75 offen offset:2048 sc1 lds
    v_mfma_f32_16x16x32_bf16 v[184:187], v[228:231], v[72:75], v[184:187]
    ds_read_b64_tr_b16 v[92:93], v2 offset:96
    ds_read_b64_tr_b16 v[94:95], v2 offset:4704
    v_mfma_f32_16x16x32_bf16 v[200:203], v[228:231], v[76:79], v[200:203]
    buffer_load_dwordx4 v17, s[8:11], s75 offen offset:3072 sc1 lds
    s_waitcnt lgkmcnt(11)
    v_mfma_f32_16x16x32_bf16 v[172:175], v[232:235], v[68:71], v[172:175]
    v_mfma_f32_16x16x32_bf16 v[188:191], v[232:235], v[72:75], v[188:191]
    v_mfma_f32_16x16x32_bf16 v[204:207], v[232:235], v[76:79], v[204:207]
    s_add_u32 m0, s76, s63
    s_add_u32 s78, s75, 4096
    buffer_load_dwordx4 v17, s[8:11], s78 offen sc1 lds
    s_add_u32 s76, s76, 20480
    s_cmp_eq_u32 s76, 163840
    s_cselect_b32 s76, 0, s76
    s_waitcnt lgkmcnt(0)
    s_waitcnt vmcnt(15)
    s_barrier
    v_mfma_f32_16x16x32_bf16 v[160:163], v[80:83], v[56:59], v[160:163]
    v_add_u32 v4, s77, v24
    v_add_u32 v5, s77, v25
    s_add_u32 s77, s77, 20480
    s_cmp_eq_u32 s77, 163840
    s_cselect_b32 s77, 0, s77
    v_mfma_f32_16x16x32_bf16 v[176:179], v[80:83], v[60:63], v[176:179]
    ds_read_b128 v[68:71], v5 offset:0
    s_add_u32 m0, s76, s62
    s_add_u32 s75, s75, 10240
    buffer_load_dwordx4 v17, s[8:11], s75 offen sc1 lds
    v_mfma_f32_16x16x32_bf16 v[192:195], v[80:83], v[64:67], v[192:195]
    ds_read_b128 v[72:75], v5 offset:1024
    v_mfma_f32_16x16x32_bf16 v[164:167], v[84:87], v[56:59], v[164:167]
    ds_read_b128 v[76:79], v5 offset:2048
    buffer_load_dwordx4 v17, s[8:11], s75 offen offset:1024 sc1 lds
    v_mfma_f32_16x16x32_bf16 v[180:183], v[84:87], v[60:63], v[180:183]
    ds_read_b64_tr_b16 v[220:221], v4 offset:0
    ds_read_b64_tr_b16 v[222:223], v4 offset:4608
    v_mfma_f32_16x16x32_bf16 v[196:199], v[84:87], v[64:67], v[196:199]
    ds_read_b64_tr_b16 v[224:225], v4 offset:32
    ds_read_b64_tr_b16 v[226:227], v4 offset:4640
    v_mfma_f32_16x16x32_bf16 v[168:171], v[88:91], v[56:59], v[168:171]
    ds_read_b64_tr_b16 v[228:229], v4 offset:64
    ds_read_b64_tr_b16 v[230:231], v4 offset:4672
    buffer_load_dwordx4 v17, s[8:11], s75 offen offset:2048 sc1 lds
    v_mfma_f32_16x16x32_bf16 v[184:187], v[88:91], v[60:63], v[184:187]
    ds_read_b64_tr_b16 v[232:233], v4 offset:96
    ds_read_b64_tr_b16 v[234:235], v4 offset:4704
    v_mfma_f32_16x16x32_bf16 v[200:203], v[88:91], v[64:67], v[200:203]
    buffer_load_dwordx4 v17, s[8:11], s75 offen offset:3072 sc1 lds
    v_mfma_f32_16x16x32_bf16 v[172:175], v[92:95], v[56:59], v[172:175]
    v_mfma_f32_16x16x32_bf16 v[188:191], v[92:95], v[60:63], v[188:191]
    v_mfma_f32_16x16x32_bf16 v[204:207], v[92:95], v[64:67], v[204:207]
    s_add_u32 m0, s76, s63
    s_add_u32 s78, s75, 4096
    buffer_load_dwordx4 v17, s[8:11], s78 offen sc1 lds
    s_add_u32 s76, s76, 20480
    s_cmp_eq_u32 s76, 163840
    s_cselect_b32 s76, 0, s76
    s_waitcnt lgkmcnt(6)
    v_mfma_f32_16x16x32_bf16 v[160:163], v[220:223], v[68:71], v[160:163]
    v_add_u32 v2, s77, v24
    v_add_u32 v3, s77, v25
    s_add_u32 s77, s77, 20480
    s_cmp_eq_u32 s77, 163840
    s_cselect_b32 s77, 0, s77
    v_mfma_f32_16x16x32_bf16 v[176:179], v[220:223], v[72:75], v[176:179]
    ds_read_b128 v[56:59], v3 offset:0
    s_add_u32 m0, s76, s62
    s_add_u32 s75, s75, 10240
    buffer_load_dwordx4 v17, s[8:11], s75 offen sc1 lds
    v_mfma_f32_16x16x32_bf16 v[192:195], v[220:223], v[76:79], v[192:195]
    ds_read_b128 v[60:63], v3 offset:1024
    s_waitcnt lgkmcnt(6)
    v_mfma_f32_16x16x32_bf16 v[164:167], v[224:227], v[68:71], v[164:167]
    ds_read_b128 v[64:67], v3 offset:2048
    buffer_load_dwordx4 v17, s[8:11], s75 offen offset:1024 sc1 lds
    v_mfma_f32_16x16x32_bf16 v[180:183], v[224:227], v[72:75], v[180:183]
    ds_read_b64_tr_b16 v[80:81], v2 offset:0
    ds_read_b64_tr_b16 v[82:83], v2 offset:4608
    v_mfma_f32_16x16x32_bf16 v[196:199], v[224:227], v[76:79], v[196:199]
    ds_read_b64_tr_b16 v[84:85], v2 offset:32
    ds_read_b64_tr_b16 v[86:87], v2 offset:4640
    s_waitcnt lgkmcnt(9)
    v_mfma_f32_16x16x32_bf16 v[168:171], v[228:231], v[68:71], v[168:171]
    ds_read_b64_tr_b16 v[88:89], v2 offset:64
    ds_read_b64_tr_b16 v[90:91], v2 offset:4672
    buffer_load_dwordx4 v17, s[8:11], s75 offen offset:2048 sc1 lds
    v_mfma_f32_16x16x32_bf16 v[184:187], v[228:231], v[72:75], v[184:187]
    ds_read_b64_tr_b16 v[92:93], v2 offset:96
    ds_read_b64_tr_b16 v[94:95], v2 offset:4704
    v_mfma_f32_16x16x32_bf16 v[200:203], v[228:231], v[76:79], v[200:203]
    buffer_load_dwordx4 v17, s[8:11], s75 offen offset:3072 sc1 lds
    s_waitcnt lgkmcnt(11)
    v_mfma_f32_16x16x32_bf16 v[172:175], v[232:235], v[68:71], v[172:175]
    v_mfma_f32_16x16x32_bf16 v[188:191], v[232:235], v[72:75], v[188:191]
    v_mfma_f32_16x16x32_bf16 v[204:207], v[232:235], v[76:79], v[204:207]
    s_add_u32 m0, s76, s63
    s_add_u32 s78, s75, 4096
    buffer_load_dwordx4 v17, s[8:11], s78 offen sc1 lds
    s_add_u32 s76, s76, 20480
    s_cmp_eq_u32 s76, 163840
    s_cselect_b32 s76, 0, s76
    s_waitcnt lgkmcnt(0)
    s_waitcnt vmcnt(15)
    s_mov_b32 s41, 4
L_op_50:
    s_barrier
    s_cmp_lg_u32 s41, 8
    s_cbranch_scc1 L_k6_52
L_k6_52:
    s_cmp_lg_u32 s41, 10
    s_cbranch_scc1 L_k10_53
    s_cmp_lg_u32 s33, 4
    s_cbranch_scc1 L_polld_55
    s_and_b32 s45, s49, 0xffffff00
    v_mov_b32 v2, 0
    s_mov_b32 s46, 0
L_poll_54:
    buffer_load_dwordx4 v[4:7], v2, s[28:31], s45 offen sc0 sc1
    s_waitcnt vmcnt(0)
    v_and_b32 v4, v4, v5
    v_and_b32 v6, v6, v7
    v_and_b32 v4, v4, v6
    s_nop 0
    v_readfirstlane_b32 s47, v4
    s_add_u32 s46, s46, 1
    s_and_b32 s47, s47, 2
    s_cmp_eq_u32 s47, 2
    s_cbranch_scc1 L_polld_55
    s_sleep 2
    s_cmp_lt_u32 s46, 200000
    s_cbranch_scc1 L_poll_54
L_polld_55:
    s_barrier
L_k10_53:
    s_cmp_ge_u32 s41, 26
    s_cbranch_scc1 L_opn_51
    v_mfma_f32_16x16x32_bf16 v[160:163], v[80:83], v[56:59], v[160:163]
    v_add_u32 v4, s77, v24
    v_add_u32 v5, s77, v25
    s_add_u32 s77, s77, 20480
    s_cmp_eq_u32 s77, 163840
    s_cselect_b32 s77, 0, s77
    v_mfma_f32_16x16x32_bf16 v[176:179], v[80:83], v[60:63], v[176:179]
    ds_read_b128 v[68:71], v5 offset:0
    s_add_u32 m0, s76, s62
    s_add_u32 s75, s75, 10240
    buffer_load_dwordx4 v17, s[8:11], s75 offen sc1 lds
    v_mfma_f32_16x16x32_bf16 v[192:195], v[80:83], v[64:67], v[192:195]
    ds_read_b128 v[72:75], v5 offset:1024
    v_mfma_f32_16x16x32_bf16 v[164:167], v[84:87], v[56:59], v[164:167]
    ds_read_b128 v[76:79], v5 offset:2048
    buffer_load_dwordx4 v17, s[8:11], s75 offen offset:1024 sc1 lds
    v_mfma_f32_16x16x32_bf16 v[180:183], v[84:87], v[60:63], v[180:183]
    ds_read_b64_tr_b16 v[220:221], v4 offset:0
    ds_read_b64_tr_b16 v[222:223], v4 offset:4608
    v_mfma_f32_16x16x32_bf16 v[196:199], v[84:87], v[64:67], v[196:199]
    ds_read_b64_tr_b16 v[224:225], v4 offset:32
    ds_read_b64_tr_b16 v[226:227], v4 offset:4640
    v_mfma_f32_16x16x32_bf16 v[168:171], v[88:91], v[56:59], v[168:171]
    ds_read_b64_tr_b16 v[228:229], v4 offset:64
    ds_read_b64_tr_b16 v[230:231], v4 offset:4672
    buffer_load_dwordx4 v17, s[8:11], s75 offen offset:2048 sc1 lds
    v_mfma_f32_16x16x32_bf16 v[184:187], v[88:91], v[60:63], v[184:187]
    ds_read_b64_tr_b16 v[232:233], v4 offset:96
    ds_read_b64_tr_b16 v[234:235], v4 offset:4704
    v_mfma_f32_16x16x32_bf16 v[200:203], v[88:91], v[64:67], v[200:203]
    buffer_load_dwordx4 v17, s[8:11], s75 offen offset:3072 sc1 lds
    v_mfma_f32_16x16x32_bf16 v[172:175], v[92:95], v[56:59], v[172:175]
    v_mfma_f32_16x16x32_bf16 v[188:191], v[92:95], v[60:63], v[188:191]
    v_mfma_f32_16x16x32_bf16 v[204:207], v[92:95], v[64:67], v[204:207]
    s_add_u32 m0, s76, s63
    s_add_u32 s78, s75, 4096
    buffer_load_dwordx4 v17, s[8:11], s78 offen sc1 lds
    s_add_u32 s76, s76, 20480
    s_cmp_eq_u32 s76, 163840
    s_cselect_b32 s76, 0, s76
    s_waitcnt lgkmcnt(6)
    v_mfma_f32_16x16x32_bf16 v[160:163], v[220:223], v[68:71], v[160:163]
    v_add_u32 v2, s77, v24
    v_add_u32 v3, s77, v25
    s_add_u32 s77, s77, 20480
    s_cmp_eq_u32 s77, 163840
    s_cselect_b32 s77, 0, s77
    v_mfma_f32_16x16x32_bf16 v[176:179], v[220:223], v[72:75], v[176:179]
    ds_read_b128 v[56:59], v3 offset:0
    s_add_u32 m0, s76, s62
    s_add_u32 s75, s75, 10240
    buffer_load_dwordx4 v17, s[8:11], s75 offen sc1 lds
    v_mfma_f32_16x16x32_bf16 v[192:195], v[220:223], v[76:79], v[192:195]
    ds_read_b128 v[60:63], v3 offset:1024
    s_waitcnt lgkmcnt(6)
    v_mfma_f32_16x16x32_bf16 v[164:167], v[224:227], v[68:71], v[164:167]
    ds_read_b128 v[64:67], v3 offset:2048
    buffer_load_dwordx4 v17, s[8:11], s75 offen offset:1024 sc1 lds
    v_mfma_f32_16x16x32_bf16 v[180:183], v[224:227], v[72:75], v[180:183]
    ds_read_b64_tr_b16 v[80:81], v2 offset:0
    ds_read_b64_tr_b16 v[82:83], v2 offset:4608
    v_mfma_f32_16x16x32_bf16 v[196:199], v[224:227], v[76:79], v[196:199]
    ds_read_b64_tr_b16 v[84:85], v2 offset:32
    ds_read_b64_tr_b16 v[86:87], v2 offset:4640
    s_waitcnt lgkmcnt(9)
    v_mfma_f32_16x16x32_bf16 v[168:171], v[228:231], v[68:71], v[168:171]
    ds_read_b64_tr_b16 v[88:89], v2 offset:64
    ds_read_b64_tr_b16 v[90:91], v2 offset:4672
    buffer_load_dwordx4 v17, s[8:11], s75 offen offset:2048 sc1 lds
    v_mfma_f32_16x16x32_bf16 v[184:187], v[228:231], v[72:75], v[184:187]
    ds_read_b64_tr_b16 v[92:93], v2 offset:96
    ds_read_b64_tr_b16 v[94:95], v2 offset:4704
    v_mfma_f32_16x16x32_bf16 v[200:203], v[228:231], v[76:79], v[200:203]
    buffer_load_dwordx4 v17, s[8:11], s75 offen offset:3072 sc1 lds
    s_waitcnt lgkmcnt(11)
    v_mfma_f32_16x16x32_bf16 v[172:175], v[232:235], v[68:71], v[172:175]
    v_mfma_f32_16x16x32_bf16 v[188:191], v[232:235], v[72:75], v[188:191]
    v_mfma_f32_16x16x32_bf16 v[204:207], v[232:235], v[76:79], v[204:207]
    s_add_u32 m0, s76, s63
    s_add_u32 s78, s75, 4096
    buffer_load_dwordx4 v17, s[8:11], s78 offen sc1 lds
    s_add_u32 s76, s76, 20480
    s_cmp_eq_u32 s76, 163840
    s_cselect_b32 s76, 0, s76
    s_waitcnt lgkmcnt(0)
    s_waitcnt vmcnt(15)
    s_add_u32 s41, s41, 2
    s_branch L_op_50
L_opn_51:
    v_mfma_f32_16x16x32_bf16 v[160:163], v[80:83], v[56:59], v[160:163]
    v_add_u32 v4, s77, v24
    v_add_u32 v5, s77, v25
    s_add_u32 s77, s77, 20480
    s_cmp_eq_u32 s77, 163840
    s_cselect_b32 s77, 0, s77
    v_mfma_f32_16x16x32_bf16 v[176:179], v[80:83], v[60:63], v[176:179]
    ds_read_b128 v[68:71], v5 offset:0
    v_mfma_f32_16x16x32_bf16 v[192:195], v[80:83], v[64:67], v[192:195]
    ds_read_b128 v[72:75], v5 offset:1024
    v_mfma_f32_16x16x32_bf16 v[164:167], v[84:87], v[56:59], v[164:167]
    ds_read_b128 v[76:79], v5 offset:2048
    v_mfma_f32_16x16x32_bf16 v[180:183], v[84:87], v[60:63], v[180:183]
    ds_read_b64_tr_b16 v[220:221], v4 offset:0
    ds_read_b64_tr_b16 v[222:223], v4 offset:4608
    v_mfma_f32_16x16x32_bf16 v[196:199], v[84:87], v[64:67], v[196:199]
    ds_read_b64_tr_b16 v[224:225], v4 offset:32
    ds_read_b64_tr_b16 v[226:227], v4 offset:4640
    v_mfma_f32_16x16x32_bf16 v[168:171], v[88:91], v[56:59], v[168:171]
    ds_read_b64_tr_b16 v[228:229], v4 offset:64
    ds_read_b64_tr_b16 v[230:231], v4 offset:4672
    v_mfma_f32_16x16x32_bf16 v[184:187], v[88:91], v[60:63], v[184:187]
    ds_read_b64_tr_b16 v[232:233], v4 offset:96
    ds_read_b64_tr_b16 v[234:235], v4 offset:4704
    v_mfma_f32_16x16x32_bf16 v[200:203], v[88:91], v[64:67], v[200:203]
    v_mfma_f32_16x16x32_bf16 v[172:175], v[92:95], v[56:59], v[172:175]
    v_mfma_f32_16x16x32_bf16 v[188:191], v[92:95], v[60:63], v[188:191]
    v_mfma_f32_16x16x32_bf16 v[204:207], v[92:95], v[64:67], v[204:207]
    s_waitcnt lgkmcnt(6)
    v_mfma_f32_16x16x32_bf16 v[160:163], v[220:223], v[68:71], v[160:163]
    v_add_u32 v2, s77, v24
    v_add_u32 v3, s77, v25
    s_add_u32 s77, s77, 20480
    s_cmp_eq_u32 s77, 163840
    s_cselect_b32 s77, 0, s77
    v_mfma_f32_16x16x32_bf16 v[176:179], v[220:223], v[72:75], v[176:179]
    ds_read_b128 v[56:59], v3 offset:0
    v_mfma_f32_16x16x32_bf16 v[192:195], v[220:223], v[76:79], v[192:195]
    ds_read_b128 v[60:63], v3 offset:1024
    s_waitcnt lgkmcnt(6)
    v_mfma_f32_16x16x32_bf16 v[164:167], v[224:227], v[68:71], v[164:167]
    ds_read_b128 v[64:67], v3 offset:2048
    v_mfma_f32_16x16x32_bf16 v[180:183], v[224:227], v[72:75], v[180:183]
    ds_read_b64_tr_b16 v[80:81], v2 offset:0
    ds_read_b64_tr_b16 v[82:83], v2 offset:4608
    v_mfma_f32_16x16x32_bf16 v[196:199], v[224:227], v[76:79], v[196:199]
    ds_read_b64_tr_b16 v[84:85], v2 offset:32
    ds_read_b64_tr_b16 v[86:87], v2 offset:4640
    s_waitcnt lgkmcnt(9)
    v_mfma_f32_16x16x32_bf16 v[168:171], v[228:231], v[68:71], v[168:171]
    ds_read_b64_tr_b16 v[88:89], v2 offset:64
    ds_read_b64_tr_b16 v[90:91], v2 offset:4672
    v_mfma_f32_16x16x32_bf16 v[184:187], v[228:231], v[72:75], v[184:187]
    ds_read_b64_tr_b16 v[92:93], v2 offset:96
    ds_read_b64_tr_b16 v[94:95], v2 offset:4704
    v_mfma_f32_16x16x32_bf16 v[200:203], v[228:231], v[76:79], v[200:203]
    s_waitcnt lgkmcnt(11)
    v_mfma_f32_16x16x32_bf16 v[172:175], v[232:235], v[68:71], v[172:175]
    v_mfma_f32_16x16x32_bf16 v[188:191], v[232:235], v[72:75], v[188:191]
    v_mfma_f32_16x16x32_bf16 v[204:207], v[232:235], v[76:79], v[204:207]
    s_waitcnt lgkmcnt(0)
    s_waitcnt vmcnt(0)
    s_add_u32 s41, s41, 2
    s_cmp_lt_u32 s41, 32
    s_cbranch_scc1 L_op_50
    s_nop 7
    s_mul_i32 s66, s39, 3
    s_lshr_b32 s66, s66, 3
    s_lshl_b32 s78, s48, 8
    s_lshl_b32 s46, s37, 2
    s_add_u32 s78, s78, s46
    s_add_u32 s78, s78, 117456896
    s_lshl_b32 s67, s48, 4
    s_add_u32 s67, s67, s66
    s_lshl_b32 s67, s67, 1
    s_add_u32 s67, s67, s79
    s_lshl_b32 s67, s67, 13
    s_add_u32 s67, s67, 67108864
    s_cmp_eq_u32 s66, s37
    s_cbranch_scc1 L_keep_56
    v_cvt_pk_bf16_f32 v56, v160, v161
    v_cvt_pk_bf16_f32 v57, v162, v163
    v_cvt_pk_bf16_f32 v58, v164, v165
    v_cvt_pk_bf16_f32 v59, v166, v167
    v_cvt_pk_bf16_f32 v60, v168, v169
    v_cvt_pk_bf16_f32 v61, v170, v171
    v_cvt_pk_bf16_f32 v62, v172, v173
    v_cvt_pk_bf16_f32 v63, v174, v175
    v_cvt_pk_bf16_f32 v64, v176, v177
    v_cvt_pk_bf16_f32 v65, v178, v179
    v_cvt_pk_bf16_f32 v66, v180, v181
    v_cvt_pk_bf16_f32 v67, v182, v183
    v_cvt_pk_bf16_f32 v68, v184, v185
    v_cvt_pk_bf16_f32 v69, v186, v187
    v_cvt_pk_bf16_f32 v70, v188, v189
    v_cvt_pk_bf16_f32 v71, v190, v191
    v_cvt_pk_bf16_f32 v72, v192, v193
    v_cvt_pk_bf16_f32 v73, v194, v195
    v_cvt_pk_bf16_f32 v74, v196, v197
    v_cvt_pk_bf16_f32 v75, v198, v199
    v_cvt_pk_bf16_f32 v76, v200, v201
    v_cvt_pk_bf16_f32 v77, v202, v203
    v_cvt_pk_bf16_f32 v78, v204, v205
    v_cvt_pk_bf16_f32 v79, v206, v207
    s_lshl_b32 s45, s37, 16
    s_add_u32 s45, s45, s67
    s_add_u32 s46, s45, 0
    buffer_store_dwordx4 v[56:59], v26, s[28:31], s46 offen sc0 sc1
    s_add_u32 s46, s45, 1024
    buffer_store_dwordx4 v[60:63], v26, s[28:31], s46 offen sc0 sc1
    s_add_u32 s46, s45, 2048
    buffer_store_dwordx4 v[64:67], v26, s[28:31], s46 offen sc0 sc1
    s_add_u32 s46, s45, 3072
    buffer_store_dwordx4 v[68:71], v26, s[28:31], s46 offen sc0 sc1
    s_add_u32 s46, s45, 4096
    buffer_store_dwordx4 v[72:75], v26, s[28:31], s46 offen sc0 sc1
    s_add_u32 s46, s45, 5120
    buffer_store_dwordx4 v[76:79], v26, s[28:31], s46 offen sc0 sc1
L_keep_56:
    s_waitcnt vmcnt(0)
    s_barrier
    s_cmp_lg_u32 s33, 0
    s_cbranch_scc1 L_sig_59
    v_mov_b32 v2, 0
    v_mov_b32 v3, 1
    s_mov_b64 s[70:71], exec
    s_mov_b64 exec, 1
    buffer_store_dword v3, v2, s[28:31], s78 offen sc0 sc1
    s_mov_b64 exec, s[70:71]
L_sig_59:
    s_cmp_lg_u32 s33, 0
    s_cbranch_scc1 L_polld_61
    s_and_b32 s45, s78, 0xffffff00
    v_mov_b32 v2, 0
    s_mov_b32 s46, 0
L_poll_60:
    buffer_load_dwordx4 v[4:7], v2, s[28:31], s45 offen sc0 sc1
    s_waitcnt vmcnt(0)
    v_and_b32 v4, v4, v5
    v_and_b32 v6, v6, v7
    v_and_b32 v4, v4, v6
    s_nop 0
    v_readfirstlane_b32 s47, v4
    s_add_u32 s46, s46, 1
    s_and_b32 s47, s47, 1
    s_cmp_eq_u32 s47, 1
    s_cbranch_scc1 L_polld_61
    s_sleep 2
    s_cmp_lt_u32 s46, 200000
    s_cbranch_scc1 L_poll_60
L_polld_61:
    s_barrier
    s_cmp_lg_u32 s66, s37
    s_cbranch_scc1 L_s2e_58
    s_add_u32 s45, s37, 1
    s_and_b32 s45, s45, 3
    s_lshl_b32 s45, s45, 16
    s_add_u32 s45, s45, s67
    s_add_u32 s46, s45, 0
    buffer_load_dwordx4 v[56:59], v26, s[28:31], s46 offen sc0 sc1
    s_add_u32 s46, s45, 1024
    buffer_load_dwordx4 v[60:63], v26, s[28:31], s46 offen sc0 sc1
    s_add_u32 s46, s45, 2048
    buffer_load_dwordx4 v[64:67], v26, s[28:31], s46 offen sc0 sc1
    s_add_u32 s46, s45, 3072
    buffer_load_dwordx4 v[68:71], v26, s[28:31], s46 offen sc0 sc1
    s_add_u32 s46, s45, 4096
    buffer_load_dwordx4 v[72:75], v26, s[28:31], s46 offen sc0 sc1
    s_add_u32 s46, s45, 5120
    buffer_load_dwordx4 v[76:79], v26, s[28:31], s46 offen sc0 sc1
    s_add_u32 s45, s37, 2
    s_and_b32 s45, s45, 3
    s_lshl_b32 s45, s45, 16
    s_add_u32 s45, s45, s67
    s_add_u32 s46, s45, 0
    buffer_load_dwordx4 v[88:91], v26, s[28:31], s46 offen sc0 sc1
    s_add_u32 s46, s45, 1024
    buffer_load_dwordx4 v[92:95], v26, s[28:31], s46 offen sc0 sc1
    s_add_u32 s46, s45, 2048
    buffer_load_dwordx4 v[96:99], v26, s[28:31], s46 offen sc0 sc1
    s_add_u32 s46, s45, 3072
    buffer_load_dwordx4 v[100:103], v26, s[28:31], s46 offen sc0 sc1
    s_add_u32 s46, s45, 4096
    buffer_load_dwordx4 v[104:107], v26, s[28:31], s46 offen sc0 sc1
    s_add_u32 s46, s45, 5120
    buffer_load_dwordx4 v[108:111], v26, s[28:31], s46 offen sc0 sc1
    s_add_u32 s45, s37, 3
    s_and_b32 s45, s45, 3
    s_lshl_b32 s45, s45, 16
    s_add_u32 s45, s45, s67
    s_add_u32 s46, s45, 0
    buffer_load_dwordx4 v[120:123], v26, s[28:31], s46 offen sc0 sc1
    s_add_u32 s46, s45, 1024
    buffer_load_dwordx4 v[124:127], v26, s[28:31], s46 offen sc0 sc1
    s_add_u32 s46, s45, 2048
    buffer_load_dwordx4 v[128:131], v26, s[28:31], s46 offen sc0 sc1
    s_add_u32 s46, s45, 3072
    buffer_load_dwordx4 v[132:135], v26, s[28:31], s46 offen sc0 sc1
    s_add_u32 s46, s45, 4096
    buffer_load_dwordx4 v[136:139], v26, s[28:31], s46 offen sc0 sc1
    s_add_u32 s46, s45, 5120
    buffer_load_dwordx4 v[140:143], v26, s[28:31], s46 offen sc0 sc1
    s_load_dwordx2 s[80:81], s[0:1], 80
    v_and_b32 v2, 15, v1
    v_mul_u32_u24 v2, 2304, v2
    v_lshrrev_b32 v3, 4, v1
    v_lshlrev_b32 v3, 3, v3
    v_add_u32 v2, v2, v3
    s_mul_i32 s45, s35, 160
    s_lshl_b32 s46, s39, 4
    s_add_u32 s45, s45, s46
    s_mul_i32 s45, s45, 2304
    s_mul_i32 s46, s34, 1152
    s_add_u32 s45, s45, s46
    s_mul_i32 s46, s38, 288
    s_add_u32 s45, s45, s46
    s_add_u32 s45, s45, 160
    s_waitcnt lgkmcnt(0)
    s_mov_b32 s16, s80
    s_mov_b32 s17, s81
    s_mov_b32 s18, 2949120
    s_mov_b32 s19, 0x20000
    s_waitcnt vmcnt(12)
    v_lshlrev_b32 v4, 16, v56
    v_and_b32 v5, 0xffff0000, v56
    v_add_f32 v160, v160, v4
    v_add_f32 v161, v161, v5
    v_lshlrev_b32 v4, 16, v57
    v_and_b32 v5, 0xffff0000, v57
    v_add_f32 v162, v162, v4
    v_add_f32 v163, v163, v5
    v_lshlrev_b32 v4, 16, v58
    v_and_b32 v5, 0xffff0000, v58
    v_add_f32 v164, v164, v4
    v_add_f32 v165, v165, v5
    v_lshlrev_b32 v4, 16, v59
    v_and_b32 v5, 0xffff0000, v59
    v_add_f32 v166, v166, v4
    v_add_f32 v167, v167, v5
    v_lshlrev_b32 v4, 16, v60
    v_and_b32 v5, 0xffff0000, v60
    v_add_f32 v168, v168, v4
    v_add_f32 v169, v169, v5
    v_lshlrev_b32 v4, 16, v61
    v_and_b32 v5, 0xffff0000, v61
    v_add_f32 v170, v170, v4
    v_add_f32 v171, v171, v5
    v_lshlrev_b32 v4, 16, v62
    v_and_b32 v5, 0xffff0000, v62
    v_add_f32 v172, v172, v4
    v_add_f32 v173, v173, v5
    v_lshlrev_b32 v4, 16, v63
    v_and_b32 v5, 0xffff0000, v63
    v_add_f32 v174, v174, v4
    v_add_f32 v175, v175, v5
    v_lshlrev_b32 v4, 16, v64
    v_and_b32 v5, 0xffff0000, v64
    v_add_f32 v176, v176, v4
    v_add_f32 v177, v177, v5
    v_lshlrev_b32 v4, 16, v65
    v_and_b32 v5, 0xffff0000, v65
    v_add_f32 v178, v178, v4
    v_add_f32 v179, v179, v5
    v_lshlrev_b32 v4, 16, v66
    v_and_b32 v5, 0xffff0000, v66
    v_add_f32 v180, v180, v4
    v_add_f32 v181, v181, v5
    v_lshlrev_b32 v4, 16, v67
    v_and_b32 v5, 0xffff0000, v67
    v_add_f32 v182, v182, v4
    v_add_f32 v183, v183, v5
    v_lshlrev_b32 v4, 16, v68
    v_and_b32 v5, 0xffff0000, v68
    v_add_f32 v184, v184, v4
    v_add_f32 v185, v185, v5
    v_lshlrev_b32 v4, 16, v69
    v_and_b32 v5, 0xffff0000, v69
    v_add_f32 v186, v186, v4
    v_add_f32 v187, v187, v5
    v_lshlrev_b32 v4, 16, v70
    v_and_b32 v5, 0xffff0000, v70
    v_add_f32 v188, v188, v4
    v_add_f32 v189, v189, v5
    v_lshlrev_b32 v4, 16, v71
    v_and_b32 v5, 0xffff0000, v71
    v_add_f32 v190, v190, v4
    v_add_f32 v191, v191, v5
    v_lshlrev_b32 v4, 16, v72
    v_and_b32 v5, 0xffff0000, v72
    v_add_f32 v192, v192, v4
    v_add_f32 v193, v193, v5
    v_lshlrev_b32 v4, 16, v73
    v_and_b32 v5, 0xffff0000, v73
    v_add_f32 v194, v194, v4
    v_add_f32 v195, v195, v5
    v_lshlrev_b32 v4, 16, v74
    v_and_b32 v5, 0xffff0000, v74
    v_add_f32 v196, v196, v4
    v_add_f32 v197, v197, v5
    v_lshlrev_b32 v4, 16, v75
    v_and_b32 v5, 0xffff0000, v75
    v_add_f32 v198, v198, v4
    v_add_f32 v199, v199, v5
    v_lshlrev_b32 v4, 16, v76
    v_and_b32 v5, 0xffff0000, v76
    v_add_f32 v200, v200, v4
    v_add_f32 v201, v201, v5
    v_lshlrev_b32 v4, 16, v77
    v_and_b32 v5, 0xffff0000, v77
    v_add_f32 v202, v202, v4
    v_add_f32 v203, v203, v5
    v_lshlrev_b32 v4, 16, v78
    v_and_b32 v5, 0xffff0000, v78
    v_add_f32 v204, v204, v4
    v_add_f32 v205, v205, v5
    v_lshlrev_b32 v4, 16, v79
    v_and_b32 v5, 0xffff0000, v79
    v_add_f32 v206, v206, v4
    v_add_f32 v207, v207, v5
    s_waitcnt vmcnt(6)
    v_lshlrev_b32 v4, 16, v88
    v_and_b32 v5, 0xffff0000, v88
    v_add_f32 v160, v160, v4
    v_add_f32 v161, v161, v5
    v_lshlrev_b32 v4, 16, v89
    v_and_b32 v5, 0xffff0000, v89
    v_add_f32 v162, v162, v4
    v_add_f32 v163, v163, v5
    v_lshlrev_b32 v4, 16, v90
    v_and_b32 v5, 0xffff0000, v90
    v_add_f32 v164, v164, v4
    v_add_f32 v165, v165, v5
    v_lshlrev_b32 v4, 16, v91
    v_and_b32 v5, 0xffff0000, v91
    v_add_f32 v166, v166, v4
    v_add_f32 v167, v167, v5
    v_lshlrev_b32 v4, 16, v92
    v_and_b32 v5, 0xffff0000, v92
    v_add_f32 v168, v168, v4
    v_add_f32 v169, v169, v5
    v_lshlrev_b32 v4, 16, v93
    v_and_b32 v5, 0xffff0000, v93
    v_add_f32 v170, v170, v4
    v_add_f32 v171, v171, v5
    v_lshlrev_b32 v4, 16, v94
    v_and_b32 v5, 0xffff0000, v94
    v_add_f32 v172, v172, v4
    v_add_f32 v173, v173, v5
    v_lshlrev_b32 v4, 16, v95
    v_and_b32 v5, 0xffff0000, v95
    v_add_f32 v174, v174, v4
    v_add_f32 v175, v175, v5
    v_lshlrev_b32 v4, 16, v96
    v_and_b32 v5, 0xffff0000, v96
    v_add_f32 v176, v176, v4
    v_add_f32 v177, v177, v5
    v_lshlrev_b32 v4, 16, v97
    v_and_b32 v5, 0xffff0000, v97
    v_add_f32 v178, v178, v4
    v_add_f32 v179, v179, v5
    v_lshlrev_b32 v4, 16, v98
    v_and_b32 v5, 0xffff0000, v98
    v_add_f32 v180, v180, v4
    v_add_f32 v181, v181, v5
    v_lshlrev_b32 v4, 16, v99
    v_and_b32 v5, 0xffff0000, v99
    v_add_f32 v182, v182, v4
    v_add_f32 v183, v183, v5
    v_lshlrev_b32 v4, 16, v100
    v_and_b32 v5, 0xffff0000, v100
    v_add_f32 v184, v184, v4
    v_add_f32 v185, v185, v5
    v_lshlrev_b32 v4, 16, v101
    v_and_b32 v5, 0xffff0000, v101
    v_add_f32 v186, v186, v4
    v_add_f32 v187, v187, v5
    v_lshlrev_b32 v4, 16, v102
    v_and_b32 v5, 0xffff0000, v102
    v_add_f32 v188, v188, v4
    v_add_f32 v189, v189, v5
    v_lshlrev_b32 v4, 16, v103
    v_and_b32 v5, 0xffff0000, v103
    v_add_f32 v190, v190, v4
    v_add_f32 v191, v191, v5
    v_lshlrev_b32 v4, 16, v104
    v_and_b32 v5, 0xffff0000, v104
    v_add_f32 v192, v192, v4
    v_add_f32 v193, v193, v5
    v_lshlrev_b32 v4, 16, v105
    v_and_b32 v5, 0xffff0000, v105
    v_add_f32 v194, v194, v4
    v_add_f32 v195, v195, v5
    v_lshlrev_b32 v4, 16, v106
    v_and_b32 v5, 0xffff0000, v106
    v_add_f32 v196, v196, v4
    v_add_f32 v197, v197, v5
    v_lshlrev_b32 v4, 16, v107
    v_and_b32 v5, 0xffff0000, v107
    v_add_f32 v198, v198, v4
    v_add_f32 v199, v199, v5
    v_lshlrev_b32 v4, 16, v108
    v_and_b32 v5, 0xffff0000, v108
    v_add_f32 v200, v200, v4
    v_add_f32 v201, v201, v5
    v_lshlrev_b32 v4, 16, v109
    v_and_b32 v5, 0xffff0000, v109
    v_add_f32 v202, v202, v4
    v_add_f32 v203, v203, v5
    v_lshlrev_b32 v4, 16, v110
    v_and_b32 v5, 0xffff0000, v110
    v_add_f32 v204, v204, v4
    v_add_f32 v205, v205, v5
    v_lshlrev_b32 v4, 16, v111
    v_and_b32 v5, 0xffff0000, v111
    v_add_f32 v206, v206, v4
    v_add_f32 v207, v207, v5
    s_waitcnt vmcnt(0)
    v_lshlrev_b32 v4, 16, v120
    v_and_b32 v5, 0xffff0000, v120
    v_add_f32 v160, v160, v4
    v_add_f32 v161, v161, v5
    v_lshlrev_b32 v4, 16, v121
    v_and_b32 v5, 0xffff0000, v121
    v_add_f32 v162, v162, v4
    v_add_f32 v163, v163, v5
    v_lshlrev_b32 v4, 16, v122
    v_and_b32 v5, 0xffff0000, v122
    v_add_f32 v164, v164, v4
    v_add_f32 v165, v165, v5
    v_lshlrev_b32 v4, 16, v123
    v_and_b32 v5, 0xffff0000, v123
    v_add_f32 v166, v166, v4
    v_add_f32 v167, v167, v5
    v_lshlrev_b32 v4, 16, v124
    v_and_b32 v5, 0xffff0000, v124
    v_add_f32 v168, v168, v4
    v_add_f32 v169, v169, v5
    v_lshlrev_b32 v4, 16, v125
    v_and_b32 v5, 0xffff0000, v125
    v_add_f32 v170, v170, v4
    v_add_f32 v171, v171, v5
    v_lshlrev_b32 v4, 16, v126
    v_and_b32 v5, 0xffff0000, v126
    v_add_f32 v172, v172, v4
    v_add_f32 v173, v173, v5
    v_lshlrev_b32 v4, 16, v127
    v_and_b32 v5, 0xffff0000, v127
    v_add_f32 v174, v174, v4
    v_add_f32 v175, v175, v5
    v_lshlrev_b32 v4, 16, v128
    v_and_b32 v5, 0xffff0000, v128
    v_add_f32 v176, v176, v4
    v_add_f32 v177, v177, v5
    v_lshlrev_b32 v4, 16, v129
    v_and_b32 v5, 0xffff0000, v129
    v_add_f32 v178, v178, v4
    v_add_f32 v179, v179, v5
    v_lshlrev_b32 v4, 16, v130
    v_and_b32 v5, 0xffff0000, v130
    v_add_f32 v180, v180, v4
    v_add_f32 v181, v181, v5
    v_lshlrev_b32 v4, 16, v131
    v_and_b32 v5, 0xffff0000, v131
    v_add_f32 v182, v182, v4
    v_add_f32 v183, v183, v5
    v_lshlrev_b32 v4, 16, v132
    v_and_b32 v5, 0xffff0000, v132
    v_add_f32 v184, v184, v4
    v_add_f32 v185, v185, v5
    v_lshlrev_b32 v4, 16, v133
    v_and_b32 v5, 0xffff0000, v133
    v_add_f32 v186, v186, v4
    v_add_f32 v187, v187, v5
    v_lshlrev_b32 v4, 16, v134
    v_and_b32 v5, 0xffff0000, v134
    v_add_f32 v188, v188, v4
    v_add_f32 v189, v189, v5
    v_lshlrev_b32 v4, 16, v135
    v_and_b32 v5, 0xffff0000, v135
    v_add_f32 v190, v190, v4
    v_add_f32 v191, v191, v5
    v_lshlrev_b32 v4, 16, v136
    v_and_b32 v5, 0xffff0000, v136
    v_add_f32 v192, v192, v4
    v_add_f32 v193, v193, v5
    v_lshlrev_b32 v4, 16, v137
    v_and_b32 v5, 0xffff0000, v137
    v_add_f32 v194, v194, v4
    v_add_f32 v195, v195, v5
    v_lshlrev_b32 v4, 16, v138
    v_and_b32 v5, 0xffff0000, v138
    v_add_f32 v196, v196, v4
    v_add_f32 v197, v197, v5
    v_lshlrev_b32 v4, 16, v139
    v_and_b32 v5, 0xffff0000, v139
    v_add_f32 v198, v198, v4
    v_add_f32 v199, v199, v5
    v_lshlrev_b32 v4, 16, v140
    v_and_b32 v5, 0xffff0000, v140
    v_add_f32 v200, v200, v4
    v_add_f32 v201, v201, v5
    v_lshlrev_b32 v4, 16, v141
    v_and_b32 v5, 0xffff0000, v141
    v_add_f32 v202, v202, v4
    v_add_f32 v203, v203, v5
    v_lshlrev_b32 v4, 16, v142
    v_and_b32 v5, 0xffff0000, v142
    v_add_f32 v204, v204, v4
    v_add_f32 v205, v205, v5
    v_lshlrev_b32 v4, 16, v143
    v_and_b32 v5, 0xffff0000, v143
    v_add_f32 v206, v206, v4
    v_add_f32 v207, v207, v5
    v_cvt_pk_bf16_f32 v56, v160, v161
    v_cvt_pk_bf16_f32 v57, v162, v163
    s_add_u32 s46, s45, 0
    buffer_store_dwordx2 v[56:57], v2, s[16:19], s46 offen
    v_cvt_pk_bf16_f32 v58, v164, v165
    v_cvt_pk_bf16_f32 v59, v166, v167
    s_add_u32 s46, s45, 32
    buffer_store_dwordx2 v[58:59], v2, s[16:19], s46 offen
    v_cvt_pk_bf16_f32 v60, v168, v169
    v_cvt_pk_bf16_f32 v61, v170, v171
    s_add_u32 s46, s45, 64
    buffer_store_dwordx2 v[60:61], v2, s[16:19], s46 offen
    v_cvt_pk_bf16_f32 v62, v172, v173
    v_cvt_pk_bf16_f32 v63, v174, v175
    s_add_u32 s46, s45, 96
    buffer_store_dwordx2 v[62:63], v2, s[16:19], s46 offen
    v_cvt_pk_bf16_f32 v64, v176, v177
    v_cvt_pk_bf16_f32 v65, v178, v179
    s_add_u32 s46, s45, 36864
    buffer_store_dwordx2 v[64:65], v2, s[16:19], s46 offen
    v_cvt_pk_bf16_f32 v66, v180, v181
    v_cvt_pk_bf16_f32 v67, v182, v183
    s_add_u32 s46, s45, 36896
    buffer_store_dwordx2 v[66:67], v2, s[16:19], s46 offen
    v_cvt_pk_bf16_f32 v68, v184, v185
    v_cvt_pk_bf16_f32 v69, v186, v187
    s_add_u32 s46, s45, 36928
    buffer_store_dwordx2 v[68:69], v2, s[16:19], s46 offen
    v_cvt_pk_bf16_f32 v70, v188, v189
    v_cvt_pk_bf16_f32 v71, v190, v191
    s_add_u32 s46, s45, 36960
    buffer_store_dwordx2 v[70:71], v2, s[16:19], s46 offen
    v_cvt_pk_bf16_f32 v72, v192, v193
    v_cvt_pk_bf16_f32 v73, v194, v195
    s_add_u32 s46, s45, 73728
    buffer_store_dwordx2 v[72:73], v2, s[16:19], s46 offen
    v_cvt_pk_bf16_f32 v74, v196, v197
    v_cvt_pk_bf16_f32 v75, v198, v199
    s_add_u32 s46, s45, 73760
    buffer_store_dwordx2 v[74:75], v2, s[16:19], s46 offen
    v_cvt_pk_bf16_f32 v76, v200, v201
    v_cvt_pk_bf16_f32 v77, v202, v203
    s_add_u32 s46, s45, 73792
    buffer_store_dwordx2 v[76:77], v2, s[16:19], s46 offen
    v_cvt_pk_bf16_f32 v78, v204, v205
    v_cvt_pk_bf16_f32 v79, v206, v207
    s_add_u32 s46, s45, 73824
    buffer_store_dwordx2 v[78:79], v2, s[16:19], s46 offen
L_s2e_58:
    s_branch L_k1_fin
L_nq2:
    s_cmp_ge_u32 s33, 4
    s_cbranch_scc1 L_gw_62
    v_lshrrev_b32 v2, 4, v1
    v_and_b32 v6, 1, v2
    v_lshrrev_b32 v7, 1, v2
    v_lshlrev_b32 v7, 2, v7
    v_or_b32 v6, v6, v7
    s_and_b32 s45, s40, 1
    s_lshl_b32 s45, s45, 3
    v_or_b32 v6, s45, v6
    v_and_b32 v7, 15, v1
    v_xor_b32 v6, v6, v7
    v_lshlrev_b32 v6, 4, v6
    v_lshlrev_b32 v7, 13, v2
    v_add_u32 v28, v6, v7
    v_add_u32 v29, 31744, v28
    v_lshrrev_b32 v6, 3, v1
    v_mul_u32_u24 v6, 1152, v6
    v_and_b32 v7, 7, v1
    v_xor_b32 v7, v7, v2
    v_lshlrev_b32 v7, 4, v7
    s_and_b32 s45, s40, 1
    s_lshl_b32 s45, s45, 6
    v_xor_b32 v7, s45, v7
    v_xor_b32 v5, 64, v7
    v_add_u32 v32, v6, v7
    v_add_u32 v33, v6, v5
    v_add_u32 v33, 8192, v33
    v_add_u32 v34, v6, v7
    v_add_u32 v34, 16384, v34
    v_add_u32 v35, v6, v5
    v_add_u32 v35, 24576, v35
    v_add_u32 v36, v6, v7
    v_add_u32 v36, 36864, v36
    s_lshl_b32 s63, s40, 16
    s_lshl_b32 s45, s36, 8
    s_add_u32 s63, s63, s45
    s_lshl_b32 s69, s40, 11
    s_add_u32 s69, s69, 122880
    s_mul_i32 s72, s40, 46080
    s_mul_i32 s73, s40, 5120
    s_add_u32 s73, s73, 81920
    s_lshl_b32 s45, s38, 1
    s_add_u32 s45, s45, s35
    s_sub_u32 s46, s45, 9
    s_cmp_ge_u32 s45, 9
    s_cselect_b32 s45, s46, s45
    s_lshl_b32 s62, s45, 19
    s_lshl_b32 s66, s45, 7
    s_mov_b32 s65, 0
    s_mov_b32 s68, 0
    s_mov_b32 s64, 0
    s_mov_b32 s67, 0
    s_add_u32 s76, s66, s72
    s_add_u32 s77, s68, s73
    s_mov_b32 m0, s77
    s_add_u32 s66, s66, 128
    buffer_load_dwordx4 v32, s[8:11], s76 offen  lds
    s_cmp_eq_u32 s66, 1152
    s_cselect_b32 s66, 0, s66
    s_mov_b32 m0, s77
    s_nop 0
    buffer_load_dwordx4 v33, s[8:11], s76 offen offset:1024  lds
    s_mov_b32 m0, s77
    s_nop 0
    buffer_load_dwordx4 v34, s[8:11], s76 offen offset:2048  lds
    s_mov_b32 m0, s77
    s_nop 0
    buffer_load_dwordx4 v35, s[8:11], s76 offen offset:3072  lds
    s_add_u32 s77, s77, 4096
    s_mov_b32 m0, s77
    s_sub_u32 s68, 20480, s68
    buffer_load_dwordx4 v36, s[8:11], s76 offen  lds
    v_lshrrev_b32 v2, 4, v1
    v_and_b32 v3, 15, v1
    s_and_b32 s45, s40, 1
    s_lshl_b32 s45, s45, 3
    v_add_u32 v4, s45, v2
    v_xor_b32 v4, v4, v3
    v_lshlrev_b32 v4, 4, v4
    v_lshlrev_b32 v5, 8, v2
    v_add_u32 v8, v4, v5
    v_lshlrev_b32 v4, 1, v2
    v_xor_b32 v4, v4, v3
    v_lshlrev_b32 v4, 4, v4
    v_add_u32 v9, v4, v5
    s_mov_b32 s79, 0
    v_lshrrev_b32 v2, 4, v1
    v_bfe_u32 v3, v1, 2, 2
    v_and_b32 v4, 3, v1
    v_lshlrev_b32 v5, 3, v2
    v_add_u32 v5, v5, v3
    v_and_b32 v6, 1, v3
    v_lshrrev_b32 v7, 1, v3
    v_lshlrev_b32 v7, 2, v7
    v_or_b32 v6, v6, v7
    v_and_b32 v7, 1, v2
    v_lshlrev_b32 v7, 3, v7
    v_or_b32 v6, v6, v7
    v_xor_b32 v6, v6, v4
    v_lshlrev_b32 v6, 4, v6
    v_lshlrev_b32 v5, 8, v5
    v_add_u32 v5, v5, v6
    v_and_b32 v6, 1, v4
    v_lshlrev_b32 v6, 3, v6
    v_add_u32 v5, v5, v6
    v_xor_b32 v5, s79, v5
    v_add_u32 v5, 122880, v5
    v_mov_b32 v20, v5
    v_xor_b32 v21, 8, v5
    v_xor_b32 v22, 64, v5
    v_xor_b32 v23, 72, v5
    v_and_b32 v6, 15, v1
    v_lshrrev_b32 v7, 1, v6
    v_xor_b32 v7, v7, v2
    v_lshlrev_b32 v7, 4, v7
    v_lshlrev_b32 v6, 7, v6
    v_add_u32 v6, v6, v7
    s_lshl_b32 s45, s39, 11
    s_add_u32 s45, s45, 81920
    v_add_u32 v10, s45, v6
    v_xor_b32 v11, 64, v10
    s_mov_b32 s78, 0
    s_mov_b32 s54, 20480
    v_mov_b64 v[160:161], 0
    v_mov_b64 v[162:163], 0
    v_mov_b64 v[164:165], 0
    v_mov_b64 v[166:167], 0
    v_mov_b64 v[168:169], 0
    v_mov_b64 v[170:171], 0
    v_mov_b64 v[172:173], 0
    v_mov_b64 v[174:175], 0
    v_mov_b64 v[176:177], 0
    v_mov_b64 v[178:179], 0
    v_mov_b64 v[180:181], 0
    v_mov_b64 v[182:183], 0
    v_mov_b64 v[184:185], 0
    v_mov_b64 v[186:187], 0
    v_mov_b64 v[188:189], 0
    v_mov_b64 v[190:191], 0
    s_waitcnt vmcnt(0)
    s_barrier
    s_add_u32 s76, s66, s72
    s_add_u32 s77, s68, s73
    s_mov_b32 m0, s77
    s_add_u32 s66, s66, 128
    buffer_load_dwordx4 v32, s[8:11], s76 offen  lds
    s_cmp_eq_u32 s66, 1152
    s_cselect_b32 s66, 0, s66
    s_mov_b32 m0, s77
    s_nop 0
    buffer_load_dwordx4 v33, s[8:11], s76 offen offset:1024  lds
    s_mov_b32 m0, s77
    s_nop 0
    buffer_load_dwordx4 v34, s[8:11], s76 offen offset:2048  lds
    s_mov_b32 m0, s77
    s_nop 0
    buffer_load_dwordx4 v35, s[8:11], s76 offen offset:3072  lds
    s_add_u32 s77, s77, 4096
    s_mov_b32 m0, s77
    s_sub_u32 s68, 20480, s68
    buffer_load_dwordx4 v36, s[8:11], s76 offen  lds
    ds_read_b128 v[88:91], v10 offset:0
    ds_read_b128 v[92:95], v10 offset:2048
    ds_read_b64_tr_b16 v[56:57], v20
    ds_read_b64_tr_b16 v[58:59], v20 offset:1024
    ds_read_b64_tr_b16 v[60:61], v21
    ds_read_b64_tr_b16 v[62:63], v21 offset:1024
    ds_read_b64_tr_b16 v[64:65], v22
    ds_read_b64_tr_b16 v[66:67], v22 offset:1024
    ds_read_b64_tr_b16 v[68:69], v23
    ds_read_b64_tr_b16 v[70:71], v23 offset:1024
    s_add_u32 s78, s78, 8192
    s_mov_b32 s55, 8192
    s_cmp_eq_u32 s78, 32768
    s_cselect_b32 s78, 0, s78
    s_cselect_b32 s55, 4294942720, s55
    v_add_u32 v20, s55, v20
    v_add_u32 v21, s55, v21
    v_add_u32 v22, s55, v22
    v_add_u32 v23, s55, v23
    s_waitcnt lgkmcnt(0)
    s_mov_b32 s41, 0
L_q0_63:
    s_cmp_lg_u32 s41, 2
    s_cbranch_scc1 L_wo0_64
    v_lshlrev_b32 v7, 7, v1
    s_lshl_b32 s45, s38, 3
    s_add_u32 s45, s45, s35
    s_mul_i32 s45, s45, 36864
    s_mul_i32 s46, s37, 1179648
    s_add_u32 s45, s45, s46
    s_mul_i32 s47, s40, 9216
    s_add_u32 s47, s47, s45
    buffer_load_dword v40, v7, s[24:27], s47 offen
    s_add_u32 s47, s47, 1024
    buffer_load_dword v40, v7, s[24:27], s47 offen
L_wo0_64:
    s_barrier
    v_mfma_f32_16x16x32_bf16 v[160:163], v[56:59], v[88:91], v[160:163]
    ds_read_b128 v[100:103], v11 offset:0
    ds_read_b128 v[104:107], v11 offset:2048
    v_mfma_f32_16x16x32_bf16 v[176:179], v[56:59], v[92:95], v[176:179]
    ds_read_b64_tr_b16 v[72:73], v20
    ds_read_b64_tr_b16 v[74:75], v20 offset:1024
    v_mfma_f32_16x16x32_bf16 v[164:167], v[60:63], v[88:91], v[164:167]
    ds_read_b64_tr_b16 v[76:77], v21
    ds_read_b64_tr_b16 v[78:79], v21 offset:1024
    v_mfma_f32_16x16x32_bf16 v[180:183], v[60:63], v[92:95], v[180:183]
    ds_read_b64_tr_b16 v[80:81], v22
    ds_read_b64_tr_b16 v[82:83], v22 offset:1024
    v_mfma_f32_16x16x32_bf16 v[168:171], v[64:67], v[88:91], v[168:171]
    ds_read_b64_tr_b16 v[84:85], v23
    ds_read_b64_tr_b16 v[86:87], v23 offset:1024
    v_mfma_f32_16x16x32_bf16 v[184:187], v[64:67], v[92:95], v[184:187]
    v_mfma_f32_16x16x32_bf16 v[172:175], v[68:71], v[88:91], v[172:175]
    s_add_u32 s78, s78, 8192
    s_mov_b32 s55, 8192
    s_cmp_eq_u32 s78, 32768
    s_cselect_b32 s78, 0, s78
    s_cselect_b32 s55, 4294942720, s55
    v_add_u32 v20, s55, v20
    v_add_u32 v21, s55, v21
    v_mfma_f32_16x16x32_bf16 v[188:191], v[68:71], v[92:95], v[188:191]
    v_add_u32 v22, s55, v22
    v_add_u32 v23, s55, v23
    v_add_u32 v10, s54, v10
    v_add_u32 v11, s54, v11
    s_sub_u32 s54, 0, s54
    s_waitcnt lgkmcnt(0)
    s_cmp_eq_u32 s41, 2
    s_cbranch_scc1 L_xw_65
    s_waitcnt vmcnt(0)
    s_branch L_xw2_66
L_xw_65:
    s_waitcnt vmcnt(2)
L_xw2_66:
    s_barrier
    v_mfma_f32_16x16x32_bf16 v[160:163], v[72:75], v[100:103], v[160:163]
    ds_read_b128 v[88:91], v10 offset:0
    ds_read_b128 v[92:95], v10 offset:2048
    s_add_u32 s76, s66, s72
    s_add_u32 s77, s68, s73
    s_mov_b32 m0, s77
    s_add_u32 s66, s66, 128
    buffer_load_dwordx4 v32, s[8:11], s76 offen  lds
    s_cmp_eq_u32 s66, 1152
    s_cselect_b32 s66, 0, s66
    v_mfma_f32_16x16x32_bf16 v[176:179], v[72:75], v[104:107], v[176:179]
    ds_read_b64_tr_b16 v[56:57], v20
    ds_read_b64_tr_b16 v[58:59], v20 offset:1024
    v_mfma_f32_16x16x32_bf16 v[164:167], v[76:79], v[100:103], v[164:167]
    ds_read_b64_tr_b16 v[60:61], v21
    ds_read_b64_tr_b16 v[62:63], v21 offset:1024
    s_mov_b32 m0, s77
    s_nop 0
    buffer_load_dwordx4 v33, s[8:11], s76 offen offset:1024  lds
    v_mfma_f32_16x16x32_bf16 v[180:183], v[76:79], v[104:107], v[180:183]
    ds_read_b64_tr_b16 v[64:65], v22
    ds_read_b64_tr_b16 v[66:67], v22 offset:1024
    v_mfma_f32_16x16x32_bf16 v[168:171], v[80:83], v[100:103], v[168:171]
    ds_read_b64_tr_b16 v[68:69], v23
    ds_read_b64_tr_b16 v[70:71], v23 offset:1024
    s_mov_b32 m0, s77
    s_nop 0
    buffer_load_dwordx4 v34, s[8:11], s76 offen offset:2048  lds
    v_mfma_f32_16x16x32_bf16 v[184:187], v[80:83], v[104:107], v[184:187]
    s_mov_b32 m0, s77
    s_nop 0
    buffer_load_dwordx4 v35, s[8:11], s76 offen offset:3072  lds
    v_mfma_f32_16x16x32_bf16 v[172:175], v[84:87], v[100:103], v[172:175]
    s_add_u32 s78, s78, 8192
    s_mov_b32 s55, 8192
    s_cmp_eq_u32 s78, 32768
    s_cselect_b32 s78, 0, s78
    s_cselect_b32 s55, 4294942720, s55
    v_add_u32 v20, s55, v20
    v_add_u32 v21, s55, v21
    v_mfma_f32_16x16x32_bf16 v[188:191], v[84:87], v[104:107], v[188:191]
    v_add_u32 v22, s55, v22
    v_add_u32 v23, s55, v23
    s_add_u32 s77, s77, 4096
    s_mov_b32 m0, s77
    s_sub_u32 s68, 20480, s68
    buffer_load_dwordx4 v36, s[8:11], s76 offen  lds
    s_waitcnt lgkmcnt(0)
    s_add_u32 s41, s41, 1
    s_cmp_lt_u32 s41, 7
    s_cbranch_scc1 L_q0_63
    s_barrier
    v_mfma_f32_16x16x32_bf16 v[160:163], v[56:59], v[88:91], v[160:163]
    ds_read_b128 v[100:103], v11 offset:0
    ds_read_b128 v[104:107], v11 offset:2048
    v_mfma_f32_16x16x32_bf16 v[176:179], v[56:59], v[92:95], v[176:179]
    ds_read_b64_tr_b16 v[72:73], v20
    ds_read_b64_tr_b16 v[74:75], v20 offset:1024
    v_mfma_f32_16x16x32_bf16 v[164:167], v[60:63], v[88:91], v[164:167]
    ds_read_b64_tr_b16 v[76:77], v21
    ds_read_b64_tr_b16 v[78:79], v21 offset:1024
    v_mfma_f32_16x16x32_bf16 v[180:183], v[60:63], v[92:95], v[180:183]
    ds_read_b64_tr_b16 v[80:81], v22
    ds_read_b64_tr_b16 v[82:83], v22 offset:1024
    v_mfma_f32_16x16x32_bf16 v[168:171], v[64:67], v[88:91], v[168:171]
    ds_read_b64_tr_b16 v[84:85], v23
    ds_read_b64_tr_b16 v[86:87], v23 offset:1024
    v_mfma_f32_16x16x32_bf16 v[184:187], v[64:67], v[92:95], v[184:187]
    v_mfma_f32_16x16x32_bf16 v[172:175], v[68:71], v[88:91], v[172:175]
    s_add_u32 s78, s78, 8192
    s_mov_b32 s55, 8192
    s_cmp_eq_u32 s78, 32768
    s_cselect_b32 s78, 0, s78
    s_cselect_b32 s55, 4294942720, s55
    v_add_u32 v20, s55, v20
    v_add_u32 v21, s55, v21
    v_mfma_f32_16x16x32_bf16 v[188:191], v[68:71], v[92:95], v[188:191]
    v_add_u32 v22, s55, v22
    v_add_u32 v23, s55, v23
    v_add_u32 v10, s54, v10
    v_add_u32 v11, s54, v11
    s_sub_u32 s54, 0, s54
    s_waitcnt lgkmcnt(0)
    s_waitcnt vmcnt(0)
    s_barrier
    v_mfma_f32_16x16x32_bf16 v[160:163], v[72:75], v[100:103], v[160:163]
    ds_read_b128 v[88:91], v10 offset:0
    ds_read_b128 v[92:95], v10 offset:2048
    s_add_u32 s76, s66, s72
    s_add_u32 s77, s68, s73
    s_mov_b32 m0, s77
    s_add_u32 s66, s66, 128
    buffer_load_dwordx4 v32, s[8:11], s76 offen  lds
    s_cmp_eq_u32 s66, 1152
    s_cselect_b32 s66, 0, s66
    v_mfma_f32_16x16x32_bf16 v[176:179], v[72:75], v[104:107], v[176:179]
    ds_read_b64_tr_b16 v[56:57], v20
    ds_read_b64_tr_b16 v[58:59], v20 offset:1024
    s_mov_b32 m0, s77
    s_nop 0
    buffer_load_dwordx4 v33, s[8:11], s76 offen offset:1024  lds
    v_mfma_f32_16x16x32_bf16 v[164:167], v[76:79], v[100:103], v[164:167]
    ds_read_b64_tr_b16 v[60:61], v21
    ds_read_b64_tr_b16 v[62:63], v21 offset:1024
    s_mov_b32 m0, s77
    s_nop 0
    buffer_load_dwordx4 v34, s[8:11], s76 offen offset:2048  lds
    v_mfma_f32_16x16x32_bf16 v[180:183], v[76:79], v[104:107], v[180:183]
    ds_read_b64_tr_b16 v[64:65], v22
    ds_read_b64_tr_b16 v[66:67], v22 offset:1024
    s_mov_b32 m0, s77
    s_nop 0
    buffer_load_dwordx4 v35, s[8:11], s76 offen offset:3072  lds
    v_mfma_f32_16x16x32_bf16 v[168:171], v[80:83], v[100:103], v[168:171]
    ds_read_b64_tr_b16 v[68:69], v23
    ds_read_b64_tr_b16 v[70:71], v23 offset:1024
    s_add_u32 s77, s77, 4096
    s_mov_b32 m0, s77
    s_sub_u32 s68, 20480, s68
    buffer_load_dwordx4 v36, s[8:11], s76 offen  lds
    s_add_u32 s60, s43, s57
    s_add_u32 s61, s44, s57
    s_mov_b32 m0, s60
    v_xor_b32 v6, 64, v8
    buffer_load_dwordx4 v8, s[16:19], s61 offen nt lds
    v_mfma_f32_16x16x32_bf16 v[184:187], v[80:83], v[104:107], v[184:187]
    s_mov_b32 m0, s60
    s_nop 0
    buffer_load_dwordx4 v6, s[16:19], s61 offen offset:1024 nt lds
    v_mfma_f32_16x16x32_bf16 v[172:175], v[84:87], v[100:103], v[172:175]
    s_add_u32 s78, s78, 8192
    s_mov_b32 s55, 8192
    s_cmp_eq_u32 s78, 32768
    s_cselect_b32 s78, 0, s78
    s_cselect_b32 s55, 4294942720, s55
    v_add_u32 v20, s55, v20
    v_add_u32 v21, s55, v21
    s_add_u32 s60, s60, 8192
    s_mov_b32 m0, s60
    v_xor_b32 v7, 128, v9
    buffer_load_dwordx4 v9, s[20:23], s61 offen nt lds
    v_mfma_f32_16x16x32_bf16 v[188:191], v[84:87], v[104:107], v[188:191]
    v_add_u32 v22, s55, v22
    v_add_u32 v23, s55, v23
    s_mov_b32 m0, s60
    s_add_u32 s44, s44, 8192
    buffer_load_dwordx4 v7, s[20:23], s61 offen offset:1024 nt lds
    s_cmp_eq_u32 s44, 131072
    s_cselect_b32 s44, 524288, s44
    s_add_u32 s43, s43, 16384
    s_cmp_eq_u32 s43, 81920
    s_cselect_b32 s43, 0, s43
    s_waitcnt lgkmcnt(0)
    s_add_u32 s41, s41, 1
    s_barrier
    v_mfma_f32_16x16x32_bf16 v[160:163], v[56:59], v[88:91], v[160:163]
    ds_read_b128 v[100:103], v11 offset:0
    ds_read_b128 v[104:107], v11 offset:2048
    v_mfma_f32_16x16x32_bf16 v[176:179], v[56:59], v[92:95], v[176:179]
    ds_read_b64_tr_b16 v[72:73], v20
    ds_read_b64_tr_b16 v[74:75], v20 offset:1024
    s_add_u32 s60, s43, s57
    s_add_u32 s61, s44, s57
    s_mov_b32 m0, s60
    v_xor_b32 v6, 64, v8
    buffer_load_dwordx4 v8, s[16:19], s61 offen nt lds
    v_mfma_f32_16x16x32_bf16 v[164:167], v[60:63], v[88:91], v[164:167]
    ds_read_b64_tr_b16 v[76:77], v21
    ds_read_b64_tr_b16 v[78:79], v21 offset:1024
    v_mfma_f32_16x16x32_bf16 v[180:183], v[60:63], v[92:95], v[180:183]
    ds_read_b64_tr_b16 v[80:81], v22
    ds_read_b64_tr_b16 v[82:83], v22 offset:1024
    s_mov_b32 m0, s60
    s_nop 0
    buffer_load_dwordx4 v6, s[16:19], s61 offen offset:1024 nt lds
    v_mfma_f32_16x16x32_bf16 v[168:171], v[64:67], v[88:91], v[168:171]
    ds_read_b64_tr_b16 v[84:85], v23
    ds_read_b64_tr_b16 v[86:87], v23 offset:1024
    v_mfma_f32_16x16x32_bf16 v[184:187], v[64:67], v[92:95], v[184:187]
    s_add_u32 s60, s60, 8192
    s_mov_b32 m0, s60
    v_xor_b32 v7, 128, v9
    buffer_load_dwordx4 v9, s[20:23], s61 offen nt lds
    v_mfma_f32_16x16x32_bf16 v[172:175], v[68:71], v[88:91], v[172:175]
    s_add_u32 s78, s78, 8192
    s_mov_b32 s55, 8192
    s_cmp_eq_u32 s78, 32768
    s_cselect_b32 s78, 0, s78
    s_cselect_b32 s55, 4294942720, s55
    v_add_u32 v20, s55, v20
    v_add_u32 v21, s55, v21
    v_mfma_f32_16x16x32_bf16 v[188:191], v[68:71], v[92:95], v[188:191]
    v_add_u32 v22, s55, v22
    v_add_u32 v23, s55, v23
    v_add_u32 v10, s54, v10
    v_add_u32 v11, s54, v11
    s_sub_u32 s54, 0, s54
    s_mov_b32 m0, s60
    s_add_u32 s44, s44, 8192
    buffer_load_dwordx4 v7, s[20:23], s61 offen offset:1024 nt lds
    s_cmp_eq_u32 s44, 131072
    s_cselect_b32 s44, 524288, s44
    s_add_u32 s43, s43, 16384
    s_cmp_eq_u32 s43, 81920
    s_cselect_b32 s43, 0, s43
    s_waitcnt lgkmcnt(0)
    s_waitcnt vmcnt(8)
    s_barrier
    v_mfma_f32_16x16x32_bf16 v[160:163], v[72:75], v[100:103], v[160:163]
    s_add_u32 s76, s66, s72
    s_add_u32 s77, s68, s73
    s_mov_b32 m0, s77
    s_add_u32 s66, s66, 128
    buffer_load_dwordx4 v32, s[8:11], s76 offen  lds
    s_cmp_eq_u32 s66, 1152
    s_cselect_b32 s66, 0, s66
    v_mfma_f32_16x16x32_bf16 v[176:179], v[72:75], v[104:107], v[176:179]
    s_mov_b32 m0, s77
    s_nop 0
    buffer_load_dwordx4 v33, s[8:11], s76 offen offset:1024  lds
    v_mfma_f32_16x16x32_bf16 v[164:167], v[76:79], v[100:103], v[164:167]
    s_mov_b32 m0, s77
    s_nop 0
    buffer_load_dwordx4 v34, s[8:11], s76 offen offset:2048  lds
    v_mfma_f32_16x16x32_bf16 v[180:183], v[76:79], v[104:107], v[180:183]
    s_mov_b32 m0, s77
    s_nop 0
    buffer_load_dwordx4 v35, s[8:11], s76 offen offset:3072  lds
    v_mfma_f32_16x16x32_bf16 v[168:171], v[80:83], v[100:103], v[168:171]
    s_add_u32 s77, s77, 4096
    s_mov_b32 m0, s77
    s_sub_u32 s68, 20480, s68
    buffer_load_dwordx4 v36, s[8:11], s76 offen  lds
    s_add_u32 s60, s43, s57
    s_add_u32 s61, s44, s57
    s_mov_b32 m0, s60
    v_xor_b32 v6, 64, v8
    buffer_load_dwordx4 v8, s[16:19], s61 offen nt lds
    v_mfma_f32_16x16x32_bf16 v[184:187], v[80:83], v[104:107], v[184:187]
    s_mov_b32 m0, s60
    s_nop 0
    buffer_load_dwordx4 v6, s[16:19], s61 offen offset:1024 nt lds
    v_mfma_f32_16x16x32_bf16 v[172:175], v[84:87], v[100:103], v[172:175]
    s_add_u32 s60, s60, 8192
    s_mov_b32 m0, s60
    v_xor_b32 v7, 128, v9
    buffer_load_dwordx4 v9, s[20:23], s61 offen nt lds
    v_mfma_f32_16x16x32_bf16 v[188:191], v[84:87], v[104:107], v[188:191]
    s_mov_b32 m0, s60
    s_add_u32 s44, s44, 8192
    buffer_load_dwordx4 v7, s[20:23], s61 offen offset:1024 nt lds
    s_cmp_eq_u32 s44, 131072
    s_cselect_b32 s44, 524288, s44
    s_add_u32 s43, s43, 16384
    s_cmp_eq_u32 s43, 81920
    s_cselect_b32 s43, 0, s43
    s_waitcnt lgkmcnt(0)
    s_add_u32 s41, s41, 1
    s_mov_b32 s80, 0x3e0293ee
    s_mov_b32 s81, 0x3e0293ee
    s_nop 3
    v_pk_mul_f32 v[160:161], v[160:161], s[80:81]
    v_pk_mul_f32 v[162:163], v[162:163], s[80:81]
    v_pk_mul_f32 v[164:165], v[164:165], s[80:81]
    v_pk_mul_f32 v[166:167], v[166:167], s[80:81]
    v_cvt_pk_bf16_f32 v2, v160, v161
    v_cvt_pk_bf16_f32 v3, v162, v163
    v_cvt_pk_bf16_f32 v4, v164, v165
    v_cvt_pk_bf16_f32 v5, v166, v167
    v_cndmask_b32 v112, v2, v4, s[52:53]
    v_cndmask_b32 v113, v3, v5, s[52:53]
    v_cndmask_b32 v114, v4, v2, s[52:53]
    v_cndmask_b32 v115, v5, v3, s[52:53]
    v_pk_mul_f32 v[168:169], v[168:169], s[80:81]
    v_pk_mul_f32 v[170:171], v[170:171], s[80:81]
    v_pk_mul_f32 v[172:173], v[172:173], s[80:81]
    v_pk_mul_f32 v[174:175], v[174:175], s[80:81]
    v_cvt_pk_bf16_f32 v2, v168, v169
    v_cvt_pk_bf16_f32 v3, v170, v171
    v_cvt_pk_bf16_f32 v4, v172, v173
    v_cvt_pk_bf16_f32 v5, v174, v175
    v_cndmask_b32 v116, v2, v4, s[52:53]
    v_cndmask_b32 v117, v3, v5, s[52:53]
    v_cndmask_b32 v118, v4, v2, s[52:53]
    v_cndmask_b32 v119, v5, v3, s[52:53]
    v_pk_mul_f32 v[176:177], v[176:177], s[80:81]
    v_pk_mul_f32 v[178:179], v[178:179], s[80:81]
    v_pk_mul_f32 v[180:181], v[180:181], s[80:81]
    v_pk_mul_f32 v[182:183], v[182:183], s[80:81]
    v_cvt_pk_bf16_f32 v2, v176, v177
    v_cvt_pk_bf16_f32 v3, v178, v179
    v_cvt_pk_bf16_f32 v4, v180, v181
    v_cvt_pk_bf16_f32 v5, v182, v183
    v_cndmask_b32 v128, v2, v4, s[52:53]
    v_cndmask_b32 v129, v3, v5, s[52:53]
    v_cndmask_b32 v130, v4, v2, s[52:53]
    v_cndmask_b32 v131, v5, v3, s[52:53]
    v_pk_mul_f32 v[184:185], v[184:185], s[80:81]
    v_pk_mul_f32 v[186:187], v[186:187], s[80:81]
    v_pk_mul_f32 v[188:189], v[188:189], s[80:81]
    v_pk_mul_f32 v[190:191], v[190:191], s[80:81]
    v_cvt_pk_bf16_f32 v2, v184, v185
    v_cvt_pk_bf16_f32 v3, v186, v187
    v_cvt_pk_bf16_f32 v4, v188, v189
    v_cvt_pk_bf16_f32 v5, v190, v191
    v_cndmask_b32 v132, v2, v4, s[52:53]
    v_cndmask_b32 v133, v3, v5, s[52:53]
    v_cndmask_b32 v134, v4, v2, s[52:53]
    v_cndmask_b32 v135, v5, v3, s[52:53]
    v_lshrrev_b32 v2, 4, v1
    v_and_b32 v3, 15, v1
    v_xor_b32 v4, v2, v3
    v_lshlrev_b32 v4, 4, v4
    v_lshlrev_b32 v3, 8, v3
    v_add_u32 v6, v3, v4
    v_bfe_u32 v3, v1, 2, 2
    v_and_b32 v4, 3, v1
    v_lshlrev_b32 v0, 2, v2
    v_add_u32 v0, v0, v3
    v_and_b32 v2, 7, v0
    v_lshlrev_b32 v2, 1, v2
    v_lshrrev_b32 v3, 1, v4
    v_xor_b32 v2, v2, v3
    v_lshlrev_b32 v2, 4, v2
    v_lshlrev_b32 v0, 8, v0
    v_add_u32 v0, v0, v2
    v_and_b32 v2, 1, v4
    v_lshlrev_b32 v2, 3, v2
    v_add_u32 v0, v0, v2
    v_add_u32 v7, 8192, v0
    s_mov_b32 s51, 0x46800000
    s_mov_b32 s42, 0
    s_mov_b32 s56, 16384
    s_barrier
    v_mbcnt_lo_u32_b32 v2, -1, 0
    v_mbcnt_hi_u32_b32 v2, -1, v2
    v_lshlrev_b32 v2, 4, v2
    s_lshl_b32 s45, s39, 11
    s_add_u32 s45, s45, 61440
    v_add_u32 v2, s45, v2
    ds_read_b128 v[120:123], v2 offset:0
    ds_read_b128 v[124:127], v2 offset:1024
    ds_read_b128 v[136:139], v2 offset:2048
    ds_read_b128 v[140:143], v2 offset:3072
    s_waitcnt vmcnt(0)
    v_mov_b64 v[12:13], 0
    v_mov_b64 v[14:15], 0
    v_mov_b32 v8, 0
    v_mov_b64 v[16:17], 0
    v_mov_b64 v[18:19], 0
    v_mov_b32 v9, 0
    s_waitcnt lgkmcnt(0)
    s_cmp_lg_u32 s33, 0
    s_cbranch_scc1 L_frs2_67
    s_mov_b64 s[70:71], exec
    s_mov_b64 exec, 1
    s_lshl_b32 s45, s59, 2
    v_mov_b32 v2, s45
    v_mov_b32 v3, 1
    global_atomic_add v2, v3, s[4:5] sc1
    s_lshl_b32 s45, s48, 2
    v_mov_b32 v4, s45
    v_mov_b32 v5, 0x10000
    global_atomic_add v4, v5, s[4:5] sc1
    s_mov_b64 exec, s[70:71]
L_frs2_67:
    s_barrier
    v_add_u32 v4, s42, v6
    ds_read_b128 v[56:59], v4
    ds_read_b128 v[72:75], v4 offset:4096
    v_xor_b32 v1, 64, v4
    ds_read_b128 v[60:63], v1
    ds_read_b128 v[76:79], v1 offset:4096
    v_xor_b32 v0, 128, v4
    ds_read_b128 v[64:67], v0
    ds_read_b128 v[80:83], v0 offset:4096
    v_xor_b32 v1, 192, v4
    ds_read_b128 v[68:71], v1
    ds_read_b128 v[84:87], v1 offset:4096
    v_add_u32 v4, s42, v7
    ds_read_b64_tr_b16 v[24:25], v4
    ds_read_b64_tr_b16 v[26:27], v4 offset:4096
    v_xor_b32 v1, 32, v4
    ds_read_b64_tr_b16 v[28:29], v1
    ds_read_b64_tr_b16 v[30:31], v1 offset:4096
    v_xor_b32 v0, 64, v4
    ds_read_b64_tr_b16 v[32:33], v0
    ds_read_b64_tr_b16 v[34:35], v0 offset:4096
    v_xor_b32 v1, 96, v4
    ds_read_b64_tr_b16 v[36:37], v1
    ds_read_b64_tr_b16 v[38:39], v1 offset:4096
    v_xor_b32 v0, 128, v4
    ds_read_b64_tr_b16 v[40:41], v0
    ds_read_b64_tr_b16 v[42:43], v0 offset:4096
    v_xor_b32 v1, 160, v4
    ds_read_b64_tr_b16 v[44:45], v1
    ds_read_b64_tr_b16 v[46:47], v1 offset:4096
    v_xor_b32 v0, 192, v4
    ds_read_b64_tr_b16 v[48:49], v0
    ds_read_b64_tr_b16 v[50:51], v0 offset:4096
    v_xor_b32 v1, 224, v4
    ds_read_b64_tr_b16 v[52:53], v1
    ds_read_b64_tr_b16 v[54:55], v1 offset:4096
    s_waitcnt lgkmcnt(0)
    v_mfma_f32_16x16x32_bf16 v[88:91], v[56:59], v[112:115], v[12:15]
    v_mfma_f32_16x16x32_bf16 v[92:95], v[72:75], v[112:115], v[12:15]
    v_mfma_f32_16x16x32_bf16 v[88:91], v[60:63], v[116:119], v[88:91]
    v_mfma_f32_16x16x32_bf16 v[92:95], v[76:79], v[116:119], v[92:95]
    v_mfma_f32_16x16x32_bf16 v[88:91], v[64:67], v[120:123], v[88:91]
    v_mfma_f32_16x16x32_bf16 v[92:95], v[80:83], v[120:123], v[92:95]
    v_mfma_f32_16x16x32_bf16 v[88:91], v[68:71], v[124:127], v[88:91]
    v_mfma_f32_16x16x32_bf16 v[92:95], v[84:87], v[124:127], v[92:95]
    s_barrier
    s_mov_b32 s50, 0
    s_setprio 1
    s_mov_b32 s62, 0
L_rnd_76:
    s_nop 2
    v_max3_f32 v2, v88, v89, v90
    v_max3_f32 v2, v2, v91, v92
    v_max3_f32 v2, v2, v93, v94
    v_max_f32 v2, v2, v95
    v_mov_b32 v3, v2
    s_nop 1
    v_permlane16_swap_b32 v2, v3
    v_max_f32 v2, v2, v3
    v_mov_b32 v3, v2
    s_nop 1
    v_permlane32_swap_b32 v2, v3
    v_max_f32 v2, v2, v3
    v_sub_f32 v12, 0, v2
    v_sub_f32 v13, 0, v2
    v_sub_f32 v14, 0, v2
    v_sub_f32 v15, 0, v2
    v_sub_f32 v88, v88, v2
    v_sub_f32 v89, v89, v2
    v_sub_f32 v90, v90, v2
    v_sub_f32 v91, v91, v2
    v_sub_f32 v92, v92, v2
    v_sub_f32 v93, v93, v2
    v_sub_f32 v94, v94, v2
    v_sub_f32 v95, v95, v2
    v_mfma_f32_16x16x32_bf16 v[96:99], v[56:59], v[128:131], v[16:19]
    v_exp_f32 v88, v88
    v_exp_f32 v89, v89
    v_exp_f32 v90, v90
    v_mfma_f32_16x16x32_bf16 v[100:103], v[72:75], v[128:131], v[16:19]
    v_exp_f32 v91, v91
    v_exp_f32 v92, v92
    v_mfma_f32_16x16x32_bf16 v[96:99], v[60:63], v[132:135], v[96:99]
    v_exp_f32 v93, v93
    v_exp_f32 v94, v94
    v_exp_f32 v95, v95
    v_mfma_f32_16x16x32_bf16 v[100:103], v[76:79], v[132:135], v[100:103]
    v_add_f32 v0, v88, v89
    v_add_f32 v1, v90, v91
    v_mfma_f32_16x16x32_bf16 v[96:99], v[64:67], v[136:139], v[96:99]
    v_add_f32 v2, v92, v93
    v_add_f32 v3, v94, v95
    v_add_f32 v0, v0, v1
    v_mfma_f32_16x16x32_bf16 v[100:103], v[80:83], v[136:139], v[100:103]
    v_add_f32 v2, v2, v3
    v_cvt_pk_bf16_f32 v88, v88, v89
    v_mfma_f32_16x16x32_bf16 v[96:99], v[68:71], v[140:143], v[96:99]
    v_add_f32 v11, v0, v2
    v_cvt_pk_bf16_f32 v89, v90, v91
    v_cmp_lt_f32 vcc, s51, v11
    v_mfma_f32_16x16x32_bf16 v[100:103], v[84:87], v[140:143], v[100:103]
    v_cvt_pk_bf16_f32 v90, v92, v93
    v_cvt_pk_bf16_f32 v91, v94, v95
    s_cbranch_vccnz L_rare_72
L_rret_73:
    s_nop 0
    v_mfma_f32_16x16x32_bf16 v[160:163], v[24:27], v[88:91], 0
    v_add_u32 v4, s56, v6
    ds_read_b128 v[56:59], v4
    ds_read_b128 v[72:75], v4 offset:4096
    v_mfma_f32_16x16x32_bf16 v[164:167], v[28:31], v[88:91], 0
    v_add_f32 v8, v8, v11
    v_xor_b32 v1, 64, v4
    ds_read_b128 v[60:63], v1
    ds_read_b128 v[76:79], v1 offset:4096
    v_mfma_f32_16x16x32_bf16 v[168:171], v[32:35], v[88:91], 0
    v_xor_b32 v0, 128, v4
    ds_read_b128 v[64:67], v0
    ds_read_b128 v[80:83], v0 offset:4096
    v_mfma_f32_16x16x32_bf16 v[172:175], v[36:39], v[88:91], 0
    v_xor_b32 v1, 192, v4
    ds_read_b128 v[68:71], v1
    ds_read_b128 v[84:87], v1 offset:4096
    v_mfma_f32_16x16x32_bf16 v[176:179], v[40:43], v[88:91], 0
    v_mfma_f32_16x16x32_bf16 v[180:183], v[44:47], v[88:91], 0
    v_mfma_f32_16x16x32_bf16 v[184:187], v[48:51], v[88:91], 0
    v_mfma_f32_16x16x32_bf16 v[188:191], v[52:55], v[88:91], 0
    v_max3_f32 v2, v96, v97, v98
    v_max3_f32 v2, v2, v99, v100
    v_max3_f32 v2, v2, v101, v102
    v_max_f32 v2, v2, v103
    v_mov_b32 v3, v2
    s_nop 1
    v_permlane16_swap_b32 v2, v3
    v_max_f32 v2, v2, v3
    v_mov_b32 v3, v2
    s_nop 1
    v_permlane32_swap_b32 v2, v3
    v_max_f32 v2, v2, v3
    v_sub_f32 v16, 0, v2
    v_sub_f32 v17, 0, v2
    v_sub_f32 v18, 0, v2
    v_sub_f32 v19, 0, v2
    v_sub_f32 v96, v96, v2
    v_sub_f32 v97, v97, v2
    v_sub_f32 v98, v98, v2
    v_sub_f32 v99, v99, v2
    v_sub_f32 v100, v100, v2
    v_sub_f32 v101, v101, v2
    v_sub_f32 v102, v102, v2
    v_sub_f32 v103, v103, v2
    s_waitcnt lgkmcnt(7)
    v_mfma_f32_16x16x32_bf16 v[88:91], v[56:59], v[112:115], v[12:15]
    v_exp_f32 v96, v96
    v_exp_f32 v97, v97
    v_exp_f32 v98, v98
    s_waitcnt lgkmcnt(6)
    v_mfma_f32_16x16x32_bf16 v[92:95], v[72:75], v[112:115], v[12:15]
    v_exp_f32 v99, v99
    v_exp_f32 v100, v100
    s_waitcnt lgkmcnt(5)
    v_mfma_f32_16x16x32_bf16 v[88:91], v[60:63], v[116:119], v[88:91]
    v_exp_f32 v101, v101
    v_exp_f32 v102, v102
    v_exp_f32 v103, v103
    s_waitcnt lgkmcnt(4)
    v_mfma_f32_16x16x32_bf16 v[92:95], v[76:79], v[116:119], v[92:95]
    v_add_f32 v0, v96, v97
    v_add_f32 v1, v98, v99
    s_waitcnt lgkmcnt(3)
    v_mfma_f32_16x16x32_bf16 v[88:91], v[64:67], v[120:123], v[88:91]
    v_add_f32 v2, v100, v101
    v_add_f32 v3, v102, v103
    v_add_f32 v0, v0, v1
    s_waitcnt lgkmcnt(2)
    v_mfma_f32_16x16x32_bf16 v[92:95], v[80:83], v[120:123], v[92:95]
    v_add_f32 v2, v2, v3
    v_cvt_pk_bf16_f32 v96, v96, v97
    s_waitcnt lgkmcnt(1)
    v_mfma_f32_16x16x32_bf16 v[88:91], v[68:71], v[124:127], v[88:91]
    v_add_f32 v11, v0, v2
    v_cvt_pk_bf16_f32 v97, v98, v99
    v_cmp_lt_f32 vcc, s51, v11
    s_waitcnt lgkmcnt(0)
    v_mfma_f32_16x16x32_bf16 v[92:95], v[84:87], v[124:127], v[92:95]
    v_cvt_pk_bf16_f32 v98, v100, v101
    v_cvt_pk_bf16_f32 v99, v102, v103
    s_cbranch_vccnz L_rare_74
L_rret_75:
    s_nop 0
    v_mfma_f32_16x16x32_bf16 v[192:195], v[24:27], v[96:99], 0
    v_add_u32 v4, s56, v7
    ds_read_b64_tr_b16 v[24:25], v4
    ds_read_b64_tr_b16 v[26:27], v4 offset:4096
    v_mfma_f32_16x16x32_bf16 v[196:199], v[28:31], v[96:99], 0
    v_add_f32 v9, v9, v11
    v_xor_b32 v1, 32, v4
    ds_read_b64_tr_b16 v[28:29], v1
    ds_read_b64_tr_b16 v[30:31], v1 offset:4096
    v_mfma_f32_16x16x32_bf16 v[200:203], v[32:35], v[96:99], 0
    v_xor_b32 v0, 64, v4
    ds_read_b64_tr_b16 v[32:33], v0
    ds_read_b64_tr_b16 v[34:35], v0 offset:4096
    v_mfma_f32_16x16x32_bf16 v[204:207], v[36:39], v[96:99], 0
    v_xor_b32 v1, 96, v4
    ds_read_b64_tr_b16 v[36:37], v1
    ds_read_b64_tr_b16 v[38:39], v1 offset:4096
    v_mfma_f32_16x16x32_bf16 v[208:211], v[40:43], v[96:99], 0
    v_xor_b32 v0, 128, v4
    ds_read_b64_tr_b16 v[40:41], v0
    ds_read_b64_tr_b16 v[42:43], v0 offset:4096
    v_mfma_f32_16x16x32_bf16 v[212:215], v[44:47], v[96:99], 0
    v_xor_b32 v1, 160, v4
    ds_read_b64_tr_b16 v[44:45], v1
    ds_read_b64_tr_b16 v[46:47], v1 offset:4096
    v_mfma_f32_16x16x32_bf16 v[216:219], v[48:51], v[96:99], 0
    v_xor_b32 v0, 192, v4
    ds_read_b64_tr_b16 v[48:49], v0
    ds_read_b64_tr_b16 v[50:51], v0 offset:4096
    v_mfma_f32_16x16x32_bf16 v[220:223], v[52:55], v[96:99], 0
    v_xor_b32 v1, 224, v4
    ds_read_b64_tr_b16 v[52:53], v1
    ds_read_b64_tr_b16 v[54:55], v1 offset:4096
    s_mov_b32 s42, s56
    s_add_u32 s56, s56, 16384
    s_cmp_eq_u32 s56, 81920
    s_cselect_b32 s56, 0, s56
    s_add_u32 s62, s62, 1
    s_waitcnt lgkmcnt(0)
    s_barrier
L_att_77:
    v_mfma_f32_16x16x32_bf16 v[96:99], v[56:59], v[128:131], v[16:19]
    v_exp_f32 v88, v88
    v_exp_f32 v89, v89
    v_exp_f32 v90, v90
    v_mfma_f32_16x16x32_bf16 v[100:103], v[72:75], v[128:131], v[16:19]
    v_exp_f32 v91, v91
    v_exp_f32 v92, v92
    v_mfma_f32_16x16x32_bf16 v[96:99], v[60:63], v[132:135], v[96:99]
    v_exp_f32 v93, v93
    v_exp_f32 v94, v94
    v_exp_f32 v95, v95
    v_mfma_f32_16x16x32_bf16 v[100:103], v[76:79], v[132:135], v[100:103]
    v_add_f32 v0, v88, v89
    v_add_f32 v1, v90, v91
    v_mfma_f32_16x16x32_bf16 v[96:99], v[64:67], v[136:139], v[96:99]
    v_add_f32 v2, v92, v93
    v_add_f32 v3, v94, v95
    v_add_f32 v0, v0, v1
    v_mfma_f32_16x16x32_bf16 v[100:103], v[80:83], v[136:139], v[100:103]
    v_add_f32 v2, v2, v3
    v_cvt_pk_bf16_f32 v88, v88, v89
    v_mfma_f32_16x16x32_bf16 v[96:99], v[68:71], v[140:143], v[96:99]
    v_add_f32 v11, v0, v2
    v_cvt_pk_bf16_f32 v89, v90, v91
    v_cmp_lt_f32 vcc, s51, v11
    v_mfma_f32_16x16x32_bf16 v[100:103], v[84:87], v[140:143], v[100:103]
    v_cvt_pk_bf16_f32 v90, v92, v93
    v_cvt_pk_bf16_f32 v91, v94, v95
    s_cbranch_vccnz L_rare_68
L_rret_69:
    s_nop 0
    v_mfma_f32_16x16x32_bf16 v[160:163], v[24:27], v[88:91], v[160:163]
    v_add_u32 v4, s56, v6
    ds_read_b128 v[56:59], v4
    ds_read_b128 v[72:75], v4 offset:4096
    v_mfma_f32_16x16x32_bf16 v[164:167], v[28:31], v[88:91], v[164:167]
    v_add_f32 v8, v8, v11
    v_xor_b32 v1, 64, v4
    ds_read_b128 v[60:63], v1
    ds_read_b128 v[76:79], v1 offset:4096
    v_mfma_f32_16x16x32_bf16 v[168:171], v[32:35], v[88:91], v[168:171]
    v_xor_b32 v0, 128, v4
    ds_read_b128 v[64:67], v0
    ds_read_b128 v[80:83], v0 offset:4096
    v_mfma_f32_16x16x32_bf16 v[172:175], v[36:39], v[88:91], v[172:175]
    v_xor_b32 v1, 192, v4
    ds_read_b128 v[68:71], v1
    ds_read_b128 v[84:87], v1 offset:4096
    v_mfma_f32_16x16x32_bf16 v[176:179], v[40:43], v[88:91], v[176:179]
    v_mfma_f32_16x16x32_bf16 v[180:183], v[44:47], v[88:91], v[180:183]
    v_mfma_f32_16x16x32_bf16 v[184:187], v[48:51], v[88:91], v[184:187]
    v_mfma_f32_16x16x32_bf16 v[188:191], v[52:55], v[88:91], v[188:191]
    s_waitcnt lgkmcnt(7)
    v_mfma_f32_16x16x32_bf16 v[88:91], v[56:59], v[112:115], v[12:15]
    v_exp_f32 v96, v96
    v_exp_f32 v97, v97
    v_exp_f32 v98, v98
    s_waitcnt lgkmcnt(6)
    v_mfma_f32_16x16x32_bf16 v[92:95], v[72:75], v[112:115], v[12:15]
    v_exp_f32 v99, v99
    v_exp_f32 v100, v100
    s_waitcnt lgkmcnt(5)
    v_mfma_f32_16x16x32_bf16 v[88:91], v[60:63], v[116:119], v[88:91]
    v_exp_f32 v101, v101
    v_exp_f32 v102, v102
    v_exp_f32 v103, v103
    s_waitcnt lgkmcnt(4)
    v_mfma_f32_16x16x32_bf16 v[92:95], v[76:79], v[116:119], v[92:95]
    v_add_f32 v0, v96, v97
    v_add_f32 v1, v98, v99
    s_waitcnt lgkmcnt(3)
    v_mfma_f32_16x16x32_bf16 v[88:91], v[64:67], v[120:123], v[88:91]
    v_add_f32 v2, v100, v101
    v_add_f32 v3, v102, v103
    v_add_f32 v0, v0, v1
    s_waitcnt lgkmcnt(2)
    v_mfma_f32_16x16x32_bf16 v[92:95], v[80:83], v[120:123], v[92:95]
    v_add_f32 v2, v2, v3
    v_cvt_pk_bf16_f32 v96, v96, v97
    s_waitcnt lgkmcnt(1)
    v_mfma_f32_16x16x32_bf16 v[88:91], v[68:71], v[124:127], v[88:91]
    v_add_f32 v11, v0, v2
    v_cvt_pk_bf16_f32 v97, v98, v99
    v_cmp_lt_f32 vcc, s51, v11
    s_waitcnt lgkmcnt(0)
    v_mfma_f32_16x16x32_bf16 v[92:95], v[84:87], v[124:127], v[92:95]
    v_cvt_pk_bf16_f32 v98, v100, v101
    v_cvt_pk_bf16_f32 v99, v102, v103
    s_cbranch_vccnz L_rare_70
L_rret_71:
    s_nop 0
    v_mfma_f32_16x16x32_bf16 v[192:195], v[24:27], v[96:99], v[192:195]
    v_add_u32 v4, s56, v7
    ds_read_b64_tr_b16 v[24:25], v4
    ds_read_b64_tr_b16 v[26:27], v4 offset:4096
    v_mfma_f32_16x16x32_bf16 v[196:199], v[28:31], v[96:99], v[196:199]
    v_add_f32 v9, v9, v11
    v_xor_b32 v1, 32, v4
    ds_read_b64_tr_b16 v[28:29], v1
    ds_read_b64_tr_b16 v[30:31], v1 offset:4096
    v_mfma_f32_16x16x32_bf16 v[200:203], v[32:35], v[96:99], v[200:203]
    v_xor_b32 v0, 64, v4
    ds_read_b64_tr_b16 v[32:33], v0
    ds_read_b64_tr_b16 v[34:35], v0 offset:4096
    v_mfma_f32_16x16x32_bf16 v[204:207], v[36:39], v[96:99], v[204:207]
    v_xor_b32 v1, 96, v4
    ds_read_b64_tr_b16 v[36:37], v1
    ds_read_b64_tr_b16 v[38:39], v1 offset:4096
    v_mfma_f32_16x16x32_bf16 v[208:211], v[40:43], v[96:99], v[208:211]
    v_xor_b32 v0, 128, v4
    ds_read_b64_tr_b16 v[40:41], v0
    ds_read_b64_tr_b16 v[42:43], v0 offset:4096
    v_mfma_f32_16x16x32_bf16 v[212:215], v[44:47], v[96:99], v[212:215]
    v_xor_b32 v1, 160, v4
    ds_read_b64_tr_b16 v[44:45], v1
    ds_read_b64_tr_b16 v[46:47], v1 offset:4096
    v_mfma_f32_16x16x32_bf16 v[216:219], v[48:51], v[96:99], v[216:219]
    v_xor_b32 v0, 192, v4
    ds_read_b64_tr_b16 v[48:49], v0
    ds_read_b64_tr_b16 v[50:51], v0 offset:4096
    v_mfma_f32_16x16x32_bf16 v[220:223], v[52:55], v[96:99], v[220:223]
    v_xor_b32 v1, 224, v4
    ds_read_b64_tr_b16 v[52:53], v1
    ds_read_b64_tr_b16 v[54:55], v1 offset:4096
    s_mov_b32 s42, s56
    s_add_u32 s56, s56, 16384
    s_cmp_eq_u32 s56, 81920
    s_cselect_b32 s56, 0, s56
    s_waitcnt lgkmcnt(0)
    s_cmp_eq_u32 s62, 17
    s_cbranch_scc1 L_sg_78
    s_barrier
L_sgr_79:
    s_add_u32 s62, s62, 1
    s_and_b32 s45, s62, 15
    s_cbranch_scc1 L_att_77
    v_mbcnt_lo_u32_b32 v1, -1, 0
    v_mbcnt_hi_u32_b32 v1, -1, v1
    v_lshlrev_b32 v26, 4, v1
    s_cmp_eq_u32 s50, 1
    s_cbranch_scc1 L_atail_80
    s_nop 7
    v_mov_b32 v88, v8
    s_nop 1
    v_permlane16_swap_b32 v8, v88
    v_add_f32 v8, v8, v88
    v_mov_b32 v88, v8
    s_nop 1
    v_permlane32_swap_b32 v8, v88
    v_add_f32 v8, v8, v88
    v_mov_b32 v89, v9
    s_nop 1
    v_permlane16_swap_b32 v9, v89
    v_add_f32 v9, v9, v89
    v_mov_b32 v89, v9
    s_nop 1
    v_permlane32_swap_b32 v9, v89
    v_add_f32 v9, v9, v89
    v_rcp_f32 v92, v8
    v_rcp_f32 v94, v9
    v_pk_mul_f32 v[160:161], v[160:161], v[92:93] op_sel_hi:[1,0]
    v_pk_mul_f32 v[162:163], v[162:163], v[92:93] op_sel_hi:[1,0]
    v_pk_mul_f32 v[164:165], v[164:165], v[92:93] op_sel_hi:[1,0]
    v_pk_mul_f32 v[166:167], v[166:167], v[92:93] op_sel_hi:[1,0]
    v_cvt_pk_bf16_f32 v112, v160, v161
    v_cvt_pk_bf16_f32 v113, v162, v163
    v_cvt_pk_bf16_f32 v114, v164, v165
    v_cvt_pk_bf16_f32 v115, v166, v167
    v_pk_mul_f32 v[168:169], v[168:169], v[92:93] op_sel_hi:[1,0]
    v_pk_mul_f32 v[170:171], v[170:171], v[92:93] op_sel_hi:[1,0]
    v_pk_mul_f32 v[172:173], v[172:173], v[92:93] op_sel_hi:[1,0]
    v_pk_mul_f32 v[174:175], v[174:175], v[92:93] op_sel_hi:[1,0]
    v_cvt_pk_bf16_f32 v116, v168, v169
    v_cvt_pk_bf16_f32 v117, v170, v171
    v_cvt_pk_bf16_f32 v118, v172, v173
    v_cvt_pk_bf16_f32 v119, v174, v175
    v_pk_mul_f32 v[176:177], v[176:177], v[92:93] op_sel_hi:[1,0]
    v_pk_mul_f32 v[178:179], v[178:179], v[92:93] op_sel_hi:[1,0]
    v_pk_mul_f32 v[180:181], v[180:181], v[92:93] op_sel_hi:[1,0]
    v_pk_mul_f32 v[182:183], v[182:183], v[92:93] op_sel_hi:[1,0]
    v_cvt_pk_bf16_f32 v120, v176, v177
    v_cvt_pk_bf16_f32 v121, v178, v179
    v_cvt_pk_bf16_f32 v122, v180, v181
    v_cvt_pk_bf16_f32 v123, v182, v183
    v_pk_mul_f32 v[184:185], v[184:185], v[92:93] op_sel_hi:[1,0]
    v_pk_mul_f32 v[186:187], v[186:187], v[92:93] op_sel_hi:[1,0]
    v_pk_mul_f32 v[188:189], v[188:189], v[92:93] op_sel_hi:[1,0]
    v_pk_mul_f32 v[190:191], v[190:191], v[92:93] op_sel_hi:[1,0]
    v_cvt_pk_bf16_f32 v124, v184, v185
    v_cvt_pk_bf16_f32 v125, v186, v187
    v_cvt_pk_bf16_f32 v126, v188, v189
    v_cvt_pk_bf16_f32 v127, v190, v191
    v_pk_mul_f32 v[192:193], v[192:193], v[94:95] op_sel_hi:[1,0]
    v_pk_mul_f32 v[194:195], v[194:195], v[94:95] op_sel_hi:[1,0]
    v_pk_mul_f32 v[196:197], v[196:197], v[94:95] op_sel_hi:[1,0]
    v_pk_mul_f32 v[198:199], v[198:199], v[94:95] op_sel_hi:[1,0]
    v_cvt_pk_bf16_f32 v128, v192, v193
    v_cvt_pk_bf16_f32 v129, v194, v195
    v_cvt_pk_bf16_f32 v130, v196, v197
    v_cvt_pk_bf16_f32 v131, v198, v199
    v_pk_mul_f32 v[200:201], v[200:201], v[94:95] op_sel_hi:[1,0]
    v_pk_mul_f32 v[202:203], v[202:203], v[94:95] op_sel_hi:[1,0]
    v_pk_mul_f32 v[204:205], v[204:205], v[94:95] op_sel_hi:[1,0]
    v_pk_mul_f32 v[206:207], v[206:207], v[94:95] op_sel_hi:[1,0]
    v_cvt_pk_bf16_f32 v132, v200, v201
    v_cvt_pk_bf16_f32 v133, v202, v203
    v_cvt_pk_bf16_f32 v134, v204, v205
    v_cvt_pk_bf16_f32 v135, v206, v207
    v_pk_mul_f32 v[208:209], v[208:209], v[94:95] op_sel_hi:[1,0]
    v_pk_mul_f32 v[210:211], v[210:211], v[94:95] op_sel_hi:[1,0]
    v_pk_mul_f32 v[212:213], v[212:213], v[94:95] op_sel_hi:[1,0]
    v_pk_mul_f32 v[214:215], v[214:215], v[94:95] op_sel_hi:[1,0]
    v_cvt_pk_bf16_f32 v136, v208, v209
    v_cvt_pk_bf16_f32 v137, v210, v211
    v_cvt_pk_bf16_f32 v138, v212, v213
    v_cvt_pk_bf16_f32 v139, v214, v215
    v_pk_mul_f32 v[216:217], v[216:217], v[94:95] op_sel_hi:[1,0]
    v_pk_mul_f32 v[218:219], v[218:219], v[94:95] op_sel_hi:[1,0]
    v_pk_mul_f32 v[220:221], v[220:221], v[94:95] op_sel_hi:[1,0]
    v_pk_mul_f32 v[222:223], v[222:223], v[94:95] op_sel_hi:[1,0]
    v_cvt_pk_bf16_f32 v140, v216, v217
    v_cvt_pk_bf16_f32 v141, v218, v219
    v_cvt_pk_bf16_f32 v142, v220, v221
    v_cvt_pk_bf16_f32 v143, v222, v223
    s_lshl_b32 s45, s34, 3
    s_add_u32 s45, s45, s35
    s_lshl_b32 s45, s45, 5
    s_lshl_b32 s46, s50, 2
    s_add_u32 s45, s45, s46
    s_add_u32 s45, s45, s36
    s_mul_i32 s45, s45, 40
    s_add_u32 s45, s45, s39
    s_lshl_b32 s58, s45, 10
    s_add_u32 s45, s58, 0
    buffer_store_dwordx4 v[112:115], v26, s[28:31], s45 offen sc1
    s_add_u32 s45, s58, 10240
    buffer_store_dwordx4 v[116:119], v26, s[28:31], s45 offen sc1
    s_add_u32 s45, s58, 20480
    buffer_store_dwordx4 v[120:123], v26, s[28:31], s45 offen sc1
    s_add_u32 s45, s58, 30720
    buffer_store_dwordx4 v[124:127], v26, s[28:31], s45 offen sc1
    s_add_u32 s45, s58, 1024
    buffer_store_dwordx4 v[128:131], v26, s[28:31], s45 offen sc1
    s_add_u32 s45, s58, 11264
    buffer_store_dwordx4 v[132:135], v26, s[28:31], s45 offen sc1
    s_add_u32 s45, s58, 21504
    buffer_store_dwordx4 v[136:139], v26, s[28:31], s45 offen sc1
    s_add_u32 s45, s58, 31744
    buffer_store_dwordx4 v[140:143], v26, s[28:31], s45 offen sc1
    s_barrier
    s_lshl_b32 s45, s39, 12
    s_add_u32 s45, s45, 81920
    v_add_u32 v2, s45, v26
    ds_read_b128 v[112:115], v2 offset:0
    ds_read_b128 v[116:119], v2 offset:1024
    ds_read_b128 v[120:123], v2 offset:2048
    ds_read_b128 v[124:127], v2 offset:3072
    ds_read_b128 v[128:131], v2 offset:4096
    ds_read_b128 v[132:135], v2 offset:5120
    ds_read_b128 v[136:139], v2 offset:6144
    ds_read_b128 v[140:143], v2 offset:7168
    v_mov_b64 v[12:13], 0
    v_mov_b64 v[14:15], 0
    v_mov_b32 v8, 0
    v_mov_b64 v[16:17], 0
    v_mov_b64 v[18:19], 0
    v_mov_b32 v9, 0
    v_add_u32 v4, s42, v7
    ds_read_b64_tr_b16 v[24:25], v4
    ds_read_b64_tr_b16 v[26:27], v4 offset:4096
    v_xor_b32 v1, 32, v4
    ds_read_b64_tr_b16 v[28:29], v1
    ds_read_b64_tr_b16 v[30:31], v1 offset:4096
    v_xor_b32 v0, 64, v4
    ds_read_b64_tr_b16 v[32:33], v0
    ds_read_b64_tr_b16 v[34:35], v0 offset:4096
    v_xor_b32 v1, 96, v4
    ds_read_b64_tr_b16 v[36:37], v1
    ds_read_b64_tr_b16 v[38:39], v1 offset:4096
    v_xor_b32 v0, 128, v4
    ds_read_b64_tr_b16 v[40:41], v0
    ds_read_b64_tr_b16 v[42:43], v0 offset:4096
    v_xor_b32 v1, 160, v4
    ds_read_b64_tr_b16 v[44:45], v1
    ds_read_b64_tr_b16 v[46:47], v1 offset:4096
    v_xor_b32 v0, 192, v4
    ds_read_b64_tr_b16 v[48:49], v0
    ds_read_b64_tr_b16 v[50:51], v0 offset:4096
    v_xor_b32 v1, 224, v4
    ds_read_b64_tr_b16 v[52:53], v1
    ds_read_b64_tr_b16 v[54:55], v1 offset:4096
    s_waitcnt lgkmcnt(0)
    s_nop 1
    v_mfma_f32_16x16x32_bf16 v[88:91], v[56:59], v[112:115], v[12:15]
    v_mfma_f32_16x16x32_bf16 v[92:95], v[72:75], v[112:115], v[12:15]
    v_mfma_f32_16x16x32_bf16 v[88:91], v[60:63], v[116:119], v[88:91]
    v_mfma_f32_16x16x32_bf16 v[92:95], v[76:79], v[116:119], v[92:95]
    v_mfma_f32_16x16x32_bf16 v[88:91], v[64:67], v[120:123], v[88:91]
    v_mfma_f32_16x16x32_bf16 v[92:95], v[80:83], v[120:123], v[92:95]
    v_mfma_f32_16x16x32_bf16 v[88:91], v[68:71], v[124:127], v[88:91]
    v_mfma_f32_16x16x32_bf16 v[92:95], v[84:87], v[124:127], v[92:95]
    s_mov_b32 s50, 1
    s_branch L_rnd_76
L_sg_78:
    s_waitcnt vmcnt(0)
    s_barrier
    s_cmp_lg_u32 s33, 0
    s_cbranch_scc1 L_sig_81
    v_mov_b32 v2, 0
    v_mov_b32 v3, 1
    s_mov_b64 s[70:71], exec
    s_mov_b64 exec, 1
    buffer_store_dword v3, v2, s[28:31], s49 offen sc0 sc1
    s_mov_b64 exec, s[70:71]
L_sig_81:
    s_branch L_sgr_79
L_atail_80:
    v_mbcnt_lo_u32_b32 v1, -1, 0
    v_mbcnt_hi_u32_b32 v1, -1, v1
    v_lshlrev_b32 v26, 4, v1
    s_setprio 0
    s_mov_b32 s79, 1
    s_waitcnt vmcnt(0)
    s_barrier
    s_nop 7
    v_mov_b32 v88, v8
    s_nop 1
    v_permlane16_swap_b32 v8, v88
    v_add_f32 v8, v8, v88
    v_mov_b32 v88, v8
    s_nop 1
    v_permlane32_swap_b32 v8, v88
    v_add_f32 v8, v8, v88
    v_mov_b32 v89, v9
    s_nop 1
    v_permlane16_swap_b32 v9, v89
    v_add_f32 v9, v9, v89
    v_mov_b32 v89, v9
    s_nop 1
    v_permlane32_swap_b32 v9, v89
    v_add_f32 v9, v9, v89
    v_rcp_f32 v92, v8
    v_rcp_f32 v94, v9
    v_pk_mul_f32 v[160:161], v[160:161], v[92:93] op_sel_hi:[1,0]
    v_pk_mul_f32 v[162:163], v[162:163], v[92:93] op_sel_hi:[1,0]
    v_pk_mul_f32 v[164:165], v[164:165], v[92:93] op_sel_hi:[1,0]
    v_pk_mul_f32 v[166:167], v[166:167], v[92:93] op_sel_hi:[1,0]
    v_cvt_pk_bf16_f32 v112, v160, v161
    v_cvt_pk_bf16_f32 v113, v162, v163
    v_cvt_pk_bf16_f32 v114, v164, v165
    v_cvt_pk_bf16_f32 v115, v166, v167
    v_pk_mul_f32 v[168:169], v[168:169], v[92:93] op_sel_hi:[1,0]
    v_pk_mul_f32 v[170:171], v[170:171], v[92:93] op_sel_hi:[1,0]
    v_pk_mul_f32 v[172:173], v[172:173], v[92:93] op_sel_hi:[1,0]
    v_pk_mul_f32 v[174:175], v[174:175], v[92:93] op_sel_hi:[1,0]
    v_cvt_pk_bf16_f32 v116, v168, v169
    v_cvt_pk_bf16_f32 v117, v170, v171
    v_cvt_pk_bf16_f32 v118, v172, v173
    v_cvt_pk_bf16_f32 v119, v174, v175
    v_pk_mul_f32 v[176:177], v[176:177], v[92:93] op_sel_hi:[1,0]
    v_pk_mul_f32 v[178:179], v[178:179], v[92:93] op_sel_hi:[1,0]
    v_pk_mul_f32 v[180:181], v[180:181], v[92:93] op_sel_hi:[1,0]
    v_pk_mul_f32 v[182:183], v[182:183], v[92:93] op_sel_hi:[1,0]
    v_cvt_pk_bf16_f32 v120, v176, v177
    v_cvt_pk_bf16_f32 v121, v178, v179
    v_cvt_pk_bf16_f32 v122, v180, v181
    v_cvt_pk_bf16_f32 v123, v182, v183
    v_pk_mul_f32 v[184:185], v[184:185], v[92:93] op_sel_hi:[1,0]
    v_pk_mul_f32 v[186:187], v[186:187], v[92:93] op_sel_hi:[1,0]
    v_pk_mul_f32 v[188:189], v[188:189], v[92:93] op_sel_hi:[1,0]
    v_pk_mul_f32 v[190:191], v[190:191], v[92:93] op_sel_hi:[1,0]
    v_cvt_pk_bf16_f32 v124, v184, v185
    v_cvt_pk_bf16_f32 v125, v186, v187
    v_cvt_pk_bf16_f32 v126, v188, v189
    v_cvt_pk_bf16_f32 v127, v190, v191
    v_pk_mul_f32 v[192:193], v[192:193], v[94:95] op_sel_hi:[1,0]
    v_pk_mul_f32 v[194:195], v[194:195], v[94:95] op_sel_hi:[1,0]
    v_pk_mul_f32 v[196:197], v[196:197], v[94:95] op_sel_hi:[1,0]
    v_pk_mul_f32 v[198:199], v[198:199], v[94:95] op_sel_hi:[1,0]
    v_cvt_pk_bf16_f32 v128, v192, v193
    v_cvt_pk_bf16_f32 v129, v194, v195
    v_cvt_pk_bf16_f32 v130, v196, v197
    v_cvt_pk_bf16_f32 v131, v198, v199
    v_pk_mul_f32 v[200:201], v[200:201], v[94:95] op_sel_hi:[1,0]
    v_pk_mul_f32 v[202:203], v[202:203], v[94:95] op_sel_hi:[1,0]
    v_pk_mul_f32 v[204:205], v[204:205], v[94:95] op_sel_hi:[1,0]
    v_pk_mul_f32 v[206:207], v[206:207], v[94:95] op_sel_hi:[1,0]
    v_cvt_pk_bf16_f32 v132, v200, v201
    v_cvt_pk_bf16_f32 v133, v202, v203
    v_cvt_pk_bf16_f32 v134, v204, v205
    v_cvt_pk_bf16_f32 v135, v206, v207
    v_pk_mul_f32 v[208:209], v[208:209], v[94:95] op_sel_hi:[1,0]
    v_pk_mul_f32 v[210:211], v[210:211], v[94:95] op_sel_hi:[1,0]
    v_pk_mul_f32 v[212:213], v[212:213], v[94:95] op_sel_hi:[1,0]
    v_pk_mul_f32 v[214:215], v[214:215], v[94:95] op_sel_hi:[1,0]
    v_cvt_pk_bf16_f32 v136, v208, v209
    v_cvt_pk_bf16_f32 v137, v210, v211
    v_cvt_pk_bf16_f32 v138, v212, v213
    v_cvt_pk_bf16_f32 v139, v214, v215
    v_pk_mul_f32 v[216:217], v[216:217], v[94:95] op_sel_hi:[1,0]
    v_pk_mul_f32 v[218:219], v[218:219], v[94:95] op_sel_hi:[1,0]
    v_pk_mul_f32 v[220:221], v[220:221], v[94:95] op_sel_hi:[1,0]
    v_pk_mul_f32 v[222:223], v[222:223], v[94:95] op_sel_hi:[1,0]
    v_cvt_pk_bf16_f32 v140, v216, v217
    v_cvt_pk_bf16_f32 v141, v218, v219
    v_cvt_pk_bf16_f32 v142, v220, v221
    v_cvt_pk_bf16_f32 v143, v222, v223
    s_lshl_b32 s45, s34, 3
    s_add_u32 s45, s45, s35
    s_lshl_b32 s45, s45, 5
    s_lshl_b32 s46, s50, 2
    s_add_u32 s45, s45, s46
    s_add_u32 s45, s45, s36
    s_mul_i32 s45, s45, 40
    s_add_u32 s45, s45, s39
    s_lshl_b32 s58, s45, 10
    v_lshrrev_b32 v2, 4, v1
    v_bfe_u32 v3, v1, 2, 2
    v_lshlrev_b32 v2, 2, v2
    v_add_u32 v2, v2, v3
    v_mul_u32_u24 v2, 288, v2
    v_and_b32 v3, 3, v1
    v_lshlrev_b32 v3, 3, v3
    v_add_u32 v2, v2, v3
    v_add_u32 v24, 10240, v2
    s_lshl_b32 s45, s39, 10
    v_add_u32 v25, s45, v26
    v_mov_b64 v[160:161], 0
    v_mov_b64 v[162:163], 0
    v_mov_b64 v[164:165], 0
    v_mov_b64 v[166:167], 0
    v_mov_b64 v[168:169], 0
    v_mov_b64 v[170:171], 0
    v_mov_b64 v[172:173], 0
    v_mov_b64 v[174:175], 0
    v_mov_b64 v[176:177], 0
    v_mov_b64 v[178:179], 0
    v_mov_b64 v[180:181], 0
    v_mov_b64 v[182:183], 0
    v_mov_b64 v[184:185], 0
    v_mov_b64 v[186:187], 0
    v_mov_b64 v[188:189], 0
    v_mov_b64 v[190:191], 0
    v_mov_b64 v[192:193], 0
    v_mov_b64 v[194:195], 0
    v_mov_b64 v[196:197], 0
    v_mov_b64 v[198:199], 0
    s_mov_b32 s77, 81920
    v_add_u32 v2, s77, v24
    v_add_u32 v3, s77, v25
    s_add_u32 s77, s77, 20480
    s_cmp_eq_u32 s77, 163840
    s_cselect_b32 s77, 0, s77
    ds_read_b128 v[56:59], v3 offset:0
    ds_read_b128 v[60:63], v3 offset:1024
    ds_read_b64_tr_b16 v[80:81], v2 offset:0
    ds_read_b64_tr_b16 v[82:83], v2 offset:4608
    ds_read_b64_tr_b16 v[84:85], v2 offset:32
    ds_read_b64_tr_b16 v[86:87], v2 offset:4640
    ds_read_b64_tr_b16 v[88:89], v2 offset:64
    ds_read_b64_tr_b16 v[90:91], v2 offset:4672
    ds_read_b64_tr_b16 v[92:93], v2 offset:96
    ds_read_b64_tr_b16 v[94:95], v2 offset:4704
    ds_read_b64_tr_b16 v[96:97], v2 offset:128
    ds_read_b64_tr_b16 v[98:99], v2 offset:4736
    s_waitcnt lgkmcnt(0)
    s_barrier
    v_mfma_f32_16x16x32_bf16 v[160:163], v[80:83], v[56:59], v[160:163]
    v_add_u32 v4, s77, v24
    v_add_u32 v5, s77, v25
    s_add_u32 s77, s77, 20480
    s_cmp_eq_u32 s77, 163840
    s_cselect_b32 s77, 0, s77
    v_mfma_f32_16x16x32_bf16 v[180:183], v[80:83], v[60:63], v[180:183]
    ds_read_b128 v[68:71], v5 offset:0
    v_mfma_f32_16x16x32_bf16 v[164:167], v[84:87], v[56:59], v[164:167]
    ds_read_b128 v[72:75], v5 offset:1024
    v_mfma_f32_16x16x32_bf16 v[184:187], v[84:87], v[60:63], v[184:187]
    ds_read_b64_tr_b16 v[220:221], v4 offset:0
    ds_read_b64_tr_b16 v[222:223], v4 offset:4608
    s_add_u32 s45, s58, 0
    buffer_store_dwordx4 v[112:115], v26, s[28:31], s45 offen sc1
    v_mfma_f32_16x16x32_bf16 v[168:171], v[88:91], v[56:59], v[168:171]
    ds_read_b64_tr_b16 v[224:225], v4 offset:32
    ds_read_b64_tr_b16 v[226:227], v4 offset:4640
    v_mfma_f32_16x16x32_bf16 v[188:191], v[88:91], v[60:63], v[188:191]
    ds_read_b64_tr_b16 v[228:229], v4 offset:64
    ds_read_b64_tr_b16 v[230:231], v4 offset:4672
    v_mfma_f32_16x16x32_bf16 v[172:175], v[92:95], v[56:59], v[172:175]
    ds_read_b64_tr_b16 v[232:233], v4 offset:96
    ds_read_b64_tr_b16 v[234:235], v4 offset:4704
    v_mfma_f32_16x16x32_bf16 v[192:195], v[92:95], v[60:63], v[192:195]
    ds_read_b64_tr_b16 v[236:237], v4 offset:128
    ds_read_b64_tr_b16 v[238:239], v4 offset:4736
    v_mfma_f32_16x16x32_bf16 v[176:179], v[96:99], v[56:59], v[176:179]
    s_add_u32 s45, s58, 10240
    buffer_store_dwordx4 v[116:119], v26, s[28:31], s45 offen sc1
    v_mfma_f32_16x16x32_bf16 v[196:199], v[96:99], v[60:63], v[196:199]
    s_waitcnt lgkmcnt(8)
    v_mfma_f32_16x16x32_bf16 v[160:163], v[220:223], v[68:71], v[160:163]
    v_add_u32 v2, s77, v24
    v_add_u32 v3, s77, v25
    s_add_u32 s77, s77, 20480
    s_cmp_eq_u32 s77, 163840
    s_cselect_b32 s77, 0, s77
    v_mfma_f32_16x16x32_bf16 v[180:183], v[220:223], v[72:75], v[180:183]
    ds_read_b128 v[56:59], v3 offset:0
    s_waitcnt lgkmcnt(7)
    v_mfma_f32_16x16x32_bf16 v[164:167], v[224:227], v[68:71], v[164:167]
    ds_read_b128 v[60:63], v3 offset:1024
    v_mfma_f32_16x16x32_bf16 v[184:187], v[224:227], v[72:75], v[184:187]
    ds_read_b64_tr_b16 v[80:81], v2 offset:0
    ds_read_b64_tr_b16 v[82:83], v2 offset:4608
    s_add_u32 s45, s58, 20480
    buffer_store_dwordx4 v[120:123], v26, s[28:31], s45 offen sc1
    s_waitcnt lgkmcnt(8)
    v_mfma_f32_16x16x32_bf16 v[168:171], v[228:231], v[68:71], v[168:171]
    ds_read_b64_tr_b16 v[84:85], v2 offset:32
    ds_read_b64_tr_b16 v[86:87], v2 offset:4640
    v_mfma_f32_16x16x32_bf16 v[188:191], v[228:231], v[72:75], v[188:191]
    ds_read_b64_tr_b16 v[88:89], v2 offset:64
    ds_read_b64_tr_b16 v[90:91], v2 offset:4672
    s_waitcnt lgkmcnt(10)
    v_mfma_f32_16x16x32_bf16 v[172:175], v[232:235], v[68:71], v[172:175]
    ds_read_b64_tr_b16 v[92:93], v2 offset:96
    ds_read_b64_tr_b16 v[94:95], v2 offset:4704
    v_mfma_f32_16x16x32_bf16 v[192:195], v[232:235], v[72:75], v[192:195]
    ds_read_b64_tr_b16 v[96:97], v2 offset:128
    ds_read_b64_tr_b16 v[98:99], v2 offset:4736
    s_waitcnt lgkmcnt(12)
    v_mfma_f32_16x16x32_bf16 v[176:179], v[236:239], v[68:71], v[176:179]
    s_add_u32 s45, s58, 30720
    buffer_store_dwordx4 v[124:127], v26, s[28:31], s45 offen sc1
    v_mfma_f32_16x16x32_bf16 v[196:199], v[236:239], v[72:75], v[196:199]
    s_waitcnt lgkmcnt(0)
    s_barrier
    v_mfma_f32_16x16x32_bf16 v[160:163], v[80:83], v[56:59], v[160:163]
    v_add_u32 v4, s77, v24
    v_add_u32 v5, s77, v25
    s_add_u32 s77, s77, 20480
    s_cmp_eq_u32 s77, 163840
    s_cselect_b32 s77, 0, s77
    v_mfma_f32_16x16x32_bf16 v[180:183], v[80:83], v[60:63], v[180:183]
    ds_read_b128 v[68:71], v5 offset:0
    v_mfma_f32_16x16x32_bf16 v[164:167], v[84:87], v[56:59], v[164:167]
    ds_read_b128 v[72:75], v5 offset:1024
    v_mfma_f32_16x16x32_bf16 v[184:187], v[84:87], v[60:63], v[184:187]
    ds_read_b64_tr_b16 v[220:221], v4 offset:0
    ds_read_b64_tr_b16 v[222:223], v4 offset:4608
    s_add_u32 s45, s58, 1024
    buffer_store_dwordx4 v[128:131], v26, s[28:31], s45 offen sc1
    v_mfma_f32_16x16x32_bf16 v[168:171], v[88:91], v[56:59], v[168:171]
    ds_read_b64_tr_b16 v[224:225], v4 offset:32
    ds_read_b64_tr_b16 v[226:227], v4 offset:4640
    v_mfma_f32_16x16x32_bf16 v[188:191], v[88:91], v[60:63], v[188:191]
    ds_read_b64_tr_b16 v[228:229], v4 offset:64
    ds_read_b64_tr_b16 v[230:231], v4 offset:4672
    v_mfma_f32_16x16x32_bf16 v[172:175], v[92:95], v[56:59], v[172:175]
    ds_read_b64_tr_b16 v[232:233], v4 offset:96
    ds_read_b64_tr_b16 v[234:235], v4 offset:4704
    v_mfma_f32_16x16x32_bf16 v[192:195], v[92:95], v[60:63], v[192:195]
    ds_read_b64_tr_b16 v[236:237], v4 offset:128
    ds_read_b64_tr_b16 v[238:239], v4 offset:4736
    v_mfma_f32_16x16x32_bf16 v[176:179], v[96:99], v[56:59], v[176:179]
    s_add_u32 s45, s58, 11264
    buffer_store_dwordx4 v[132:135], v26, s[28:31], s45 offen sc1
    v_mfma_f32_16x16x32_bf16 v[196:199], v[96:99], v[60:63], v[196:199]
    s_waitcnt lgkmcnt(8)
    v_mfma_f32_16x16x32_bf16 v[160:163], v[220:223], v[68:71], v[160:163]
    v_add_u32 v2, s77, v24
    v_add_u32 v3, s77, v25
    s_add_u32 s77, s77, 20480
    s_cmp_eq_u32 s77, 163840
    s_cselect_b32 s77, 0, s77
    v_mfma_f32_16x16x32_bf16 v[180:183], v[220:223], v[72:75], v[180:183]
    ds_read_b128 v[56:59], v3 offset:0
    s_waitcnt lgkmcnt(7)
    v_mfma_f32_16x16x32_bf16 v[164:167], v[224:227], v[68:71], v[164:167]
    ds_read_b128 v[60:63], v3 offset:1024
    v_mfma_f32_16x16x32_bf16 v[184:187], v[224:227], v[72:75], v[184:187]
    ds_read_b64_tr_b16 v[80:81], v2 offset:0
    ds_read_b64_tr_b16 v[82:83], v2 offset:4608
    s_add_u32 s45, s58, 21504
    buffer_store_dwordx4 v[136:139], v26, s[28:31], s45 offen sc1
    s_waitcnt lgkmcnt(8)
    v_mfma_f32_16x16x32_bf16 v[168:171], v[228:231], v[68:71], v[168:171]
    ds_read_b64_tr_b16 v[84:85], v2 offset:32
    ds_read_b64_tr_b16 v[86:87], v2 offset:4640
    v_mfma_f32_16x16x32_bf16 v[188:191], v[228:231], v[72:75], v[188:191]
    ds_read_b64_tr_b16 v[88:89], v2 offset:64
    ds_read_b64_tr_b16 v[90:91], v2 offset:4672
    s_waitcnt lgkmcnt(10)
    v_mfma_f32_16x16x32_bf16 v[172:175], v[232:235], v[68:71], v[172:175]
    ds_read_b64_tr_b16 v[92:93], v2 offset:96
    ds_read_b64_tr_b16 v[94:95], v2 offset:4704
    v_mfma_f32_16x16x32_bf16 v[192:195], v[232:235], v[72:75], v[192:195]
    ds_read_b64_tr_b16 v[96:97], v2 offset:128
    ds_read_b64_tr_b16 v[98:99], v2 offset:4736
    s_waitcnt lgkmcnt(12)
    v_mfma_f32_16x16x32_bf16 v[176:179], v[236:239], v[68:71], v[176:179]
    s_add_u32 s45, s58, 31744
    buffer_store_dwordx4 v[140:143], v26, s[28:31], s45 offen sc1
    v_mfma_f32_16x16x32_bf16 v[196:199], v[236:239], v[72:75], v[196:199]
    s_waitcnt lgkmcnt(0)
    s_mov_b32 s41, 4
L_op_82:
    s_barrier
    s_cmp_lg_u32 s41, 8
    s_cbranch_scc1 L_k6_84
    s_cmp_lg_u32 s33, 0
    s_cbranch_scc1 L_sig_85
    v_mov_b32 v2, 0
    v_mov_b32 v3, 3
    s_mov_b64 s[70:71], exec
    s_mov_b64 exec, 1
    buffer_store_dword v3, v2, s[28:31], s49 offen sc0 sc1
    s_mov_b64 exec, s[70:71]
L_sig_85:
L_k6_84:
    s_cmp_lg_u32 s41, 10
    s_cbranch_scc1 L_k10_86
    s_cmp_lg_u32 s33, 4
    s_cbranch_scc1 L_polld_88
    s_and_b32 s45, s49, 0xffffff00
    v_mov_b32 v2, 0
    s_mov_b32 s46, 0
L_poll_87:
    buffer_load_dwordx4 v[4:7], v2, s[28:31], s45 offen sc0 sc1
    s_waitcnt vmcnt(0)
    v_and_b32 v4, v4, v5
    v_and_b32 v6, v6, v7
    v_and_b32 v4, v4, v6
    s_nop 0
    v_readfirstlane_b32 s47, v4
    s_add_u32 s46, s46, 1
    s_and_b32 s47, s47, 2
    s_cmp_eq_u32 s47, 2
    s_cbranch_scc1 L_polld_88
    s_sleep 2
    s_cmp_lt_u32 s46, 200000
    s_cbranch_scc1 L_poll_87
L_polld_88:
    s_barrier
L_k10_86:
    v_mfma_f32_16x16x32_bf16 v[160:163], v[80:83], v[56:59], v[160:163]
    v_add_u32 v4, s77, v24
    v_add_u32 v5, s77, v25
    s_add_u32 s77, s77, 20480
    s_cmp_eq_u32 s77, 163840
    s_cselect_b32 s77, 0, s77
    v_mfma_f32_16x16x32_bf16 v[180:183], v[80:83], v[60:63], v[180:183]
    ds_read_b128 v[68:71], v5 offset:0
    v_mfma_f32_16x16x32_bf16 v[164:167], v[84:87], v[56:59], v[164:167]
    ds_read_b128 v[72:75], v5 offset:1024
    v_mfma_f32_16x16x32_bf16 v[184:187], v[84:87], v[60:63], v[184:187]
    ds_read_b64_tr_b16 v[220:221], v4 offset:0
    ds_read_b64_tr_b16 v[222:223], v4 offset:4608
    v_mfma_f32_16x16x32_bf16 v[168:171], v[88:91], v[56:59], v[168:171]
    ds_read_b64_tr_b16 v[224:225], v4 offset:32
    ds_read_b64_tr_b16 v[226:227], v4 offset:4640
    v_mfma_f32_16x16x32_bf16 v[188:191], v[88:91], v[60:63], v[188:191]
    ds_read_b64_tr_b16 v[228:229], v4 offset:64
    ds_read_b64_tr_b16 v[230:231], v4 offset:4672
    v_mfma_f32_16x16x32_bf16 v[172:175], v[92:95], v[56:59], v[172:175]
    ds_read_b64_tr_b16 v[232:233], v4 offset:96
    ds_read_b64_tr_b16 v[234:235], v4 offset:4704
    v_mfma_f32_16x16x32_bf16 v[192:195], v[92:95], v[60:63], v[192:195]
    ds_read_b64_tr_b16 v[236:237], v4 offset:128
    ds_read_b64_tr_b16 v[238:239], v4 offset:4736
    v_mfma_f32_16x16x32_bf16 v[176:179], v[96:99], v[56:59], v[176:179]
    v_mfma_f32_16x16x32_bf16 v[196:199], v[96:99], v[60:63], v[196:199]
    s_waitcnt lgkmcnt(8)
    v_mfma_f32_16x16x32_bf16 v[160:163], v[220:223], v[68:71], v[160:163]
    v_add_u32 v2, s77, v24
    v_add_u32 v3, s77, v25
    s_add_u32 s77, s77, 20480
    s_cmp_eq_u32 s77, 163840
    s_cselect_b32 s77, 0, s77
    v_mfma_f32_16x16x32_bf16 v[180:183], v[220:223], v[72:75], v[180:183]
    ds_read_b128 v[56:59], v3 offset:0
    s_waitcnt lgkmcnt(7)
    v_mfma_f32_16x16x32_bf16 v[164:167], v[224:227], v[68:71], v[164:167]
    ds_read_b128 v[60:63], v3 offset:1024
    v_mfma_f32_16x16x32_bf16 v[184:187], v[224:227], v[72:75], v[184:187]
    ds_read_b64_tr_b16 v[80:81], v2 offset:0
    ds_read_b64_tr_b16 v[82:83], v2 offset:4608
    s_waitcnt lgkmcnt(8)
    v_mfma_f32_16x16x32_bf16 v[168:171], v[228:231], v[68:71], v[168:171]
    ds_read_b64_tr_b16 v[84:85], v2 offset:32
    ds_read_b64_tr_b16 v[86:87], v2 offset:4640
    v_mfma_f32_16x16x32_bf16 v[188:191], v[228:231], v[72:75], v[188:191]
    ds_read_b64_tr_b16 v[88:89], v2 offset:64
    ds_read_b64_tr_b16 v[90:91], v2 offset:4672
    s_waitcnt lgkmcnt(10)
    v_mfma_f32_16x16x32_bf16 v[172:175], v[232:235], v[68:71], v[172:175]
    ds_read_b64_tr_b16 v[92:93], v2 offset:96
    ds_read_b64_tr_b16 v[94:95], v2 offset:4704
    v_mfma_f32_16x16x32_bf16 v[192:195], v[232:235], v[72:75], v[192:195]
    ds_read_b64_tr_b16 v[96:97], v2 offset:128
    ds_read_b64_tr_b16 v[98:99], v2 offset:4736
    s_waitcnt lgkmcnt(12)
    v_mfma_f32_16x16x32_bf16 v[176:179], v[236:239], v[68:71], v[176:179]
    v_mfma_f32_16x16x32_bf16 v[196:199], v[236:239], v[72:75], v[196:199]
    s_waitcnt lgkmcnt(0)
    s_cmp_lg_u32 s41, 6
    s_cbranch_scc1 L_k4_89
    s_waitcnt vmcnt(0)
L_k4_89:
    s_add_u32 s41, s41, 2
    s_cmp_lt_u32 s41, 32
    s_cbranch_scc1 L_op_82
    s_nop 7
    s_mul_i32 s66, s39, 3
    s_lshr_b32 s66, s66, 3
    s_lshl_b32 s78, s48, 8
    s_lshl_b32 s46, s37, 2
    s_add_u32 s78, s78, s46
    s_add_u32 s78, s78, 117456896
    s_lshl_b32 s67, s48, 4
    s_add_u32 s67, s67, s66
    s_lshl_b32 s67, s67, 1
    s_add_u32 s67, s67, s79
    s_lshl_b32 s67, s67, 13
    s_add_u32 s67, s67, 67108864
    s_cmp_eq_u32 s66, s37
    s_cbranch_scc1 L_keep_90
    v_cvt_pk_bf16_f32 v56, v160, v161
    v_cvt_pk_bf16_f32 v57, v162, v163
    v_cvt_pk_bf16_f32 v58, v164, v165
    v_cvt_pk_bf16_f32 v59, v166, v167
    v_cvt_pk_bf16_f32 v60, v168, v169
    v_cvt_pk_bf16_f32 v61, v170, v171
    v_cvt_pk_bf16_f32 v62, v172, v173
    v_cvt_pk_bf16_f32 v63, v174, v175
    v_cvt_pk_bf16_f32 v64, v176, v177
    v_cvt_pk_bf16_f32 v65, v178, v179
    v_cvt_pk_bf16_f32 v66, v180, v181
    v_cvt_pk_bf16_f32 v67, v182, v183
    v_cvt_pk_bf16_f32 v68, v184, v185
    v_cvt_pk_bf16_f32 v69, v186, v187
    v_cvt_pk_bf16_f32 v70, v188, v189
    v_cvt_pk_bf16_f32 v71, v190, v191
    v_cvt_pk_bf16_f32 v72, v192, v193
    v_cvt_pk_bf16_f32 v73, v194, v195
    v_cvt_pk_bf16_f32 v74, v196, v197
    v_cvt_pk_bf16_f32 v75, v198, v199
    s_lshl_b32 s45, s37, 16
    s_add_u32 s45, s45, s67
    s_add_u32 s46, s45, 0
    buffer_store_dwordx4 v[56:59], v26, s[28:31], s46 offen sc0 sc1
    s_add_u32 s46, s45, 1024
    buffer_store_dwordx4 v[60:63], v26, s[28:31], s46 offen sc0 sc1
    s_add_u32 s46, s45, 2048
    buffer_store_dwordx4 v[64:67], v26, s[28:31], s46 offen sc0 sc1
    s_add_u32 s46, s45, 3072
    buffer_store_dwordx4 v[68:71], v26, s[28:31], s46 offen sc0 sc1
    s_add_u32 s46, s45, 4096
    buffer_store_dwordx4 v[72:75], v26, s[28:31], s46 offen sc0 sc1
L_keep_90:
    s_waitcnt vmcnt(0)
    s_barrier
    s_cmp_lg_u32 s33, 0
    s_cbranch_scc1 L_sig_93
    v_mov_b32 v2, 0
    v_mov_b32 v3, 1
    s_mov_b64 s[70:71], exec
    s_mov_b64 exec, 1
    buffer_store_dword v3, v2, s[28:31], s78 offen sc0 sc1
    s_mov_b64 exec, s[70:71]
L_sig_93:
    s_cmp_lg_u32 s33, 0
    s_cbranch_scc1 L_polld_95
    s_and_b32 s45, s78, 0xffffff00
    v_mov_b32 v2, 0
    s_mov_b32 s46, 0
L_poll_94:
    buffer_load_dwordx4 v[4:7], v2, s[28:31], s45 offen sc0 sc1
    s_waitcnt vmcnt(0)
    v_and_b32 v4, v4, v5
    v_and_b32 v6, v6, v7
    v_and_b32 v4, v4, v6
    s_nop 0
    v_readfirstlane_b32 s47, v4
    s_add_u32 s46, s46, 1
    s_and_b32 s47, s47, 1
    s_cmp_eq_u32 s47, 1
    s_cbranch_scc1 L_polld_95
    s_sleep 2
    s_cmp_lt_u32 s46, 200000
    s_cbranch_scc1 L_poll_94
L_polld_95:
    s_barrier
    s_cmp_lg_u32 s66, s37
    s_cbranch_scc1 L_s2e_92
    s_add_u32 s45, s37, 1
    s_and_b32 s45, s45, 3
    s_lshl_b32 s45, s45, 16
    s_add_u32 s45, s45, s67
    s_add_u32 s46, s45, 0
    buffer_load_dwordx4 v[56:59], v26, s[28:31], s46 offen sc0 sc1
    s_add_u32 s46, s45, 1024
    buffer_load_dwordx4 v[60:63], v26, s[28:31], s46 offen sc0 sc1
    s_add_u32 s46, s45, 2048
    buffer_load_dwordx4 v[64:67], v26, s[28:31], s46 offen sc0 sc1
    s_add_u32 s46, s45, 3072
    buffer_load_dwordx4 v[68:71], v26, s[28:31], s46 offen sc0 sc1
    s_add_u32 s46, s45, 4096
    buffer_load_dwordx4 v[72:75], v26, s[28:31], s46 offen sc0 sc1
    s_add_u32 s45, s37, 2
    s_and_b32 s45, s45, 3
    s_lshl_b32 s45, s45, 16
    s_add_u32 s45, s45, s67
    s_add_u32 s46, s45, 0
    buffer_load_dwordx4 v[88:91], v26, s[28:31], s46 offen sc0 sc1
    s_add_u32 s46, s45, 1024
    buffer_load_dwordx4 v[92:95], v26, s[28:31], s46 offen sc0 sc1
    s_add_u32 s46, s45, 2048
    buffer_load_dwordx4 v[96:99], v26, s[28:31], s46 offen sc0 sc1
    s_add_u32 s46, s45, 3072
    buffer_load_dwordx4 v[100:103], v26, s[28:31], s46 offen sc0 sc1
    s_add_u32 s46, s45, 4096
    buffer_load_dwordx4 v[104:107], v26, s[28:31], s46 offen sc0 sc1
    s_add_u32 s45, s37, 3
    s_and_b32 s45, s45, 3
    s_lshl_b32 s45, s45, 16
    s_add_u32 s45, s45, s67
    s_add_u32 s46, s45, 0
    buffer_load_dwordx4 v[120:123], v26, s[28:31], s46 offen sc0 sc1
    s_add_u32 s46, s45, 1024
    buffer_load_dwordx4 v[124:127], v26, s[28:31], s46 offen sc0 sc1
    s_add_u32 s46, s45, 2048
    buffer_load_dwordx4 v[128:131], v26, s[28:31], s46 offen sc0 sc1
    s_add_u32 s46, s45, 3072
    buffer_load_dwordx4 v[132:135], v26, s[28:31], s46 offen sc0 sc1
    s_add_u32 s46, s45, 4096
    buffer_load_dwordx4 v[136:139], v26, s[28:31], s46 offen sc0 sc1
    s_load_dwordx2 s[80:81], s[0:1], 80
    v_and_b32 v2, 15, v1
    v_mul_u32_u24 v2, 2304, v2
    v_lshrrev_b32 v3, 4, v1
    v_lshlrev_b32 v3, 3, v3
    v_add_u32 v2, v2, v3
    s_mul_i32 s45, s35, 160
    s_lshl_b32 s46, s39, 4
    s_add_u32 s45, s45, s46
    s_mul_i32 s45, s45, 2304
    s_mul_i32 s46, s34, 1152
    s_add_u32 s45, s45, s46
    s_mul_i32 s46, s38, 288
    s_add_u32 s45, s45, s46
    s_waitcnt lgkmcnt(0)
    s_mov_b32 s16, s80
    s_mov_b32 s17, s81
    s_mov_b32 s18, 2949120
    s_mov_b32 s19, 0x20000
    s_waitcnt vmcnt(10)
    v_lshlrev_b32 v4, 16, v56
    v_and_b32 v5, 0xffff0000, v56
    v_add_f32 v160, v160, v4
    v_add_f32 v161, v161, v5
    v_lshlrev_b32 v4, 16, v57
    v_and_b32 v5, 0xffff0000, v57
    v_add_f32 v162, v162, v4
    v_add_f32 v163, v163, v5
    v_lshlrev_b32 v4, 16, v58
    v_and_b32 v5, 0xffff0000, v58
    v_add_f32 v164, v164, v4
    v_add_f32 v165, v165, v5
    v_lshlrev_b32 v4, 16, v59
    v_and_b32 v5, 0xffff0000, v59
    v_add_f32 v166, v166, v4
    v_add_f32 v167, v167, v5
    v_lshlrev_b32 v4, 16, v60
    v_and_b32 v5, 0xffff0000, v60
    v_add_f32 v168, v168, v4
    v_add_f32 v169, v169, v5
    v_lshlrev_b32 v4, 16, v61
    v_and_b32 v5, 0xffff0000, v61
    v_add_f32 v170, v170, v4
    v_add_f32 v171, v171, v5
    v_lshlrev_b32 v4, 16, v62
    v_and_b32 v5, 0xffff0000, v62
    v_add_f32 v172, v172, v4
    v_add_f32 v173, v173, v5
    v_lshlrev_b32 v4, 16, v63
    v_and_b32 v5, 0xffff0000, v63
    v_add_f32 v174, v174, v4
    v_add_f32 v175, v175, v5
    v_lshlrev_b32 v4, 16, v64
    v_and_b32 v5, 0xffff0000, v64
    v_add_f32 v176, v176, v4
    v_add_f32 v177, v177, v5
    v_lshlrev_b32 v4, 16, v65
    v_and_b32 v5, 0xffff0000, v65
    v_add_f32 v178, v178, v4
    v_add_f32 v179, v179, v5
    v_lshlrev_b32 v4, 16, v66
    v_and_b32 v5, 0xffff0000, v66
    v_add_f32 v180, v180, v4
    v_add_f32 v181, v181, v5
    v_lshlrev_b32 v4, 16, v67
    v_and_b32 v5, 0xffff0000, v67
    v_add_f32 v182, v182, v4
    v_add_f32 v183, v183, v5
    v_lshlrev_b32 v4, 16, v68
    v_and_b32 v5, 0xffff0000, v68
    v_add_f32 v184, v184, v4
    v_add_f32 v185, v185, v5
    v_lshlrev_b32 v4, 16, v69
    v_and_b32 v5, 0xffff0000, v69
    v_add_f32 v186, v186, v4
    v_add_f32 v187, v187, v5
    v_lshlrev_b32 v4, 16, v70
    v_and_b32 v5, 0xffff0000, v70
    v_add_f32 v188, v188, v4
    v_add_f32 v189, v189, v5
    v_lshlrev_b32 v4, 16, v71
    v_and_b32 v5, 0xffff0000, v71
    v_add_f32 v190, v190, v4
    v_add_f32 v191, v191, v5
    v_lshlrev_b32 v4, 16, v72
    v_and_b32 v5, 0xffff0000, v72
    v_add_f32 v192, v192, v4
    v_add_f32 v193, v193, v5
    v_lshlrev_b32 v4, 16, v73
    v_and_b32 v5, 0xffff0000, v73
    v_add_f32 v194, v194, v4
    v_add_f32 v195, v195, v5
    v_lshlrev_b32 v4, 16, v74
    v_and_b32 v5, 0xffff0000, v74
    v_add_f32 v196, v196, v4
    v_add_f32 v197, v197, v5
    v_lshlrev_b32 v4, 16, v75
    v_and_b32 v5, 0xffff0000, v75
    v_add_f32 v198, v198, v4
    v_add_f32 v199, v199, v5
    s_waitcnt vmcnt(5)
    v_lshlrev_b32 v4, 16, v88
    v_and_b32 v5, 0xffff0000, v88
    v_add_f32 v160, v160, v4
    v_add_f32 v161, v161, v5
    v_lshlrev_b32 v4, 16, v89
    v_and_b32 v5, 0xffff0000, v89
    v_add_f32 v162, v162, v4
    v_add_f32 v163, v163, v5
    v_lshlrev_b32 v4, 16, v90
    v_and_b32 v5, 0xffff0000, v90
    v_add_f32 v164, v164, v4
    v_add_f32 v165, v165, v5
    v_lshlrev_b32 v4, 16, v91
    v_and_b32 v5, 0xffff0000, v91
    v_add_f32 v166, v166, v4
    v_add_f32 v167, v167, v5
    v_lshlrev_b32 v4, 16, v92
    v_and_b32 v5, 0xffff0000, v92
    v_add_f32 v168, v168, v4
    v_add_f32 v169, v169, v5
    v_lshlrev_b32 v4, 16, v93
    v_and_b32 v5, 0xffff0000, v93
    v_add_f32 v170, v170, v4
    v_add_f32 v171, v171, v5
    v_lshlrev_b32 v4, 16, v94
    v_and_b32 v5, 0xffff0000, v94
    v_add_f32 v172, v172, v4
    v_add_f32 v173, v173, v5
    v_lshlrev_b32 v4, 16, v95
    v_and_b32 v5, 0xffff0000, v95
    v_add_f32 v174, v174, v4
    v_add_f32 v175, v175, v5
    v_lshlrev_b32 v4, 16, v96
    v_and_b32 v5, 0xffff0000, v96
    v_add_f32 v176, v176, v4
    v_add_f32 v177, v177, v5
    v_lshlrev_b32 v4, 16, v97
    v_and_b32 v5, 0xffff0000, v97
    v_add_f32 v178, v178, v4
    v_add_f32 v179, v179, v5
    v_lshlrev_b32 v4, 16, v98
    v_and_b32 v5, 0xffff0000, v98
    v_add_f32 v180, v180, v4
    v_add_f32 v181, v181, v5
    v_lshlrev_b32 v4, 16, v99
    v_and_b32 v5, 0xffff0000, v99
    v_add_f32 v182, v182, v4
    v_add_f32 v183, v183, v5
    v_lshlrev_b32 v4, 16, v100
    v_and_b32 v5, 0xffff0000, v100
    v_add_f32 v184, v184, v4
    v_add_f32 v185, v185, v5
    v_lshlrev_b32 v4, 16, v101
    v_and_b32 v5, 0xffff0000, v101
    v_add_f32 v186, v186, v4
    v_add_f32 v187, v187, v5
    v_lshlrev_b32 v4, 16, v102
    v_and_b32 v5, 0xffff0000, v102
    v_add_f32 v188, v188, v4
    v_add_f32 v189, v189, v5
    v_lshlrev_b32 v4, 16, v103
    v_and_b32 v5, 0xffff0000, v103
    v_add_f32 v190, v190, v4
    v_add_f32 v191, v191, v5
    v_lshlrev_b32 v4, 16, v104
    v_and_b32 v5, 0xffff0000, v104
    v_add_f32 v192, v192, v4
    v_add_f32 v193, v193, v5
    v_lshlrev_b32 v4, 16, v105
    v_and_b32 v5, 0xffff0000, v105
    v_add_f32 v194, v194, v4
    v_add_f32 v195, v195, v5
    v_lshlrev_b32 v4, 16, v106
    v_and_b32 v5, 0xffff0000, v106
    v_add_f32 v196, v196, v4
    v_add_f32 v197, v197, v5
    v_lshlrev_b32 v4, 16, v107
    v_and_b32 v5, 0xffff0000, v107
    v_add_f32 v198, v198, v4
    v_add_f32 v199, v199, v5
    s_waitcnt vmcnt(0)
    v_lshlrev_b32 v4, 16, v120
    v_and_b32 v5, 0xffff0000, v120
    v_add_f32 v160, v160, v4
    v_add_f32 v161, v161, v5
    v_lshlrev_b32 v4, 16, v121
    v_and_b32 v5, 0xffff0000, v121
    v_add_f32 v162, v162, v4
    v_add_f32 v163, v163, v5
    v_lshlrev_b32 v4, 16, v122
    v_and_b32 v5, 0xffff0000, v122
    v_add_f32 v164, v164, v4
    v_add_f32 v165, v165, v5
    v_lshlrev_b32 v4, 16, v123
    v_and_b32 v5, 0xffff0000, v123
    v_add_f32 v166, v166, v4
    v_add_f32 v167, v167, v5
    v_lshlrev_b32 v4, 16, v124
    v_and_b32 v5, 0xffff0000, v124
    v_add_f32 v168, v168, v4
    v_add_f32 v169, v169, v5
    v_lshlrev_b32 v4, 16, v125
    v_and_b32 v5, 0xffff0000, v125
    v_add_f32 v170, v170, v4
    v_add_f32 v171, v171, v5
    v_lshlrev_b32 v4, 16, v126
    v_and_b32 v5, 0xffff0000, v126
    v_add_f32 v172, v172, v4
    v_add_f32 v173, v173, v5
    v_lshlrev_b32 v4, 16, v127
    v_and_b32 v5, 0xffff0000, v127
    v_add_f32 v174, v174, v4
    v_add_f32 v175, v175, v5
    v_lshlrev_b32 v4, 16, v128
    v_and_b32 v5, 0xffff0000, v128
    v_add_f32 v176, v176, v4
    v_add_f32 v177, v177, v5
    v_lshlrev_b32 v4, 16, v129
    v_and_b32 v5, 0xffff0000, v129
    v_add_f32 v178, v178, v4
    v_add_f32 v179, v179, v5
    v_lshlrev_b32 v4, 16, v130
    v_and_b32 v5, 0xffff0000, v130
    v_add_f32 v180, v180, v4
    v_add_f32 v181, v181, v5
    v_lshlrev_b32 v4, 16, v131
    v_and_b32 v5, 0xffff0000, v131
    v_add_f32 v182, v182, v4
    v_add_f32 v183, v183, v5
    v_lshlrev_b32 v4, 16, v132
    v_and_b32 v5, 0xffff0000, v132
    v_add_f32 v184, v184, v4
    v_add_f32 v185, v185, v5
    v_lshlrev_b32 v4, 16, v133
    v_and_b32 v5, 0xffff0000, v133
    v_add_f32 v186, v186, v4
    v_add_f32 v187, v187, v5
    v_lshlrev_b32 v4, 16, v134
    v_and_b32 v5, 0xffff0000, v134
    v_add_f32 v188, v188, v4
    v_add_f32 v189, v189, v5
    v_lshlrev_b32 v4, 16, v135
    v_and_b32 v5, 0xffff0000, v135
    v_add_f32 v190, v190, v4
    v_add_f32 v191, v191, v5
    v_lshlrev_b32 v4, 16, v136
    v_and_b32 v5, 0xffff0000, v136
    v_add_f32 v192, v192, v4
    v_add_f32 v193, v193, v5
    v_lshlrev_b32 v4, 16, v137
    v_and_b32 v5, 0xffff0000, v137
    v_add_f32 v194, v194, v4
    v_add_f32 v195, v195, v5
    v_lshlrev_b32 v4, 16, v138
    v_and_b32 v5, 0xffff0000, v138
    v_add_f32 v196, v196, v4
    v_add_f32 v197, v197, v5
    v_lshlrev_b32 v4, 16, v139
    v_and_b32 v5, 0xffff0000, v139
    v_add_f32 v198, v198, v4
    v_add_f32 v199, v199, v5
    v_cvt_pk_bf16_f32 v56, v160, v161
    v_cvt_pk_bf16_f32 v57, v162, v163
    s_add_u32 s46, s45, 0
    buffer_store_dwordx2 v[56:57], v2, s[16:19], s46 offen
    v_cvt_pk_bf16_f32 v58, v164, v165
    v_cvt_pk_bf16_f32 v59, v166, v167
    s_add_u32 s46, s45, 32
    buffer_store_dwordx2 v[58:59], v2, s[16:19], s46 offen
    v_cvt_pk_bf16_f32 v60, v168, v169
    v_cvt_pk_bf16_f32 v61, v170, v171
    s_add_u32 s46, s45, 64
    buffer_store_dwordx2 v[60:61], v2, s[16:19], s46 offen
    v_cvt_pk_bf16_f32 v62, v172, v173
    v_cvt_pk_bf16_f32 v63, v174, v175
    s_add_u32 s46, s45, 96
    buffer_store_dwordx2 v[62:63], v2, s[16:19], s46 offen
    v_cvt_pk_bf16_f32 v64, v176, v177
    v_cvt_pk_bf16_f32 v65, v178, v179
    s_add_u32 s46, s45, 128
    buffer_store_dwordx2 v[64:65], v2, s[16:19], s46 offen
    v_cvt_pk_bf16_f32 v66, v180, v181
    v_cvt_pk_bf16_f32 v67, v182, v183
    s_add_u32 s46, s45, 36864
    buffer_store_dwordx2 v[66:67], v2, s[16:19], s46 offen
    v_cvt_pk_bf16_f32 v68, v184, v185
    v_cvt_pk_bf16_f32 v69, v186, v187
    s_add_u32 s46, s45, 36896
    buffer_store_dwordx2 v[68:69], v2, s[16:19], s46 offen
    v_cvt_pk_bf16_f32 v70, v188, v189
    v_cvt_pk_bf16_f32 v71, v190, v191
    s_add_u32 s46, s45, 36928
    buffer_store_dwordx2 v[70:71], v2, s[16:19], s46 offen
    v_cvt_pk_bf16_f32 v72, v192, v193
    v_cvt_pk_bf16_f32 v73, v194, v195
    s_add_u32 s46, s45, 36960
    buffer_store_dwordx2 v[72:73], v2, s[16:19], s46 offen
    v_cvt_pk_bf16_f32 v74, v196, v197
    v_cvt_pk_bf16_f32 v75, v198, v199
    s_add_u32 s46, s45, 36992
    buffer_store_dwordx2 v[74:75], v2, s[16:19], s46 offen
L_s2e_92:
    s_branch L_k1_fin
L_rare_68:
    s_waitcnt lgkmcnt(0)
    s_nop 9
    v_add_u32 v4, s42, v6
    v_mov_b32 v11, v4
    v_xor_b32 v4, 0, v11
    ds_read_b128 v[0:3], v4 offset:0
    s_waitcnt lgkmcnt(0)
    v_mfma_f32_16x16x32_bf16 v[88:91], v[0:3], v[112:115], v[12:15]
    s_nop 5
    v_xor_b32 v4, 64, v11
    ds_read_b128 v[0:3], v4 offset:0
    s_waitcnt lgkmcnt(0)
    v_mfma_f32_16x16x32_bf16 v[88:91], v[0:3], v[116:119], v[88:91]
    s_nop 5
    v_xor_b32 v4, 128, v11
    ds_read_b128 v[0:3], v4 offset:0
    s_waitcnt lgkmcnt(0)
    v_mfma_f32_16x16x32_bf16 v[88:91], v[0:3], v[120:123], v[88:91]
    s_nop 5
    v_xor_b32 v4, 192, v11
    ds_read_b128 v[0:3], v4 offset:0
    s_waitcnt lgkmcnt(0)
    v_mfma_f32_16x16x32_bf16 v[88:91], v[0:3], v[124:127], v[88:91]
    s_nop 5
    v_xor_b32 v4, 0, v11
    ds_read_b128 v[0:3], v4 offset:4096
    s_waitcnt lgkmcnt(0)
    v_mfma_f32_16x16x32_bf16 v[92:95], v[0:3], v[112:115], v[12:15]
    s_nop 5
    v_xor_b32 v4, 64, v11
    ds_read_b128 v[0:3], v4 offset:4096
    s_waitcnt lgkmcnt(0)
    v_mfma_f32_16x16x32_bf16 v[92:95], v[0:3], v[116:119], v[92:95]
    s_nop 5
    v_xor_b32 v4, 128, v11
    ds_read_b128 v[0:3], v4 offset:4096
    s_waitcnt lgkmcnt(0)
    v_mfma_f32_16x16x32_bf16 v[92:95], v[0:3], v[120:123], v[92:95]
    s_nop 5
    v_xor_b32 v4, 192, v11
    ds_read_b128 v[0:3], v4 offset:4096
    s_waitcnt lgkmcnt(0)
    v_mfma_f32_16x16x32_bf16 v[92:95], v[0:3], v[124:127], v[92:95]
    s_nop 5
    s_nop 7
    v_max3_f32 v2, v88, v89, v90
    v_max3_f32 v2, v2, v91, v92
    v_max3_f32 v2, v2, v93, v94
    v_max_f32 v2, v2, v95
    v_mbcnt_lo_u32_b32 v0, -1, 0
    v_mbcnt_hi_u32_b32 v0, -1, v0
    v_xor_b32 v3, 16, v0
    v_lshlrev_b32 v3, 2, v3
    ds_bpermute_b32 v4, v3, v2
    s_waitcnt lgkmcnt(0)
    v_max_f32 v2, v2, v4
    v_xor_b32 v3, 32, v0
    v_lshlrev_b32 v3, 2, v3
    ds_bpermute_b32 v4, v3, v2
    s_waitcnt lgkmcnt(0)
    v_max_f32 v2, v2, v4
    v_max_f32 v2, 0, v2
    v_sub_f32 v3, 0, v2
    v_exp_f32 v3, v3
    v_sub_f32 v12, v12, v2
    v_sub_f32 v13, v13, v2
    v_sub_f32 v14, v14, v2
    v_sub_f32 v15, v15, v2
    v_sub_f32 v88, v88, v2
    v_sub_f32 v89, v89, v2
    v_sub_f32 v90, v90, v2
    v_sub_f32 v91, v91, v2
    v_sub_f32 v92, v92, v2
    v_sub_f32 v93, v93, v2
    v_sub_f32 v94, v94, v2
    v_sub_f32 v95, v95, v2
    v_exp_f32 v88, v88
    v_exp_f32 v89, v89
    v_exp_f32 v90, v90
    v_exp_f32 v91, v91
    v_exp_f32 v92, v92
    v_exp_f32 v93, v93
    v_exp_f32 v94, v94
    v_exp_f32 v95, v95
    v_mul_f32 v160, v160, v3
    v_mul_f32 v161, v161, v3
    v_mul_f32 v162, v162, v3
    v_mul_f32 v163, v163, v3
    v_mul_f32 v164, v164, v3
    v_mul_f32 v165, v165, v3
    v_mul_f32 v166, v166, v3
    v_mul_f32 v167, v167, v3
    v_mul_f32 v168, v168, v3
    v_mul_f32 v169, v169, v3
    v_mul_f32 v170, v170, v3
    v_mul_f32 v171, v171, v3
    v_mul_f32 v172, v172, v3
    v_mul_f32 v173, v173, v3
    v_mul_f32 v174, v174, v3
    v_mul_f32 v175, v175, v3
    v_mul_f32 v176, v176, v3
    v_mul_f32 v177, v177, v3
    v_mul_f32 v178, v178, v3
    v_mul_f32 v179, v179, v3
    v_mul_f32 v180, v180, v3
    v_mul_f32 v181, v181, v3
    v_mul_f32 v182, v182, v3
    v_mul_f32 v183, v183, v3
    v_mul_f32 v184, v184, v3
    v_mul_f32 v185, v185, v3
    v_mul_f32 v186, v186, v3
    v_mul_f32 v187, v187, v3
    v_mul_f32 v188, v188, v3
    v_mul_f32 v189, v189, v3
    v_mul_f32 v190, v190, v3
    v_mul_f32 v191, v191, v3
    v_mul_f32 v8, v8, v3
    v_add_f32 v0, v88, v89
    v_add_f32 v1, v90, v91
    v_add_f32 v2, v92, v93
    v_add_f32 v3, v94, v95
    v_add_f32 v0, v0, v1
    v_add_f32 v2, v2, v3
    v_add_f32 v11, v0, v2
    v_cvt_pk_bf16_f32 v88, v88, v89
    v_cvt_pk_bf16_f32 v89, v90, v91
    v_cvt_pk_bf16_f32 v90, v92, v93
    v_cvt_pk_bf16_f32 v91, v94, v95
    s_nop 3
    s_branch L_rret_69
L_rare_72:
    s_waitcnt lgkmcnt(0)
    s_nop 9
    v_add_u32 v4, s42, v6
    v_mov_b32 v11, v4
    v_xor_b32 v4, 0, v11
    ds_read_b128 v[0:3], v4 offset:0
    s_waitcnt lgkmcnt(0)
    v_mfma_f32_16x16x32_bf16 v[88:91], v[0:3], v[112:115], v[12:15]
    s_nop 5
    v_xor_b32 v4, 64, v11
    ds_read_b128 v[0:3], v4 offset:0
    s_waitcnt lgkmcnt(0)
    v_mfma_f32_16x16x32_bf16 v[88:91], v[0:3], v[116:119], v[88:91]
    s_nop 5
    v_xor_b32 v4, 128, v11
    ds_read_b128 v[0:3], v4 offset:0
    s_waitcnt lgkmcnt(0)
    v_mfma_f32_16x16x32_bf16 v[88:91], v[0:3], v[120:123], v[88:91]
    s_nop 5
    v_xor_b32 v4, 192, v11
    ds_read_b128 v[0:3], v4 offset:0
    s_waitcnt lgkmcnt(0)
    v_mfma_f32_16x16x32_bf16 v[88:91], v[0:3], v[124:127], v[88:91]
    s_nop 5
    v_xor_b32 v4, 0, v11
    ds_read_b128 v[0:3], v4 offset:4096
    s_waitcnt lgkmcnt(0)
    v_mfma_f32_16x16x32_bf16 v[92:95], v[0:3], v[112:115], v[12:15]
    s_nop 5
    v_xor_b32 v4, 64, v11
    ds_read_b128 v[0:3], v4 offset:4096
    s_waitcnt lgkmcnt(0)
    v_mfma_f32_16x16x32_bf16 v[92:95], v[0:3], v[116:119], v[92:95]
    s_nop 5
    v_xor_b32 v4, 128, v11
    ds_read_b128 v[0:3], v4 offset:4096
    s_waitcnt lgkmcnt(0)
    v_mfma_f32_16x16x32_bf16 v[92:95], v[0:3], v[120:123], v[92:95]
    s_nop 5
    v_xor_b32 v4, 192, v11
    ds_read_b128 v[0:3], v4 offset:4096
    s_waitcnt lgkmcnt(0)
    v_mfma_f32_16x16x32_bf16 v[92:95], v[0:3], v[124:127], v[92:95]
    s_nop 5
    s_nop 7
    v_max3_f32 v2, v88, v89, v90
    v_max3_f32 v2, v2, v91, v92
    v_max3_f32 v2, v2, v93, v94
    v_max_f32 v2, v2, v95
    v_mbcnt_lo_u32_b32 v0, -1, 0
    v_mbcnt_hi_u32_b32 v0, -1, v0
    v_xor_b32 v3, 16, v0
    v_lshlrev_b32 v3, 2, v3
    ds_bpermute_b32 v4, v3, v2
    s_waitcnt lgkmcnt(0)
    v_max_f32 v2, v2, v4
    v_xor_b32 v3, 32, v0
    v_lshlrev_b32 v3, 2, v3
    ds_bpermute_b32 v4, v3, v2
    s_waitcnt lgkmcnt(0)
    v_max_f32 v2, v2, v4
    v_max_f32 v2, 0, v2
    v_sub_f32 v3, 0, v2
    v_exp_f32 v3, v3
    v_sub_f32 v12, v12, v2
    v_sub_f32 v13, v13, v2
    v_sub_f32 v14, v14, v2
    v_sub_f32 v15, v15, v2
    v_sub_f32 v88, v88, v2
    v_sub_f32 v89, v89, v2
    v_sub_f32 v90, v90, v2
    v_sub_f32 v91, v91, v2
    v_sub_f32 v92, v92, v2
    v_sub_f32 v93, v93, v2
    v_sub_f32 v94, v94, v2
    v_sub_f32 v95, v95, v2
    v_exp_f32 v88, v88
    v_exp_f32 v89, v89
    v_exp_f32 v90, v90
    v_exp_f32 v91, v91
    v_exp_f32 v92, v92
    v_exp_f32 v93, v93
    v_exp_f32 v94, v94
    v_exp_f32 v95, v95
    v_mul_f32 v160, v160, v3
    v_mul_f32 v161, v161, v3
    v_mul_f32 v162, v162, v3
    v_mul_f32 v163, v163, v3
    v_mul_f32 v164, v164, v3
    v_mul_f32 v165, v165, v3
    v_mul_f32 v166, v166, v3
    v_mul_f32 v167, v167, v3
    v_mul_f32 v168, v168, v3
    v_mul_f32 v169, v169, v3
    v_mul_f32 v170, v170, v3
    v_mul_f32 v171, v171, v3
    v_mul_f32 v172, v172, v3
    v_mul_f32 v173, v173, v3
    v_mul_f32 v174, v174, v3
    v_mul_f32 v175, v175, v3
    v_mul_f32 v176, v176, v3
    v_mul_f32 v177, v177, v3
    v_mul_f32 v178, v178, v3
    v_mul_f32 v179, v179, v3
    v_mul_f32 v180, v180, v3
    v_mul_f32 v181, v181, v3
    v_mul_f32 v182, v182, v3
    v_mul_f32 v183, v183, v3
    v_mul_f32 v184, v184, v3
    v_mul_f32 v185, v185, v3
    v_mul_f32 v186, v186, v3
    v_mul_f32 v187, v187, v3
    v_mul_f32 v188, v188, v3
    v_mul_f32 v189, v189, v3
    v_mul_f32 v190, v190, v3
    v_mul_f32 v191, v191, v3
    v_mul_f32 v8, v8, v3
    v_add_f32 v0, v88, v89
    v_add_f32 v1, v90, v91
    v_add_f32 v2, v92, v93
    v_add_f32 v3, v94, v95
    v_add_f32 v0, v0, v1
    v_add_f32 v2, v2, v3
    v_add_f32 v11, v0, v2
    v_cvt_pk_bf16_f32 v88, v88, v89
    v_cvt_pk_bf16_f32 v89, v90, v91
    v_cvt_pk_bf16_f32 v90, v92, v93
    v_cvt_pk_bf16_f32 v91, v94, v95
    s_nop 3
    s_branch L_rret_73
L_rare_70:
    s_waitcnt lgkmcnt(0)
    s_nop 9
    v_add_u32 v4, s42, v6
    v_mov_b32 v11, v4
    v_xor_b32 v4, 0, v11
    ds_read_b128 v[0:3], v4 offset:0
    s_waitcnt lgkmcnt(0)
    v_mfma_f32_16x16x32_bf16 v[96:99], v[0:3], v[128:131], v[16:19]
    s_nop 5
    v_xor_b32 v4, 64, v11
    ds_read_b128 v[0:3], v4 offset:0
    s_waitcnt lgkmcnt(0)
    v_mfma_f32_16x16x32_bf16 v[96:99], v[0:3], v[132:135], v[96:99]
    s_nop 5
    v_xor_b32 v4, 128, v11
    ds_read_b128 v[0:3], v4 offset:0
    s_waitcnt lgkmcnt(0)
    v_mfma_f32_16x16x32_bf16 v[96:99], v[0:3], v[136:139], v[96:99]
    s_nop 5
    v_xor_b32 v4, 192, v11
    ds_read_b128 v[0:3], v4 offset:0
    s_waitcnt lgkmcnt(0)
    v_mfma_f32_16x16x32_bf16 v[96:99], v[0:3], v[140:143], v[96:99]
    s_nop 5
    v_xor_b32 v4, 0, v11
    ds_read_b128 v[0:3], v4 offset:4096
    s_waitcnt lgkmcnt(0)
    v_mfma_f32_16x16x32_bf16 v[100:103], v[0:3], v[128:131], v[16:19]
    s_nop 5
    v_xor_b32 v4, 64, v11
    ds_read_b128 v[0:3], v4 offset:4096
    s_waitcnt lgkmcnt(0)
    v_mfma_f32_16x16x32_bf16 v[100:103], v[0:3], v[132:135], v[100:103]
    s_nop 5
    v_xor_b32 v4, 128, v11
    ds_read_b128 v[0:3], v4 offset:4096
    s_waitcnt lgkmcnt(0)
    v_mfma_f32_16x16x32_bf16 v[100:103], v[0:3], v[136:139], v[100:103]
    s_nop 5
    v_xor_b32 v4, 192, v11
    ds_read_b128 v[0:3], v4 offset:4096
    s_waitcnt lgkmcnt(0)
    v_mfma_f32_16x16x32_bf16 v[100:103], v[0:3], v[140:143], v[100:103]
    s_nop 5
    s_nop 7
    v_max3_f32 v2, v96, v97, v98
    v_max3_f32 v2, v2, v99, v100
    v_max3_f32 v2, v2, v101, v102
    v_max_f32 v2, v2, v103
    v_mbcnt_lo_u32_b32 v0, -1, 0
    v_mbcnt_hi_u32_b32 v0, -1, v0
    v_xor_b32 v3, 16, v0
    v_lshlrev_b32 v3, 2, v3
    ds_bpermute_b32 v4, v3, v2
    s_waitcnt lgkmcnt(0)
    v_max_f32 v2, v2, v4
    v_xor_b32 v3, 32, v0
    v_lshlrev_b32 v3, 2, v3
    ds_bpermute_b32 v4, v3, v2
    s_waitcnt lgkmcnt(0)
    v_max_f32 v2, v2, v4
    v_max_f32 v2, 0, v2
    v_sub_f32 v3, 0, v2
    v_exp_f32 v3, v3
    v_sub_f32 v16, v16, v2
    v_sub_f32 v17, v17, v2
    v_sub_f32 v18, v18, v2
    v_sub_f32 v19, v19, v2
    v_sub_f32 v96, v96, v2
    v_sub_f32 v97, v97, v2
    v_sub_f32 v98, v98, v2
    v_sub_f32 v99, v99, v2
    v_sub_f32 v100, v100, v2
    v_sub_f32 v101, v101, v2
    v_sub_f32 v102, v102, v2
    v_sub_f32 v103, v103, v2
    v_exp_f32 v96, v96
    v_exp_f32 v97, v97
    v_exp_f32 v98, v98
    v_exp_f32 v99, v99
    v_exp_f32 v100, v100
    v_exp_f32 v101, v101
    v_exp_f32 v102, v102
    v_exp_f32 v103, v103
    v_mul_f32 v192, v192, v3
    v_mul_f32 v193, v193, v3
    v_mul_f32 v194, v194, v3
    v_mul_f32 v195, v195, v3
    v_mul_f32 v196, v196, v3
    v_mul_f32 v197, v197, v3
    v_mul_f32 v198, v198, v3
    v_mul_f32 v199, v199, v3
    v_mul_f32 v200, v200, v3
    v_mul_f32 v201, v201, v3
    v_mul_f32 v202, v202, v3
    v_mul_f32 v203, v203, v3
    v_mul_f32 v204, v204, v3
    v_mul_f32 v205, v205, v3
    v_mul_f32 v206, v206, v3
    v_mul_f32 v207, v207, v3
    v_mul_f32 v208, v208, v3
    v_mul_f32 v209, v209, v3
    v_mul_f32 v210, v210, v3
    v_mul_f32 v211, v211, v3
    v_mul_f32 v212, v212, v3
    v_mul_f32 v213, v213, v3
    v_mul_f32 v214, v214, v3
    v_mul_f32 v215, v215, v3
    v_mul_f32 v216, v216, v3
    v_mul_f32 v217, v217, v3
    v_mul_f32 v218, v218, v3
    v_mul_f32 v219, v219, v3
    v_mul_f32 v220, v220, v3
    v_mul_f32 v221, v221, v3
    v_mul_f32 v222, v222, v3
    v_mul_f32 v223, v223, v3
    v_mul_f32 v9, v9, v3
    v_add_f32 v0, v96, v97
    v_add_f32 v1, v98, v99
    v_add_f32 v2, v100, v101
    v_add_f32 v3, v102, v103
    v_add_f32 v0, v0, v1
    v_add_f32 v2, v2, v3
    v_add_f32 v11, v0, v2
    v_cvt_pk_bf16_f32 v96, v96, v97
    v_cvt_pk_bf16_f32 v97, v98, v99
    v_cvt_pk_bf16_f32 v98, v100, v101
    v_cvt_pk_bf16_f32 v99, v102, v103
    s_nop 3
    s_branch L_rret_71
L_rare_74:
    s_waitcnt lgkmcnt(0)
    s_nop 9
    v_add_u32 v4, s42, v6
    v_mov_b32 v11, v4
    v_xor_b32 v4, 0, v11
    ds_read_b128 v[0:3], v4 offset:0
    s_waitcnt lgkmcnt(0)
    v_mfma_f32_16x16x32_bf16 v[96:99], v[0:3], v[128:131], v[16:19]
    s_nop 5
    v_xor_b32 v4, 64, v11
    ds_read_b128 v[0:3], v4 offset:0
    s_waitcnt lgkmcnt(0)
    v_mfma_f32_16x16x32_bf16 v[96:99], v[0:3], v[132:135], v[96:99]
    s_nop 5
    v_xor_b32 v4, 128, v11
    ds_read_b128 v[0:3], v4 offset:0
    s_waitcnt lgkmcnt(0)
    v_mfma_f32_16x16x32_bf16 v[96:99], v[0:3], v[136:139], v[96:99]
    s_nop 5
    v_xor_b32 v4, 192, v11
    ds_read_b128 v[0:3], v4 offset:0
    s_waitcnt lgkmcnt(0)
    v_mfma_f32_16x16x32_bf16 v[96:99], v[0:3], v[140:143], v[96:99]
    s_nop 5
    v_xor_b32 v4, 0, v11
    ds_read_b128 v[0:3], v4 offset:4096
    s_waitcnt lgkmcnt(0)
    v_mfma_f32_16x16x32_bf16 v[100:103], v[0:3], v[128:131], v[16:19]
    s_nop 5
    v_xor_b32 v4, 64, v11
    ds_read_b128 v[0:3], v4 offset:4096
    s_waitcnt lgkmcnt(0)
    v_mfma_f32_16x16x32_bf16 v[100:103], v[0:3], v[132:135], v[100:103]
    s_nop 5
    v_xor_b32 v4, 128, v11
    ds_read_b128 v[0:3], v4 offset:4096
    s_waitcnt lgkmcnt(0)
    v_mfma_f32_16x16x32_bf16 v[100:103], v[0:3], v[136:139], v[100:103]
    s_nop 5
    v_xor_b32 v4, 192, v11
    ds_read_b128 v[0:3], v4 offset:4096
    s_waitcnt lgkmcnt(0)
    v_mfma_f32_16x16x32_bf16 v[100:103], v[0:3], v[140:143], v[100:103]
    s_nop 5
    s_nop 7
    v_max3_f32 v2, v96, v97, v98
    v_max3_f32 v2, v2, v99, v100
    v_max3_f32 v2, v2, v101, v102
    v_max_f32 v2, v2, v103
    v_mbcnt_lo_u32_b32 v0, -1, 0
    v_mbcnt_hi_u32_b32 v0, -1, v0
    v_xor_b32 v3, 16, v0
    v_lshlrev_b32 v3, 2, v3
    ds_bpermute_b32 v4, v3, v2
    s_waitcnt lgkmcnt(0)
    v_max_f32 v2, v2, v4
    v_xor_b32 v3, 32, v0
    v_lshlrev_b32 v3, 2, v3
    ds_bpermute_b32 v4, v3, v2
    s_waitcnt lgkmcnt(0)
    v_max_f32 v2, v2, v4
    v_max_f32 v2, 0, v2
    v_sub_f32 v3, 0, v2
    v_exp_f32 v3, v3
    v_sub_f32 v16, v16, v2
    v_sub_f32 v17, v17, v2
    v_sub_f32 v18, v18, v2
    v_sub_f32 v19, v19, v2
    v_sub_f32 v96, v96, v2
    v_sub_f32 v97, v97, v2
    v_sub_f32 v98, v98, v2
    v_sub_f32 v99, v99, v2
    v_sub_f32 v100, v100, v2
    v_sub_f32 v101, v101, v2
    v_sub_f32 v102, v102, v2
    v_sub_f32 v103, v103, v2
    v_exp_f32 v96, v96
    v_exp_f32 v97, v97
    v_exp_f32 v98, v98
    v_exp_f32 v99, v99
    v_exp_f32 v100, v100
    v_exp_f32 v101, v101
    v_exp_f32 v102, v102
    v_exp_f32 v103, v103
    v_mul_f32 v192, v192, v3
    v_mul_f32 v193, v193, v3
    v_mul_f32 v194, v194, v3
    v_mul_f32 v195, v195, v3
    v_mul_f32 v196, v196, v3
    v_mul_f32 v197, v197, v3
    v_mul_f32 v198, v198, v3
    v_mul_f32 v199, v199, v3
    v_mul_f32 v200, v200, v3
    v_mul_f32 v201, v201, v3
    v_mul_f32 v202, v202, v3
    v_mul_f32 v203, v203, v3
    v_mul_f32 v204, v204, v3
    v_mul_f32 v205, v205, v3
    v_mul_f32 v206, v206, v3
    v_mul_f32 v207, v207, v3
    v_mul_f32 v208, v208, v3
    v_mul_f32 v209, v209, v3
    v_mul_f32 v210, v210, v3
    v_mul_f32 v211, v211, v3
    v_mul_f32 v212, v212, v3
    v_mul_f32 v213, v213, v3
    v_mul_f32 v214, v214, v3
    v_mul_f32 v215, v215, v3
    v_mul_f32 v216, v216, v3
    v_mul_f32 v217, v217, v3
    v_mul_f32 v218, v218, v3
    v_mul_f32 v219, v219, v3
    v_mul_f32 v220, v220, v3
    v_mul_f32 v221, v221, v3
    v_mul_f32 v222, v222, v3
    v_mul_f32 v223, v223, v3
    v_mul_f32 v9, v9, v3
    v_add_f32 v0, v96, v97
    v_add_f32 v1, v98, v99
    v_add_f32 v2, v100, v101
    v_add_f32 v3, v102, v103
    v_add_f32 v0, v0, v1
    v_add_f32 v2, v2, v3
    v_add_f32 v11, v0, v2
    v_cvt_pk_bf16_f32 v96, v96, v97
    v_cvt_pk_bf16_f32 v97, v98, v99
    v_cvt_pk_bf16_f32 v98, v100, v101
    v_cvt_pk_bf16_f32 v99, v102, v103
    s_nop 3
    s_branch L_rret_75
L_gw_62:
    v_lshrrev_b32 v2, 4, v1
    v_and_b32 v6, 1, v2
    v_lshrrev_b32 v7, 1, v2
    v_lshlrev_b32 v7, 2, v7
    v_or_b32 v6, v6, v7
    s_and_b32 s45, s40, 1
    s_lshl_b32 s45, s45, 3
    v_or_b32 v6, s45, v6
    v_and_b32 v7, 15, v1
    v_xor_b32 v6, v6, v7
    v_lshlrev_b32 v6, 4, v6
    v_lshlrev_b32 v7, 13, v2
    v_add_u32 v28, v6, v7
    v_add_u32 v29, 31744, v28
    v_lshrrev_b32 v6, 3, v1
    v_mul_u32_u24 v6, 1152, v6
    v_and_b32 v7, 7, v1
    v_xor_b32 v7, v7, v2
    v_lshlrev_b32 v7, 4, v7
    s_and_b32 s45, s40, 1
    s_lshl_b32 s45, s45, 6
    v_xor_b32 v7, s45, v7
    v_xor_b32 v5, 64, v7
    v_add_u32 v32, v6, v7
    v_add_u32 v33, v6, v5
    v_add_u32 v33, 8192, v33
    v_add_u32 v34, v6, v7
    v_add_u32 v34, 16384, v34
    v_add_u32 v35, v6, v5
    v_add_u32 v35, 24576, v35
    v_add_u32 v36, v6, v7
    v_add_u32 v36, 36864, v36
    s_lshl_b32 s63, s40, 16
    s_lshl_b32 s45, s36, 8
    s_add_u32 s63, s63, s45
    s_lshl_b32 s69, s40, 11
    s_add_u32 s69, s69, 122880
    s_mul_i32 s72, s40, 46080
    s_mul_i32 s73, s40, 5120
    s_add_u32 s73, s73, 81920
    s_lshl_b32 s45, s38, 1
    s_add_u32 s45, s45, s35
    s_sub_u32 s46, s45, 9
    s_cmp_ge_u32 s45, 9
    s_cselect_b32 s45, s46, s45
    s_lshl_b32 s62, s45, 19
    s_lshl_b32 s66, s45, 7
    s_mov_b32 s65, 0
    s_mov_b32 s68, 0
    s_mov_b32 s64, 0
    s_mov_b32 s67, 0
    s_add_u32 s74, s62, s63
    s_add_u32 s75, s65, s69
    s_mov_b32 m0, s75
    s_add_u32 s62, s62, 262144
    buffer_load_dwordx4 v28, s[12:15], s74 offen  lds
    s_cmp_eq_u32 s62, 4718592
    s_cselect_b32 s62, 0, s62
    s_add_u32 s64, s64, 1
    s_mov_b32 m0, s75
    s_add_u32 s65, s65, 8192
    buffer_load_dwordx4 v29, s[12:15], s74 offen offset:1024  lds
    s_and_b32 s65, s65, 0x7fff
    s_add_u32 s75, s63, 1024
    s_cmp_eq_u32 s64, 18
    s_cselect_b32 s63, s75, s63
    s_add_u32 s74, s62, s63
    s_add_u32 s75, s65, s69
    s_mov_b32 m0, s75
    s_add_u32 s62, s62, 262144
    buffer_load_dwordx4 v28, s[12:15], s74 offen  lds
    s_cmp_eq_u32 s62, 4718592
    s_cselect_b32 s62, 0, s62
    s_add_u32 s64, s64, 1
    s_mov_b32 m0, s75
    s_add_u32 s65, s65, 8192
    buffer_load_dwordx4 v29, s[12:15], s74 offen offset:1024  lds
    s_and_b32 s65, s65, 0x7fff
    s_add_u32 s75, s63, 1024
    s_cmp_eq_u32 s64, 18
    s_cselect_b32 s63, s75, s63
    v_lshrrev_b32 v2, 4, v1
    v_and_b32 v3, 15, v1
    s_and_b32 s45, s40, 1
    s_lshl_b32 s45, s45, 3
    v_add_u32 v4, s45, v2
    v_xor_b32 v4, v4, v3
    v_lshlrev_b32 v4, 4, v4
    v_lshlrev_b32 v5, 8, v2
    v_add_u32 v30, v4, v5
    v_lshlrev_b32 v4, 1, v2
    v_xor_b32 v4, v4, v3
    v_lshlrev_b32 v4, 4, v4
    v_add_u32 v31, v4, v5
    s_mov_b32 s79, 128
    v_lshrrev_b32 v2, 4, v1
    v_bfe_u32 v3, v1, 2, 2
    v_and_b32 v4, 3, v1
    v_lshlrev_b32 v5, 3, v2
    v_add_u32 v5, v5, v3
    v_and_b32 v6, 1, v3
    v_lshrrev_b32 v7, 1, v3
    v_lshlrev_b32 v7, 2, v7
    v_or_b32 v6, v6, v7
    v_and_b32 v7, 1, v2
    v_lshlrev_b32 v7, 3, v7
    v_or_b32 v6, v6, v7
    v_xor_b32 v6, v6, v4
    v_lshlrev_b32 v6, 4, v6
    v_lshlrev_b32 v5, 8, v5
    v_add_u32 v5, v5, v6
    v_and_b32 v6, 1, v4
    v_lshlrev_b32 v6, 3, v6
    v_add_u32 v5, v5, v6
    v_xor_b32 v5, s79, v5
    v_add_u32 v5, 122880, v5
    v_mov_b32 v20, v5
    v_xor_b32 v21, 8, v5
    v_xor_b32 v22, 64, v5
    v_xor_b32 v23, 72, v5
    v_and_b32 v6, 15, v1
    v_lshrrev_b32 v7, 1, v6
    v_xor_b32 v7, v7, v2
    v_lshlrev_b32 v7, 4, v7
    v_lshlrev_b32 v6, 7, v6
    v_add_u32 v6, v6, v7
    s_lshl_b32 s45, s39, 11
    s_add_u32 s45, s45, 81920
    v_add_u32 v10, s45, v6
    v_xor_b32 v11, 64, v10
    s_mov_b32 s78, 0
    s_mov_b32 s54, 20480
    v_mov_b64 v[160:161], 0
    v_mov_b64 v[162:163], 0
    v_mov_b64 v[164:165], 0
    v_mov_b64 v[166:167], 0
    v_mov_b64 v[168:169], 0
    v_mov_b64 v[170:171], 0
    v_mov_b64 v[172:173], 0
    v_mov_b64 v[174:175], 0
    v_mov_b64 v[176:177], 0
    v_mov_b64 v[178:179], 0
    v_mov_b64 v[180:181], 0
    v_mov_b64 v[182:183], 0
    v_mov_b64 v[184:185], 0
    v_mov_b64 v[186:187], 0
    v_mov_b64 v[188:189], 0
    v_mov_b64 v[190:191], 0
    s_waitcnt vmcnt(0)
    s_barrier
    s_add_u32 s74, s62, s63
    s_add_u32 s75, s65, s69
    s_mov_b32 m0, s75
    s_add_u32 s62, s62, 262144
    buffer_load_dwordx4 v28, s[12:15], s74 offen  lds
    s_cmp_eq_u32 s62, 4718592
    s_cselect_b32 s62, 0, s62
    s_add_u32 s64, s64, 1
    s_mov_b32 m0, s75
    s_add_u32 s65, s65, 8192
    buffer_load_dwordx4 v29, s[12:15], s74 offen offset:1024  lds
    s_and_b32 s65, s65, 0x7fff
    s_add_u32 s75, s63, 1024
    s_cmp_eq_u32 s64, 18
    s_cselect_b32 s63, s75, s63
    s_add_u32 s74, s62, s63
    s_add_u32 s75, s65, s69
    s_mov_b32 m0, s75
    s_add_u32 s62, s62, 262144
    buffer_load_dwordx4 v28, s[12:15], s74 offen  lds
    s_cmp_eq_u32 s62, 4718592
    s_cselect_b32 s62, 0, s62
    s_add_u32 s64, s64, 1
    s_mov_b32 m0, s75
    s_add_u32 s65, s65, 8192
    buffer_load_dwordx4 v29, s[12:15], s74 offen offset:1024  lds
    s_and_b32 s65, s65, 0x7fff
    s_add_u32 s75, s63, 1024
    s_cmp_eq_u32 s64, 18
    s_cselect_b32 s63, s75, s63
    ds_read_b128 v[88:91], v10 offset:0
    ds_read_b128 v[92:95], v10 offset:2048
    ds_read_b64_tr_b16 v[56:57], v20
    ds_read_b64_tr_b16 v[58:59], v20 offset:1024
    ds_read_b64_tr_b16 v[60:61], v21
    ds_read_b64_tr_b16 v[62:63], v21 offset:1024
    ds_read_b64_tr_b16 v[64:65], v22
    ds_read_b64_tr_b16 v[66:67], v22 offset:1024
    ds_read_b64_tr_b16 v[68:69], v23
    ds_read_b64_tr_b16 v[70:71], v23 offset:1024
    s_add_u32 s78, s78, 8192
    s_mov_b32 s55, 8192
    s_cmp_eq_u32 s78, 32768
    s_cselect_b32 s78, 0, s78
    s_cselect_b32 s55, 4294942720, s55
    v_add_u32 v20, s55, v20
    v_add_u32 v21, s55, v21
    v_add_u32 v22, s55, v22
    v_add_u32 v23, s55, v23
    s_waitcnt lgkmcnt(0)
    s_mov_b32 s41, 0
L_q0_96:
    s_barrier
    v_mfma_f32_16x16x32_bf16 v[160:163], v[56:59], v[88:91], v[160:163]
    ds_read_b128 v[100:103], v11 offset:0
    ds_read_b128 v[104:107], v11 offset:2048
    v_mfma_f32_16x16x32_bf16 v[176:179], v[56:59], v[92:95], v[176:179]
    ds_read_b64_tr_b16 v[72:73], v20
    ds_read_b64_tr_b16 v[74:75], v20 offset:1024
    v_mfma_f32_16x16x32_bf16 v[164:167], v[60:63], v[88:91], v[164:167]
    ds_read_b64_tr_b16 v[76:77], v21
    ds_read_b64_tr_b16 v[78:79], v21 offset:1024
    s_add_u32 s74, s62, s63
    s_add_u32 s75, s65, s69
    s_mov_b32 m0, s75
    s_add_u32 s62, s62, 262144
    buffer_load_dwordx4 v28, s[12:15], s74 offen  lds
    s_cmp_eq_u32 s62, 4718592
    s_cselect_b32 s62, 0, s62
    s_add_u32 s64, s64, 1
    v_mfma_f32_16x16x32_bf16 v[180:183], v[60:63], v[92:95], v[180:183]
    ds_read_b64_tr_b16 v[80:81], v22
    ds_read_b64_tr_b16 v[82:83], v22 offset:1024
    v_mfma_f32_16x16x32_bf16 v[168:171], v[64:67], v[88:91], v[168:171]
    ds_read_b64_tr_b16 v[84:85], v23
    ds_read_b64_tr_b16 v[86:87], v23 offset:1024
    v_mfma_f32_16x16x32_bf16 v[184:187], v[64:67], v[92:95], v[184:187]
    v_mfma_f32_16x16x32_bf16 v[172:175], v[68:71], v[88:91], v[172:175]
    s_add_u32 s78, s78, 8192
    s_mov_b32 s55, 8192
    s_cmp_eq_u32 s78, 32768
    s_cselect_b32 s78, 0, s78
    s_cselect_b32 s55, 4294942720, s55
    v_add_u32 v20, s55, v20
    v_add_u32 v21, s55, v21
    s_mov_b32 m0, s75
    s_add_u32 s65, s65, 8192
    buffer_load_dwordx4 v29, s[12:15], s74 offen offset:1024  lds
    s_and_b32 s65, s65, 0x7fff
    s_add_u32 s75, s63, 1024
    s_cmp_eq_u32 s64, 18
    s_cselect_b32 s63, s75, s63
    v_mfma_f32_16x16x32_bf16 v[188:191], v[68:71], v[92:95], v[188:191]
    v_add_u32 v22, s55, v22
    v_add_u32 v23, s55, v23
    v_add_u32 v10, s54, v10
    v_add_u32 v11, s54, v11
    s_sub_u32 s54, 0, s54
    s_waitcnt lgkmcnt(0)
    s_waitcnt vmcnt(4)
    s_barrier
    v_mfma_f32_16x16x32_bf16 v[160:163], v[72:75], v[100:103], v[160:163]
    ds_read_b128 v[88:91], v10 offset:0
    ds_read_b128 v[92:95], v10 offset:2048
    v_mfma_f32_16x16x32_bf16 v[176:179], v[72:75], v[104:107], v[176:179]
    ds_read_b64_tr_b16 v[56:57], v20
    ds_read_b64_tr_b16 v[58:59], v20 offset:1024
    v_mfma_f32_16x16x32_bf16 v[164:167], v[76:79], v[100:103], v[164:167]
    ds_read_b64_tr_b16 v[60:61], v21
    ds_read_b64_tr_b16 v[62:63], v21 offset:1024
    s_add_u32 s74, s62, s63
    s_add_u32 s75, s65, s69
    s_mov_b32 m0, s75
    s_add_u32 s62, s62, 262144
    buffer_load_dwordx4 v28, s[12:15], s74 offen  lds
    s_cmp_eq_u32 s62, 4718592
    s_cselect_b32 s62, 0, s62
    s_add_u32 s64, s64, 1
    v_mfma_f32_16x16x32_bf16 v[180:183], v[76:79], v[104:107], v[180:183]
    ds_read_b64_tr_b16 v[64:65], v22
    ds_read_b64_tr_b16 v[66:67], v22 offset:1024
    v_mfma_f32_16x16x32_bf16 v[168:171], v[80:83], v[100:103], v[168:171]
    ds_read_b64_tr_b16 v[68:69], v23
    ds_read_b64_tr_b16 v[70:71], v23 offset:1024
    v_mfma_f32_16x16x32_bf16 v[184:187], v[80:83], v[104:107], v[184:187]
    v_mfma_f32_16x16x32_bf16 v[172:175], v[84:87], v[100:103], v[172:175]
    s_add_u32 s78, s78, 8192
    s_mov_b32 s55, 8192
    s_cmp_eq_u32 s78, 32768
    s_cselect_b32 s78, 0, s78
    s_cselect_b32 s55, 4294942720, s55
    v_add_u32 v20, s55, v20
    v_add_u32 v21, s55, v21
    s_mov_b32 m0, s75
    s_add_u32 s65, s65, 8192
    buffer_load_dwordx4 v29, s[12:15], s74 offen offset:1024  lds
    s_and_b32 s65, s65, 0x7fff
    s_add_u32 s75, s63, 1024
    s_cmp_eq_u32 s64, 18
    s_cselect_b32 s63, s75, s63
    v_mfma_f32_16x16x32_bf16 v[188:191], v[84:87], v[104:107], v[188:191]
    v_add_u32 v22, s55, v22
    v_add_u32 v23, s55, v23
    s_waitcnt lgkmcnt(0)
    s_waitcnt vmcnt(4)
    s_add_u32 s41, s41, 1
    s_cmp_lt_u32 s41, 9
    s_cbranch_scc1 L_q0_96
    s_mov_b32 s67, 11
    s_mov_b32 s68, 20480
    s_add_u32 s66, s66, 256
    s_sub_u32 s45, s66, 1152
    s_cmp_ge_u32 s66, 1152
    s_cselect_b32 s66, s45, s66
    s_mov_b32 s80, 0x3e0293ee
    s_mov_b32 s81, 0x3e0293ee
    s_nop 3
    v_pk_mul_f32 v[160:161], v[160:161], s[80:81]
    v_pk_mul_f32 v[162:163], v[162:163], s[80:81]
    v_pk_mul_f32 v[164:165], v[164:165], s[80:81]
    v_pk_mul_f32 v[166:167], v[166:167], s[80:81]
    v_cvt_pk_bf16_f32 v2, v160, v161
    v_cvt_pk_bf16_f32 v3, v162, v163
    v_cvt_pk_bf16_f32 v4, v164, v165
    v_cvt_pk_bf16_f32 v5, v166, v167
    v_cndmask_b32 v112, v2, v4, s[52:53]
    v_cndmask_b32 v113, v3, v5, s[52:53]
    v_cndmask_b32 v114, v4, v2, s[52:53]
    v_cndmask_b32 v115, v5, v3, s[52:53]
    v_pk_mul_f32 v[168:169], v[168:169], s[80:81]
    v_pk_mul_f32 v[170:171], v[170:171], s[80:81]
    v_pk_mul_f32 v[172:173], v[172:173], s[80:81]
    v_pk_mul_f32 v[174:175], v[174:175], s[80:81]
    v_cvt_pk_bf16_f32 v2, v168, v169
    v_cvt_pk_bf16_f32 v3, v170, v171
    v_cvt_pk_bf16_f32 v4, v172, v173
    v_cvt_pk_bf16_f32 v5, v174, v175
    v_cndmask_b32 v116, v2, v4, s[52:53]
    v_cndmask_b32 v117, v3, v5, s[52:53]
    v_cndmask_b32 v118, v4, v2, s[52:53]
    v_cndmask_b32 v119, v5, v3, s[52:53]
    v_pk_mul_f32 v[176:177], v[176:177], s[80:81]
    v_pk_mul_f32 v[178:179], v[178:179], s[80:81]
    v_pk_mul_f32 v[180:181], v[180:181], s[80:81]
    v_pk_mul_f32 v[182:183], v[182:183], s[80:81]
    v_cvt_pk_bf16_f32 v2, v176, v177
    v_cvt_pk_bf16_f32 v3, v178, v179
    v_cvt_pk_bf16_f32 v4, v180, v181
    v_cvt_pk_bf16_f32 v5, v182, v183
    v_cndmask_b32 v120, v2, v4, s[52:53]
    v_cndmask_b32 v121, v3, v5, s[52:53]
    v_cndmask_b32 v122, v4, v2, s[52:53]
    v_cndmask_b32 v123, v5, v3, s[52:53]
    v_pk_mul_f32 v[184:185], v[184:185], s[80:81]
    v_pk_mul_f32 v[186:187], v[186:187], s[80:81]
    v_pk_mul_f32 v[188:189], v[188:189], s[80:81]
    v_pk_mul_f32 v[190:191], v[190:191], s[80:81]
    v_cvt_pk_bf16_f32 v2, v184, v185
    v_cvt_pk_bf16_f32 v3, v186, v187
    v_cvt_pk_bf16_f32 v4, v188, v189
    v_cvt_pk_bf16_f32 v5, v190, v191
    v_cndmask_b32 v124, v2, v4, s[52:53]
    v_cndmask_b32 v125, v3, v5, s[52:53]
    v_cndmask_b32 v126, v4, v2, s[52:53]
    v_cndmask_b32 v127, v5, v3, s[52:53]
    v_lshlrev_b32 v2, 4, v1
    s_lshl_b32 s45, s39, 11
    s_add_u32 s45, s45, 61440
    v_add_u32 v2, s45, v2
    ds_write_b128 v2, v[112:115] offset:0
    ds_write_b128 v2, v[116:119] offset:1024
    ds_write_b128 v2, v[120:123] offset:2048
    ds_write_b128 v2, v[124:127] offset:3072
    s_waitcnt lgkmcnt(0)
    s_barrier
    s_lshr_b32 s79, s40, 1
    s_mul_i32 s79, s79, 5
    s_and_b32 s32, s40, 1
    s_lshl_b32 s32, s32, 7
    v_lshrrev_b32 v2, 4, v1
    v_bfe_u32 v3, v1, 2, 2
    v_and_b32 v4, 3, v1
    v_lshlrev_b32 v5, 3, v2
    v_add_u32 v5, v5, v3
    v_and_b32 v6, 1, v3
    v_lshrrev_b32 v7, 1, v3
    v_lshlrev_b32 v7, 2, v7
    v_or_b32 v6, v6, v7
    v_and_b32 v7, 1, v2
    v_lshlrev_b32 v7, 3, v7
    v_or_b32 v6, v6, v7
    v_xor_b32 v6, v6, v4
    v_lshlrev_b32 v6, 4, v6
    v_lshlrev_b32 v5, 8, v5
    v_add_u32 v5, v5, v6
    v_and_b32 v6, 1, v4
    v_lshlrev_b32 v6, 3, v6
    v_add_u32 v5, v5, v6
    v_xor_b32 v5, s32, v5
    v_add_u32 v5, 139264, v5
    v_mov_b32 v20, v5
    v_xor_b32 v21, 8, v5
    v_xor_b32 v22, 64, v5
    v_xor_b32 v23, 72, v5
    v_and_b32 v6, 15, v1
    v_lshrrev_b32 v7, 1, v6
    v_xor_b32 v7, v7, v2
    v_lshlrev_b32 v7, 4, v7
    v_lshlrev_b32 v6, 7, v6
    v_add_u32 v6, v6, v7
    s_lshl_b32 s45, s79, 11
    s_add_u32 s45, s45, 102400
    v_add_u32 v10, s45, v6
    v_xor_b32 v11, 64, v10
    s_mov_b32 s78, 16384
    s_mov_b32 s54, 4294946816
    v_mov_b64 v[160:161], 0
    v_mov_b64 v[162:163], 0
    v_mov_b64 v[164:165], 0
    v_mov_b64 v[166:167], 0
    v_mov_b64 v[168:169], 0
    v_mov_b64 v[170:171], 0
    v_mov_b64 v[172:173], 0
    v_mov_b64 v[174:175], 0
    v_mov_b64 v[176:177], 0
    v_mov_b64 v[178:179], 0
    v_mov_b64 v[180:181], 0
    v_mov_b64 v[182:183], 0
    v_mov_b64 v[184:185], 0
    v_mov_b64 v[186:187], 0
    v_mov_b64 v[188:189], 0
    v_mov_b64 v[190:191], 0
    v_mov_b64 v[192:193], 0
    v_mov_b64 v[194:195], 0
    v_mov_b64 v[196:197], 0
    v_mov_b64 v[198:199], 0
    v_mov_b64 v[200:201], 0
    v_mov_b64 v[202:203], 0
    v_mov_b64 v[204:205], 0
    v_mov_b64 v[206:207], 0
    v_mov_b64 v[208:209], 0
    v_mov_b64 v[210:211], 0
    v_mov_b64 v[212:213], 0
    v_mov_b64 v[214:215], 0
    v_mov_b64 v[216:217], 0
    v_mov_b64 v[218:219], 0
    v_mov_b64 v[220:221], 0
    v_mov_b64 v[222:223], 0
    v_mov_b64 v[224:225], 0
    v_mov_b64 v[226:227], 0
    v_mov_b64 v[228:229], 0
    v_mov_b64 v[230:231], 0
    v_mov_b64 v[232:233], 0
    v_mov_b64 v[234:235], 0
    v_mov_b64 v[236:237], 0
    v_mov_b64 v[238:239], 0
    ds_read_b128 v[88:91], v10 offset:0
    ds_read_b128 v[92:95], v10 offset:2048
    ds_read_b128 v[96:99], v10 offset:4096
    ds_read_b128 v[100:103], v10 offset:6144
    ds_read_b128 v[104:107], v10 offset:8192
    ds_read_b64_tr_b16 v[56:57], v20
    ds_read_b64_tr_b16 v[58:59], v20 offset:1024
    ds_read_b64_tr_b16 v[60:61], v21
    ds_read_b64_tr_b16 v[62:63], v21 offset:1024
    ds_read_b64_tr_b16 v[64:65], v22
    ds_read_b64_tr_b16 v[66:67], v22 offset:1024
    ds_read_b64_tr_b16 v[68:69], v23
    ds_read_b64_tr_b16 v[70:71], v23 offset:1024
    s_add_u32 s78, s78, 8192
    s_mov_b32 s55, 8192
    s_cmp_eq_u32 s78, 32768
    s_cselect_b32 s78, 0, s78
    s_cselect_b32 s55, 4294942720, s55
    v_add_u32 v20, s55, v20
    v_add_u32 v21, s55, v21
    v_add_u32 v22, s55, v22
    v_add_u32 v23, s55, v23
    s_waitcnt lgkmcnt(0)
    s_mov_b32 s44, 24576
    s_mov_b32 s43, 49152
    s_barrier
    v_mfma_f32_16x16x32_bf16 v[160:163], v[56:59], v[88:91], v[160:163]
    ds_read_b128 v[108:111], v11 offset:0
    v_mfma_f32_16x16x32_bf16 v[176:179], v[56:59], v[92:95], v[176:179]
    ds_read_b128 v[112:115], v11 offset:2048
    s_add_u32 s74, s62, s63
    s_add_u32 s75, s65, s69
    s_mov_b32 m0, s75
    s_add_u32 s62, s62, 262144
    buffer_load_dwordx4 v28, s[12:15], s74 offen  lds
    s_cmp_eq_u32 s62, 4718592
    s_cselect_b32 s62, 0, s62
    s_add_u32 s64, s64, 1
    v_mfma_f32_16x16x32_bf16 v[192:195], v[56:59], v[96:99], v[192:195]
    v_mfma_f32_16x16x32_bf16 v[208:211], v[56:59], v[100:103], v[208:211]
    ds_read_b128 v[116:119], v11 offset:4096
    v_mfma_f32_16x16x32_bf16 v[224:227], v[56:59], v[104:107], v[224:227]
    ds_read_b128 v[120:123], v11 offset:6144
    v_mfma_f32_16x16x32_bf16 v[164:167], v[60:63], v[88:91], v[164:167]
    s_mov_b32 m0, s75
    s_add_u32 s65, s65, 8192
    buffer_load_dwordx4 v29, s[12:15], s74 offen offset:1024  lds
    s_and_b32 s65, s65, 0x7fff
    s_add_u32 s75, s63, 1024
    s_cmp_eq_u32 s64, 18
    s_cselect_b32 s63, s75, s63
    v_mfma_f32_16x16x32_bf16 v[180:183], v[60:63], v[92:95], v[180:183]
    ds_read_b128 v[124:127], v11 offset:8192
    v_mfma_f32_16x16x32_bf16 v[196:199], v[60:63], v[96:99], v[196:199]
    ds_read_b64_tr_b16 v[72:73], v20
    ds_read_b64_tr_b16 v[74:75], v20 offset:1024
    v_mfma_f32_16x16x32_bf16 v[212:215], v[60:63], v[100:103], v[212:215]
    s_add_u32 s60, s43, s57
    s_add_u32 s61, s44, s57
    s_mov_b32 m0, s60
    v_xor_b32 v37, 64, v30
    buffer_load_dwordx4 v30, s[16:19], s61 offen nt lds
    v_mfma_f32_16x16x32_bf16 v[228:231], v[60:63], v[104:107], v[228:231]
    ds_read_b64_tr_b16 v[76:77], v21
    ds_read_b64_tr_b16 v[78:79], v21 offset:1024
    v_mfma_f32_16x16x32_bf16 v[168:171], v[64:67], v[88:91], v[168:171]
    ds_read_b64_tr_b16 v[80:81], v22
    ds_read_b64_tr_b16 v[82:83], v22 offset:1024
    v_mfma_f32_16x16x32_bf16 v[184:187], v[64:67], v[92:95], v[184:187]
    s_mov_b32 m0, s60
    s_nop 0
    buffer_load_dwordx4 v37, s[16:19], s61 offen offset:1024 nt lds
    v_mfma_f32_16x16x32_bf16 v[200:203], v[64:67], v[96:99], v[200:203]
    ds_read_b64_tr_b16 v[84:85], v23
    ds_read_b64_tr_b16 v[86:87], v23 offset:1024
    v_mfma_f32_16x16x32_bf16 v[216:219], v[64:67], v[100:103], v[216:219]
    v_mfma_f32_16x16x32_bf16 v[232:235], v[64:67], v[104:107], v[232:235]
    v_mfma_f32_16x16x32_bf16 v[172:175], v[68:71], v[88:91], v[172:175]
    s_add_u32 s78, s78, 8192
    s_mov_b32 s55, 8192
    s_cmp_eq_u32 s78, 32768
    s_cselect_b32 s78, 0, s78
    s_cselect_b32 s55, 4294942720, s55
    s_add_u32 s60, s60, 8192
    s_mov_b32 m0, s60
    v_xor_b32 v38, 128, v31
    buffer_load_dwordx4 v31, s[20:23], s61 offen nt lds
    v_mfma_f32_16x16x32_bf16 v[188:191], v[68:71], v[92:95], v[188:191]
    v_add_u32 v20, s55, v20
    v_add_u32 v21, s55, v21
    v_mfma_f32_16x16x32_bf16 v[204:207], v[68:71], v[96:99], v[204:207]
    v_add_u32 v22, s55, v22
    v_add_u32 v23, s55, v23
    v_mfma_f32_16x16x32_bf16 v[220:223], v[68:71], v[100:103], v[220:223]
    v_add_u32 v10, s54, v10
    v_add_u32 v11, s54, v11
    s_sub_u32 s54, 0, s54
    s_mov_b32 m0, s60
    s_add_u32 s44, s44, 8192
    buffer_load_dwordx4 v38, s[20:23], s61 offen offset:1024 nt lds
    s_cmp_eq_u32 s44, 131072
    s_cselect_b32 s44, 524288, s44
    s_add_u32 s43, s43, 16384
    s_cmp_eq_u32 s43, 81920
    s_cselect_b32 s43, 0, s43
    v_mfma_f32_16x16x32_bf16 v[236:239], v[68:71], v[104:107], v[236:239]
    s_waitcnt lgkmcnt(0)
    s_waitcnt vmcnt(8)
    s_barrier
    s_mov_b32 s41, 0
L_ga_97:
    v_mfma_f32_16x16x32_bf16 v[160:163], v[72:75], v[108:111], v[160:163]
    ds_read_b128 v[88:91], v10 offset:0
    s_add_u32 s76, s66, s72
    s_add_u32 s77, s68, s73
    s_mov_b32 m0, s77
    s_add_u32 s66, s66, 128
    buffer_load_dwordx4 v32, s[8:11], s76 offen  lds
    s_cmp_eq_u32 s66, 1152
    s_cselect_b32 s66, 0, s66
    v_mfma_f32_16x16x32_bf16 v[176:179], v[72:75], v[112:115], v[176:179]
    ds_read_b128 v[92:95], v10 offset:2048
    v_mfma_f32_16x16x32_bf16 v[192:195], v[72:75], v[116:119], v[192:195]
    s_mov_b32 m0, s77
    s_nop 0
    buffer_load_dwordx4 v33, s[8:11], s76 offen offset:1024  lds
    v_mfma_f32_16x16x32_bf16 v[208:211], v[72:75], v[120:123], v[208:211]
    ds_read_b128 v[96:99], v10 offset:4096
    v_mfma_f32_16x16x32_bf16 v[224:227], v[72:75], v[124:127], v[224:227]
    ds_read_b128 v[100:103], v10 offset:6144
    s_mov_b32 m0, s77
    s_nop 0
    buffer_load_dwordx4 v34, s[8:11], s76 offen offset:2048  lds
    v_mfma_f32_16x16x32_bf16 v[164:167], v[76:79], v[108:111], v[164:167]
    v_mfma_f32_16x16x32_bf16 v[180:183], v[76:79], v[112:115], v[180:183]
    ds_read_b128 v[104:107], v10 offset:8192
    s_mov_b32 m0, s77
    s_nop 0
    buffer_load_dwordx4 v35, s[8:11], s76 offen offset:3072  lds
    v_mfma_f32_16x16x32_bf16 v[196:199], v[76:79], v[116:119], v[196:199]
    ds_read_b64_tr_b16 v[56:57], v20
    ds_read_b64_tr_b16 v[58:59], v20 offset:1024
    v_mfma_f32_16x16x32_bf16 v[212:215], v[76:79], v[120:123], v[212:215]
    s_add_u32 s77, s77, 4096
    s_mov_b32 m0, s77
    s_sub_u32 s68, 20480, s68
    buffer_load_dwordx4 v36, s[8:11], s76 offen  lds
    v_mfma_f32_16x16x32_bf16 v[228:231], v[76:79], v[124:127], v[228:231]
    ds_read_b64_tr_b16 v[60:61], v21
    ds_read_b64_tr_b16 v[62:63], v21 offset:1024
    v_mfma_f32_16x16x32_bf16 v[168:171], v[80:83], v[108:111], v[168:171]
    ds_read_b64_tr_b16 v[64:65], v22
    ds_read_b64_tr_b16 v[66:67], v22 offset:1024
    s_add_u32 s74, s62, s63
    s_add_u32 s75, s65, s69
    s_mov_b32 m0, s75
    s_add_u32 s62, s62, 262144
    buffer_load_dwordx4 v28, s[12:15], s74 offen  lds
    s_cmp_eq_u32 s62, 4718592
    s_cselect_b32 s62, 0, s62
    s_add_u32 s64, s64, 1
    v_mfma_f32_16x16x32_bf16 v[184:187], v[80:83], v[112:115], v[184:187]
    s_mov_b32 m0, s75
    s_add_u32 s65, s65, 8192
    buffer_load_dwordx4 v29, s[12:15], s74 offen offset:1024  lds
    s_and_b32 s65, s65, 0x7fff
    s_add_u32 s75, s63, 1024
    s_cmp_eq_u32 s64, 18
    s_cselect_b32 s63, s75, s63
    v_mfma_f32_16x16x32_bf16 v[200:203], v[80:83], v[116:119], v[200:203]
    ds_read_b64_tr_b16 v[68:69], v23
    ds_read_b64_tr_b16 v[70:71], v23 offset:1024
    v_mfma_f32_16x16x32_bf16 v[216:219], v[80:83], v[120:123], v[216:219]
    s_add_u32 s60, s43, s57
    s_add_u32 s61, s44, s57
    s_mov_b32 m0, s60
    v_xor_b32 v37, 64, v30
    buffer_load_dwordx4 v30, s[16:19], s61 offen nt lds
    v_mfma_f32_16x16x32_bf16 v[232:235], v[80:83], v[124:127], v[232:235]
    v_mfma_f32_16x16x32_bf16 v[172:175], v[84:87], v[108:111], v[172:175]
    s_add_u32 s78, s78, 8192
    s_mov_b32 s55, 8192
    s_cmp_eq_u32 s78, 32768
    s_cselect_b32 s78, 0, s78
    s_cselect_b32 s55, 4294942720, s55
    s_mov_b32 m0, s60
    s_nop 0
    buffer_load_dwordx4 v37, s[16:19], s61 offen offset:1024 nt lds
    v_mfma_f32_16x16x32_bf16 v[188:191], v[84:87], v[112:115], v[188:191]
    v_add_u32 v20, s55, v20
    v_add_u32 v21, s55, v21
    v_mfma_f32_16x16x32_bf16 v[204:207], v[84:87], v[116:119], v[204:207]
    s_add_u32 s60, s60, 8192
    s_mov_b32 m0, s60
    v_xor_b32 v38, 128, v31
    buffer_load_dwordx4 v31, s[20:23], s61 offen nt lds
    v_mfma_f32_16x16x32_bf16 v[220:223], v[84:87], v[120:123], v[220:223]
    v_add_u32 v22, s55, v22
    v_add_u32 v23, s55, v23
    v_mfma_f32_16x16x32_bf16 v[236:239], v[84:87], v[124:127], v[236:239]
    s_mov_b32 m0, s60
    s_add_u32 s44, s44, 8192
    buffer_load_dwordx4 v38, s[20:23], s61 offen offset:1024 nt lds
    s_cmp_eq_u32 s44, 131072
    s_cselect_b32 s44, 524288, s44
    s_add_u32 s43, s43, 16384
    s_cmp_eq_u32 s43, 81920
    s_cselect_b32 s43, 0, s43
    s_waitcnt lgkmcnt(0)
    s_waitcnt vmcnt(17)
    s_barrier
    v_mfma_f32_16x16x32_bf16 v[160:163], v[56:59], v[88:91], v[160:163]
    ds_read_b128 v[108:111], v11 offset:0
    v_mfma_f32_16x16x32_bf16 v[176:179], v[56:59], v[92:95], v[176:179]
    ds_read_b128 v[112:115], v11 offset:2048
    s_add_u32 s74, s62, s63
    s_add_u32 s75, s65, s69
    s_mov_b32 m0, s75
    s_add_u32 s62, s62, 262144
    buffer_load_dwordx4 v28, s[12:15], s74 offen  lds
    s_cmp_eq_u32 s62, 4718592
    s_cselect_b32 s62, 0, s62
    s_add_u32 s64, s64, 1
    v_mfma_f32_16x16x32_bf16 v[192:195], v[56:59], v[96:99], v[192:195]
    v_mfma_f32_16x16x32_bf16 v[208:211], v[56:59], v[100:103], v[208:211]
    ds_read_b128 v[116:119], v11 offset:4096
    v_mfma_f32_16x16x32_bf16 v[224:227], v[56:59], v[104:107], v[224:227]
    ds_read_b128 v[120:123], v11 offset:6144
    v_mfma_f32_16x16x32_bf16 v[164:167], v[60:63], v[88:91], v[164:167]
    s_mov_b32 m0, s75
    s_add_u32 s65, s65, 8192
    buffer_load_dwordx4 v29, s[12:15], s74 offen offset:1024  lds
    s_and_b32 s65, s65, 0x7fff
    s_add_u32 s75, s63, 1024
    s_cmp_eq_u32 s64, 18
    s_cselect_b32 s63, s75, s63
    v_mfma_f32_16x16x32_bf16 v[180:183], v[60:63], v[92:95], v[180:183]
    ds_read_b128 v[124:127], v11 offset:8192
    v_mfma_f32_16x16x32_bf16 v[196:199], v[60:63], v[96:99], v[196:199]
    ds_read_b64_tr_b16 v[72:73], v20
    ds_read_b64_tr_b16 v[74:75], v20 offset:1024
    v_mfma_f32_16x16x32_bf16 v[212:215], v[60:63], v[100:103], v[212:215]
    s_add_u32 s60, s43, s57
    s_add_u32 s61, s44, s57
    s_mov_b32 m0, s60
    v_xor_b32 v37, 64, v30
    buffer_load_dwordx4 v30, s[16:19], s61 offen nt lds
    v_mfma_f32_16x16x32_bf16 v[228:231], v[60:63], v[104:107], v[228:231]
    ds_read_b64_tr_b16 v[76:77], v21
    ds_read_b64_tr_b16 v[78:79], v21 offset:1024
    v_mfma_f32_16x16x32_bf16 v[168:171], v[64:67], v[88:91], v[168:171]
    ds_read_b64_tr_b16 v[80:81], v22
    ds_read_b64_tr_b16 v[82:83], v22 offset:1024
    v_mfma_f32_16x16x32_bf16 v[184:187], v[64:67], v[92:95], v[184:187]
    s_mov_b32 m0, s60
    s_nop 0
    buffer_load_dwordx4 v37, s[16:19], s61 offen offset:1024 nt lds
    v_mfma_f32_16x16x32_bf16 v[200:203], v[64:67], v[96:99], v[200:203]
    ds_read_b64_tr_b16 v[84:85], v23
    ds_read_b64_tr_b16 v[86:87], v23 offset:1024
    v_mfma_f32_16x16x32_bf16 v[216:219], v[64:67], v[100:103], v[216:219]
    v_mfma_f32_16x16x32_bf16 v[232:235], v[64:67], v[104:107], v[232:235]
    v_mfma_f32_16x16x32_bf16 v[172:175], v[68:71], v[88:91], v[172:175]
    s_add_u32 s78, s78, 8192
    s_mov_b32 s55, 8192
    s_cmp_eq_u32 s78, 32768
    s_cselect_b32 s78, 0, s78
    s_cselect_b32 s55, 4294942720, s55
    s_add_u32 s60, s60, 8192
    s_mov_b32 m0, s60
    v_xor_b32 v38, 128, v31
    buffer_load_dwordx4 v31, s[20:23], s61 offen nt lds
    v_mfma_f32_16x16x32_bf16 v[188:191], v[68:71], v[92:95], v[188:191]
    v_add_u32 v20, s55, v20
    v_add_u32 v21, s55, v21
    v_mfma_f32_16x16x32_bf16 v[204:207], v[68:71], v[96:99], v[204:207]
    v_add_u32 v22, s55, v22
    v_add_u32 v23, s55, v23
    v_mfma_f32_16x16x32_bf16 v[220:223], v[68:71], v[100:103], v[220:223]
    v_add_u32 v10, s54, v10
    v_add_u32 v11, s54, v11
    s_sub_u32 s54, 0, s54
    s_mov_b32 m0, s60
    s_add_u32 s44, s44, 8192
    buffer_load_dwordx4 v38, s[20:23], s61 offen offset:1024 nt lds
    s_cmp_eq_u32 s44, 131072
    s_cselect_b32 s44, 524288, s44
    s_add_u32 s43, s43, 16384
    s_cmp_eq_u32 s43, 81920
    s_cselect_b32 s43, 0, s43
    v_mfma_f32_16x16x32_bf16 v[236:239], v[68:71], v[104:107], v[236:239]
    s_cmp_lg_u32 s41, 99
    s_cbranch_scc1 L_wopf_98
    v_lshlrev_b32 v2, 7, v1
    s_lshl_b32 s45, s38, 3
    s_add_u32 s45, s45, s35
    s_mul_i32 s45, s45, 36864
    s_mul_i32 s46, s37, 1179648
    s_add_u32 s45, s45, s46
    s_mul_i32 s47, s40, 9216
    s_add_u32 s47, s47, s45
    buffer_load_dword v132, v2, s[24:27], s47 offen
    s_add_u32 s47, s47, 1024
    buffer_load_dword v132, v2, s[24:27], s47 offen
L_wopf_98:
    s_cmp_lg_u32 s33, 4
    s_cbranch_scc1 L_fc2_100
    s_cmp_lg_u32 s41, 4
    s_cbranch_scc1 L_fc_99
    s_lshl_b32 s45, s59, 2
    v_mov_b32 v130, s45
    s_lshl_b32 s45, s48, 2
    v_mov_b32 v131, s45
    global_load_dword v128, v130, s[4:5] sc1
    global_load_dword v129, v131, s[4:5] sc1
L_fc_99:
    s_cmp_lg_u32 s41, 8
    s_cbranch_scc1 L_fc2_100
    s_mov_b32 s46, 0
    s_branch L_fchk1_103
L_fchk_101:
    s_lshl_b32 s45, s59, 2
    v_mov_b32 v130, s45
    s_lshl_b32 s45, s48, 2
    v_mov_b32 v131, s45
    global_load_dword v128, v130, s[4:5] sc1
    global_load_dword v129, v131, s[4:5] sc1
    s_waitcnt vmcnt(0)
L_fchk1_103:
    v_and_b32 v128, 0xffff, v128
    v_lshrrev_b32 v129, 16, v129
    v_min_u32 v128, v128, v129
    s_nop 0
    v_readfirstlane_b32 s47, v128
    s_add_u32 s46, s46, 1
    s_cmp_ge_u32 s47, 4
    s_cbranch_scc1 L_fchkd_102
    s_cmp_ge_u32 s46, 100000
    s_cbranch_scc1 L_fchkd_102
    s_sleep 8
    s_branch L_fchk_101
L_fchkd_102:
L_fc2_100:
    s_waitcnt lgkmcnt(0)
    s_waitcnt vmcnt(12)
    s_barrier
    s_add_u32 s41, s41, 2
    s_cmp_lt_u32 s41, 12
    s_cbranch_scc1 L_ga_97
    v_mfma_f32_16x16x32_bf16 v[160:163], v[72:75], v[108:111], v[160:163]
    ds_read_b128 v[88:91], v10 offset:0
    s_add_u32 s76, s66, s72
    s_add_u32 s77, s68, s73
    s_mov_b32 m0, s77
    s_add_u32 s66, s66, 128
    buffer_load_dwordx4 v32, s[8:11], s76 offen  lds
    s_cmp_eq_u32 s66, 1152
    s_cselect_b32 s66, 0, s66
    v_mfma_f32_16x16x32_bf16 v[176:179], v[72:75], v[112:115], v[176:179]
    ds_read_b128 v[92:95], v10 offset:2048
    v_mfma_f32_16x16x32_bf16 v[192:195], v[72:75], v[116:119], v[192:195]
    s_mov_b32 m0, s77
    s_nop 0
    buffer_load_dwordx4 v33, s[8:11], s76 offen offset:1024  lds
    v_mfma_f32_16x16x32_bf16 v[208:211], v[72:75], v[120:123], v[208:211]
    ds_read_b128 v[96:99], v10 offset:4096
    v_mfma_f32_16x16x32_bf16 v[224:227], v[72:75], v[124:127], v[224:227]
    ds_read_b128 v[100:103], v10 offset:6144
    s_mov_b32 m0, s77
    s_nop 0
    buffer_load_dwordx4 v34, s[8:11], s76 offen offset:2048  lds
    v_mfma_f32_16x16x32_bf16 v[164:167], v[76:79], v[108:111], v[164:167]
    v_mfma_f32_16x16x32_bf16 v[180:183], v[76:79], v[112:115], v[180:183]
    ds_read_b128 v[104:107], v10 offset:8192
    s_mov_b32 m0, s77
    s_nop 0
    buffer_load_dwordx4 v35, s[8:11], s76 offen offset:3072  lds
    v_mfma_f32_16x16x32_bf16 v[196:199], v[76:79], v[116:119], v[196:199]
    ds_read_b64_tr_b16 v[56:57], v20
    ds_read_b64_tr_b16 v[58:59], v20 offset:1024
    v_mfma_f32_16x16x32_bf16 v[212:215], v[76:79], v[120:123], v[212:215]
    s_add_u32 s77, s77, 4096
    s_mov_b32 m0, s77
    s_sub_u32 s68, 20480, s68
    buffer_load_dwordx4 v36, s[8:11], s76 offen  lds
    v_mfma_f32_16x16x32_bf16 v[228:231], v[76:79], v[124:127], v[228:231]
    ds_read_b64_tr_b16 v[60:61], v21
    ds_read_b64_tr_b16 v[62:63], v21 offset:1024
    v_mfma_f32_16x16x32_bf16 v[168:171], v[80:83], v[108:111], v[168:171]
    ds_read_b64_tr_b16 v[64:65], v22
    ds_read_b64_tr_b16 v[66:67], v22 offset:1024
    s_add_u32 s74, s62, s63
    s_add_u32 s75, s65, s69
    s_mov_b32 m0, s75
    s_add_u32 s62, s62, 262144
    buffer_load_dwordx4 v28, s[12:15], s74 offen  lds
    s_cmp_eq_u32 s62, 4718592
    s_cselect_b32 s62, 0, s62
    s_add_u32 s64, s64, 1
    v_mfma_f32_16x16x32_bf16 v[184:187], v[80:83], v[112:115], v[184:187]
    s_mov_b32 m0, s75
    s_add_u32 s65, s65, 8192
    buffer_load_dwordx4 v29, s[12:15], s74 offen offset:1024  lds
    s_and_b32 s65, s65, 0x7fff
    s_add_u32 s75, s63, 1024
    s_cmp_eq_u32 s64, 18
    s_cselect_b32 s63, s75, s63
    v_mfma_f32_16x16x32_bf16 v[200:203], v[80:83], v[116:119], v[200:203]
    ds_read_b64_tr_b16 v[68:69], v23
    ds_read_b64_tr_b16 v[70:71], v23 offset:1024
    v_mfma_f32_16x16x32_bf16 v[216:219], v[80:83], v[120:123], v[216:219]
    s_add_u32 s60, s43, s57
    s_add_u32 s61, s44, s57
    s_mov_b32 m0, s60
    v_xor_b32 v37, 64, v30
    buffer_load_dwordx4 v30, s[16:19], s61 offen nt lds
    v_mfma_f32_16x16x32_bf16 v[232:235], v[80:83], v[124:127], v[232:235]
    v_mfma_f32_16x16x32_bf16 v[172:175], v[84:87], v[108:111], v[172:175]
    s_add_u32 s78, s78, 8192
    s_mov_b32 s55, 8192
    s_cmp_eq_u32 s78, 32768
    s_cselect_b32 s78, 0, s78
    s_cselect_b32 s55, 4294942720, s55
    s_mov_b32 m0, s60
    s_nop 0
    buffer_load_dwordx4 v37, s[16:19], s61 offen offset:1024 nt lds
    v_mfma_f32_16x16x32_bf16 v[188:191], v[84:87], v[112:115], v[188:191]
    v_add_u32 v20, s55, v20
    v_add_u32 v21, s55, v21
    v_mfma_f32_16x16x32_bf16 v[204:207], v[84:87], v[116:119], v[204:207]
    s_add_u32 s60, s60, 8192
    s_mov_b32 m0, s60
    v_xor_b32 v38, 128, v31
    buffer_load_dwordx4 v31, s[20:23], s61 offen nt lds
    v_mfma_f32_16x16x32_bf16 v[220:223], v[84:87], v[120:123], v[220:223]
    v_add_u32 v22, s55, v22
    v_add_u32 v23, s55, v23
    v_mfma_f32_16x16x32_bf16 v[236:239], v[84:87], v[124:127], v[236:239]
    s_mov_b32 m0, s60
    s_add_u32 s44, s44, 8192
    buffer_load_dwordx4 v38, s[20:23], s61 offen offset:1024 nt lds
    s_cmp_eq_u32 s44, 131072
    s_cselect_b32 s44, 524288, s44
    s_add_u32 s43, s43, 16384
    s_cmp_eq_u32 s43, 81920
    s_cselect_b32 s43, 0, s43
    s_waitcnt lgkmcnt(0)
    s_waitcnt vmcnt(17)
    s_barrier
    v_mfma_f32_16x16x32_bf16 v[160:163], v[56:59], v[88:91], v[160:163]
    ds_read_b128 v[108:111], v11 offset:0
    v_mfma_f32_16x16x32_bf16 v[176:179], v[56:59], v[92:95], v[176:179]
    ds_read_b128 v[112:115], v11 offset:2048
    v_mfma_f32_16x16x32_bf16 v[192:195], v[56:59], v[96:99], v[192:195]
    s_add_u32 s60, s43, s57
    s_add_u32 s61, s44, s57
    s_mov_b32 m0, s60
    v_xor_b32 v37, 64, v30
    buffer_load_dwordx4 v30, s[16:19], s61 offen nt lds
    v_mfma_f32_16x16x32_bf16 v[208:211], v[56:59], v[100:103], v[208:211]
    ds_read_b128 v[116:119], v11 offset:4096
    v_mfma_f32_16x16x32_bf16 v[224:227], v[56:59], v[104:107], v[224:227]
    ds_read_b128 v[120:123], v11 offset:6144
    v_mfma_f32_16x16x32_bf16 v[164:167], v[60:63], v[88:91], v[164:167]
    v_mfma_f32_16x16x32_bf16 v[180:183], v[60:63], v[92:95], v[180:183]
    ds_read_b128 v[124:127], v11 offset:8192
    v_mfma_f32_16x16x32_bf16 v[196:199], v[60:63], v[96:99], v[196:199]
    ds_read_b64_tr_b16 v[72:73], v20
    ds_read_b64_tr_b16 v[74:75], v20 offset:1024
    s_mov_b32 m0, s60
    s_nop 0
    buffer_load_dwordx4 v37, s[16:19], s61 offen offset:1024 nt lds
    v_mfma_f32_16x16x32_bf16 v[212:215], v[60:63], v[100:103], v[212:215]
    v_mfma_f32_16x16x32_bf16 v[228:231], v[60:63], v[104:107], v[228:231]
    ds_read_b64_tr_b16 v[76:77], v21
    ds_read_b64_tr_b16 v[78:79], v21 offset:1024
    v_mfma_f32_16x16x32_bf16 v[168:171], v[64:67], v[88:91], v[168:171]
    ds_read_b64_tr_b16 v[80:81], v22
    ds_read_b64_tr_b16 v[82:83], v22 offset:1024
    v_mfma_f32_16x16x32_bf16 v[184:187], v[64:67], v[92:95], v[184:187]
    v_mfma_f32_16x16x32_bf16 v[200:203], v[64:67], v[96:99], v[200:203]
    ds_read_b64_tr_b16 v[84:85], v23
    ds_read_b64_tr_b16 v[86:87], v23 offset:1024
    s_add_u32 s60, s60, 8192
    s_mov_b32 m0, s60
    v_xor_b32 v38, 128, v31
    buffer_load_dwordx4 v31, s[20:23], s61 offen nt lds
    v_mfma_f32_16x16x32_bf16 v[216:219], v[64:67], v[100:103], v[216:219]
    v_mfma_f32_16x16x32_bf16 v[232:235], v[64:67], v[104:107], v[232:235]
    v_mfma_f32_16x16x32_bf16 v[172:175], v[68:71], v[88:91], v[172:175]
    s_add_u32 s78, s78, 8192
    s_mov_b32 s55, 8192
    s_cmp_eq_u32 s78, 32768
    s_cselect_b32 s78, 0, s78
    s_cselect_b32 s55, 4294942720, s55
    v_mfma_f32_16x16x32_bf16 v[188:191], v[68:71], v[92:95], v[188:191]
    v_add_u32 v20, s55, v20
    v_add_u32 v21, s55, v21
    v_mfma_f32_16x16x32_bf16 v[204:207], v[68:71], v[96:99], v[204:207]
    v_add_u32 v22, s55, v22
    v_add_u32 v23, s55, v23
    s_mov_b32 m0, s60
    s_add_u32 s44, s44, 8192
    buffer_load_dwordx4 v38, s[20:23], s61 offen offset:1024 nt lds
    s_cmp_eq_u32 s44, 131072
    s_cselect_b32 s44, 524288, s44
    s_add_u32 s43, s43, 16384
    s_cmp_eq_u32 s43, 81920
    s_cselect_b32 s43, 0, s43
    v_mfma_f32_16x16x32_bf16 v[220:223], v[68:71], v[100:103], v[220:223]
    v_add_u32 v10, s54, v10
    v_add_u32 v11, s54, v11
    s_sub_u32 s54, 0, s54
    v_mfma_f32_16x16x32_bf16 v[236:239], v[68:71], v[104:107], v[236:239]
    s_waitcnt lgkmcnt(0)
    s_waitcnt vmcnt(10)
    s_barrier
    v_mfma_f32_16x16x32_bf16 v[160:163], v[72:75], v[108:111], v[160:163]
    ds_read_b128 v[88:91], v10 offset:0
    v_mfma_f32_16x16x32_bf16 v[176:179], v[72:75], v[112:115], v[176:179]
    ds_read_b128 v[92:95], v10 offset:2048
    v_mfma_f32_16x16x32_bf16 v[192:195], v[72:75], v[116:119], v[192:195]
    s_add_u32 s60, s43, s57
    s_add_u32 s61, s44, s57
    s_mov_b32 m0, s60
    v_xor_b32 v37, 64, v30
    buffer_load_dwordx4 v30, s[16:19], s61 offen nt lds
    v_mfma_f32_16x16x32_bf16 v[208:211], v[72:75], v[120:123], v[208:211]
    ds_read_b128 v[96:99], v10 offset:4096
    v_mfma_f32_16x16x32_bf16 v[224:227], v[72:75], v[124:127], v[224:227]
    ds_read_b128 v[100:103], v10 offset:6144
    v_mfma_f32_16x16x32_bf16 v[164:167], v[76:79], v[108:111], v[164:167]
    v_mfma_f32_16x16x32_bf16 v[180:183], v[76:79], v[112:115], v[180:183]
    ds_read_b128 v[104:107], v10 offset:8192
    v_mfma_f32_16x16x32_bf16 v[196:199], v[76:79], v[116:119], v[196:199]
    ds_read_b64_tr_b16 v[56:57], v20
    ds_read_b64_tr_b16 v[58:59], v20 offset:1024
    s_mov_b32 m0, s60
    s_nop 0
    buffer_load_dwordx4 v37, s[16:19], s61 offen offset:1024 nt lds
    v_mfma_f32_16x16x32_bf16 v[212:215], v[76:79], v[120:123], v[212:215]
    v_mfma_f32_16x16x32_bf16 v[228:231], v[76:79], v[124:127], v[228:231]
    ds_read_b64_tr_b16 v[60:61], v21
    ds_read_b64_tr_b16 v[62:63], v21 offset:1024
    v_mfma_f32_16x16x32_bf16 v[168:171], v[80:83], v[108:111], v[168:171]
    ds_read_b64_tr_b16 v[64:65], v22
    ds_read_b64_tr_b16 v[66:67], v22 offset:1024
    v_mfma_f32_16x16x32_bf16 v[184:187], v[80:83], v[112:115], v[184:187]
    v_mfma_f32_16x16x32_bf16 v[200:203], v[80:83], v[116:119], v[200:203]
    ds_read_b64_tr_b16 v[68:69], v23
    ds_read_b64_tr_b16 v[70:71], v23 offset:1024
    s_add_u32 s60, s60, 8192
    s_mov_b32 m0, s60
    v_xor_b32 v38, 128, v31
    buffer_load_dwordx4 v31, s[20:23], s61 offen nt lds
    v_mfma_f32_16x16x32_bf16 v[216:219], v[80:83], v[120:123], v[216:219]
    v_mfma_f32_16x16x32_bf16 v[232:235], v[80:83], v[124:127], v[232:235]
    v_mfma_f32_16x16x32_bf16 v[172:175], v[84:87], v[108:111], v[172:175]
    s_add_u32 s78, s78, 8192
    s_mov_b32 s55, 8192
    s_cmp_eq_u32 s78, 32768
    s_cselect_b32 s78, 0, s78
    s_cselect_b32 s55, 4294942720, s55
    v_mfma_f32_16x16x32_bf16 v[188:191], v[84:87], v[112:115], v[188:191]
    v_add_u32 v20, s55, v20
    v_add_u32 v21, s55, v21
    v_mfma_f32_16x16x32_bf16 v[204:207], v[84:87], v[116:119], v[204:207]
    s_mov_b32 m0, s60
    s_add_u32 s44, s44, 8192
    buffer_load_dwordx4 v38, s[20:23], s61 offen offset:1024 nt lds
    s_cmp_eq_u32 s44, 131072
    s_cselect_b32 s44, 524288, s44
    s_add_u32 s43, s43, 16384
    s_cmp_eq_u32 s43, 81920
    s_cselect_b32 s43, 0, s43
    v_mfma_f32_16x16x32_bf16 v[220:223], v[84:87], v[120:123], v[220:223]
    v_add_u32 v22, s55, v22
    v_add_u32 v23, s55, v23
    v_mfma_f32_16x16x32_bf16 v[236:239], v[84:87], v[124:127], v[236:239]
    s_waitcnt lgkmcnt(0)
    s_waitcnt vmcnt(8)
    s_barrier
    v_mfma_f32_16x16x32_bf16 v[160:163], v[56:59], v[88:91], v[160:163]
    ds_read_b128 v[108:111], v11 offset:0
    v_mfma_f32_16x16x32_bf16 v[176:179], v[56:59], v[92:95], v[176:179]
    ds_read_b128 v[112:115], v11 offset:2048
    v_mfma_f32_16x16x32_bf16 v[192:195], v[56:59], v[96:99], v[192:195]
    s_add_u32 s60, s43, s57
    s_add_u32 s61, s44, s57
    s_mov_b32 m0, s60
    v_xor_b32 v37, 64, v30
    buffer_load_dwordx4 v30, s[16:19], s61 offen nt lds
    v_mfma_f32_16x16x32_bf16 v[208:211], v[56:59], v[100:103], v[208:211]
    ds_read_b128 v[116:119], v11 offset:4096
    v_mfma_f32_16x16x32_bf16 v[224:227], v[56:59], v[104:107], v[224:227]
    ds_read_b128 v[120:123], v11 offset:6144
    v_mfma_f32_16x16x32_bf16 v[164:167], v[60:63], v[88:91], v[164:167]
    v_mfma_f32_16x16x32_bf16 v[180:183], v[60:63], v[92:95], v[180:183]
    ds_read_b128 v[124:127], v11 offset:8192
    v_mfma_f32_16x16x32_bf16 v[196:199], v[60:63], v[96:99], v[196:199]
    ds_read_b64_tr_b16 v[72:73], v20
    ds_read_b64_tr_b16 v[74:75], v20 offset:1024
    s_mov_b32 m0, s60
    s_nop 0
    buffer_load_dwordx4 v37, s[16:19], s61 offen offset:1024 nt lds
    v_mfma_f32_16x16x32_bf16 v[212:215], v[60:63], v[100:103], v[212:215]
    v_mfma_f32_16x16x32_bf16 v[228:231], v[60:63], v[104:107], v[228:231]
    ds_read_b64_tr_b16 v[76:77], v21
    ds_read_b64_tr_b16 v[78:79], v21 offset:1024
    v_mfma_f32_16x16x32_bf16 v[168:171], v[64:67], v[88:91], v[168:171]
    ds_read_b64_tr_b16 v[80:81], v22
    ds_read_b64_tr_b16 v[82:83], v22 offset:1024
    v_mfma_f32_16x16x32_bf16 v[184:187], v[64:67], v[92:95], v[184:187]
    v_mfma_f32_16x16x32_bf16 v[200:203], v[64:67], v[96:99], v[200:203]
    ds_read_b64_tr_b16 v[84:85], v23
    ds_read_b64_tr_b16 v[86:87], v23 offset:1024
    s_add_u32 s60, s60, 8192
    s_mov_b32 m0, s60
    v_xor_b32 v38, 128, v31
    buffer_load_dwordx4 v31, s[20:23], s61 offen nt lds
    v_mfma_f32_16x16x32_bf16 v[216:219], v[64:67], v[100:103], v[216:219]
    v_mfma_f32_16x16x32_bf16 v[232:235], v[64:67], v[104:107], v[232:235]
    v_mfma_f32_16x16x32_bf16 v[172:175], v[68:71], v[88:91], v[172:175]
    s_add_u32 s78, s78, 8192
    s_mov_b32 s55, 8192
    s_cmp_eq_u32 s78, 32768
    s_cselect_b32 s78, 0, s78
    s_cselect_b32 s55, 4294942720, s55
    v_mfma_f32_16x16x32_bf16 v[188:191], v[68:71], v[92:95], v[188:191]
    v_add_u32 v20, s55, v20
    v_add_u32 v21, s55, v21
    v_mfma_f32_16x16x32_bf16 v[204:207], v[68:71], v[96:99], v[204:207]
    v_add_u32 v22, s55, v22
    v_add_u32 v23, s55, v23
    s_mov_b32 m0, s60
    s_add_u32 s44, s44, 8192
    buffer_load_dwordx4 v38, s[20:23], s61 offen offset:1024 nt lds
    s_cmp_eq_u32 s44, 131072
    s_cselect_b32 s44, 524288, s44
    s_add_u32 s43, s43, 16384
    s_cmp_eq_u32 s43, 81920
    s_cselect_b32 s43, 0, s43
    v_mfma_f32_16x16x32_bf16 v[220:223], v[68:71], v[100:103], v[220:223]
    v_add_u32 v10, s54, v10
    v_add_u32 v11, s54, v11
    s_sub_u32 s54, 0, s54
    v_mfma_f32_16x16x32_bf16 v[236:239], v[68:71], v[104:107], v[236:239]
    s_waitcnt lgkmcnt(0)
    s_waitcnt vmcnt(8)
    s_barrier
    v_mfma_f32_16x16x32_bf16 v[160:163], v[72:75], v[108:111], v[160:163]
    v_mfma_f32_16x16x32_bf16 v[176:179], v[72:75], v[112:115], v[176:179]
    v_mfma_f32_16x16x32_bf16 v[192:195], v[72:75], v[116:119], v[192:195]
    v_mfma_f32_16x16x32_bf16 v[208:211], v[72:75], v[120:123], v[208:211]
    v_mfma_f32_16x16x32_bf16 v[224:227], v[72:75], v[124:127], v[224:227]
    v_mfma_f32_16x16x32_bf16 v[164:167], v[76:79], v[108:111], v[164:167]
    v_mfma_f32_16x16x32_bf16 v[180:183], v[76:79], v[112:115], v[180:183]
    v_mfma_f32_16x16x32_bf16 v[196:199], v[76:79], v[116:119], v[196:199]
    v_mfma_f32_16x16x32_bf16 v[212:215], v[76:79], v[120:123], v[212:215]
    v_mfma_f32_16x16x32_bf16 v[228:231], v[76:79], v[124:127], v[228:231]
    v_mfma_f32_16x16x32_bf16 v[168:171], v[80:83], v[108:111], v[168:171]
    v_mfma_f32_16x16x32_bf16 v[184:187], v[80:83], v[112:115], v[184:187]
    v_mfma_f32_16x16x32_bf16 v[200:203], v[80:83], v[116:119], v[200:203]
    v_mfma_f32_16x16x32_bf16 v[216:219], v[80:83], v[120:123], v[216:219]
    v_mfma_f32_16x16x32_bf16 v[232:235], v[80:83], v[124:127], v[232:235]
    v_mfma_f32_16x16x32_bf16 v[172:175], v[84:87], v[108:111], v[172:175]
    v_mfma_f32_16x16x32_bf16 v[188:191], v[84:87], v[112:115], v[188:191]
    v_mfma_f32_16x16x32_bf16 v[204:207], v[84:87], v[116:119], v[204:207]
    v_mfma_f32_16x16x32_bf16 v[220:223], v[84:87], v[120:123], v[220:223]
    v_mfma_f32_16x16x32_bf16 v[236:239], v[84:87], v[124:127], v[236:239]
    s_mov_b32 s80, 0x3e0293ee
    s_mov_b32 s81, 0x3e0293ee
    s_nop 3
    v_pk_mul_f32 v[160:161], v[160:161], s[80:81]
    v_pk_mul_f32 v[162:163], v[162:163], s[80:81]
    v_pk_mul_f32 v[164:165], v[164:165], s[80:81]
    v_pk_mul_f32 v[166:167], v[166:167], s[80:81]
    v_cvt_pk_bf16_f32 v2, v160, v161
    v_cvt_pk_bf16_f32 v3, v162, v163
    v_cvt_pk_bf16_f32 v4, v164, v165
    v_cvt_pk_bf16_f32 v5, v166, v167
    v_cndmask_b32 v112, v2, v4, s[52:53]
    v_cndmask_b32 v113, v3, v5, s[52:53]
    v_cndmask_b32 v114, v4, v2, s[52:53]
    v_cndmask_b32 v115, v5, v3, s[52:53]
    v_pk_mul_f32 v[168:169], v[168:169], s[80:81]
    v_pk_mul_f32 v[170:171], v[170:171], s[80:81]
    v_pk_mul_f32 v[172:173], v[172:173], s[80:81]
    v_pk_mul_f32 v[174:175], v[174:175], s[80:81]
    v_cvt_pk_bf16_f32 v2, v168, v169
    v_cvt_pk_bf16_f32 v3, v170, v171
    v_cvt_pk_bf16_f32 v4, v172, v173
    v_cvt_pk_bf16_f32 v5, v174, v175
    v_cndmask_b32 v116, v2, v4, s[52:53]
    v_cndmask_b32 v117, v3, v5, s[52:53]
    v_cndmask_b32 v118, v4, v2, s[52:53]
    v_cndmask_b32 v119, v5, v3, s[52:53]
    v_pk_mul_f32 v[176:177], v[176:177], s[80:81]
    v_pk_mul_f32 v[178:179], v[178:179], s[80:81]
    v_pk_mul_f32 v[180:181], v[180:181], s[80:81]
    v_pk_mul_f32 v[182:183], v[182:183], s[80:81]
    v_cvt_pk_bf16_f32 v2, v176, v177
    v_cvt_pk_bf16_f32 v3, v178, v179
    v_cvt_pk_bf16_f32 v4, v180, v181
    v_cvt_pk_bf16_f32 v5, v182, v183
    v_cndmask_b32 v120, v2, v4, s[52:53]
    v_cndmask_b32 v121, v3, v5, s[52:53]
    v_cndmask_b32 v122, v4, v2, s[52:53]
    v_cndmask_b32 v123, v5, v3, s[52:53]
    v_pk_mul_f32 v[184:185], v[184:185], s[80:81]
    v_pk_mul_f32 v[186:187], v[186:187], s[80:81]
    v_pk_mul_f32 v[188:189], v[188:189], s[80:81]
    v_pk_mul_f32 v[190:191], v[190:191], s[80:81]
    v_cvt_pk_bf16_f32 v2, v184, v185
    v_cvt_pk_bf16_f32 v3, v186, v187
    v_cvt_pk_bf16_f32 v4, v188, v189
    v_cvt_pk_bf16_f32 v5, v190, v191
    v_cndmask_b32 v124, v2, v4, s[52:53]
    v_cndmask_b32 v125, v3, v5, s[52:53]
    v_cndmask_b32 v126, v4, v2, s[52:53]
    v_cndmask_b32 v127, v5, v3, s[52:53]
    v_pk_mul_f32 v[192:193], v[192:193], s[80:81]
    v_pk_mul_f32 v[194:195], v[194:195], s[80:81]
    v_pk_mul_f32 v[196:197], v[196:197], s[80:81]
    v_pk_mul_f32 v[198:199], v[198:199], s[80:81]
    v_cvt_pk_bf16_f32 v2, v192, v193
    v_cvt_pk_bf16_f32 v3, v194, v195
    v_cvt_pk_bf16_f32 v4, v196, v197
    v_cvt_pk_bf16_f32 v5, v198, v199
    v_cndmask_b32 v128, v2, v4, s[52:53]
    v_cndmask_b32 v129, v3, v5, s[52:53]
    v_cndmask_b32 v130, v4, v2, s[52:53]
    v_cndmask_b32 v131, v5, v3, s[52:53]
    v_pk_mul_f32 v[200:201], v[200:201], s[80:81]
    v_pk_mul_f32 v[202:203], v[202:203], s[80:81]
    v_pk_mul_f32 v[204:205], v[204:205], s[80:81]
    v_pk_mul_f32 v[206:207], v[206:207], s[80:81]
    v_cvt_pk_bf16_f32 v2, v200, v201
    v_cvt_pk_bf16_f32 v3, v202, v203
    v_cvt_pk_bf16_f32 v4, v204, v205
    v_cvt_pk_bf16_f32 v5, v206, v207
    v_cndmask_b32 v132, v2, v4, s[52:53]
    v_cndmask_b32 v133, v3, v5, s[52:53]
    v_cndmask_b32 v134, v4, v2, s[52:53]
    v_cndmask_b32 v135, v5, v3, s[52:53]
    v_pk_mul_f32 v[208:209], v[208:209], s[80:81]
    v_pk_mul_f32 v[210:211], v[210:211], s[80:81]
    v_pk_mul_f32 v[212:213], v[212:213], s[80:81]
    v_pk_mul_f32 v[214:215], v[214:215], s[80:81]
    v_cvt_pk_bf16_f32 v2, v208, v209
    v_cvt_pk_bf16_f32 v3, v210, v211
    v_cvt_pk_bf16_f32 v4, v212, v213
    v_cvt_pk_bf16_f32 v5, v214, v215
    v_cndmask_b32 v136, v2, v4, s[52:53]
    v_cndmask_b32 v137, v3, v5, s[52:53]
    v_cndmask_b32 v138, v4, v2, s[52:53]
    v_cndmask_b32 v139, v5, v3, s[52:53]
    v_pk_mul_f32 v[216:217], v[216:217], s[80:81]
    v_pk_mul_f32 v[218:219], v[218:219], s[80:81]
    v_pk_mul_f32 v[220:221], v[220:221], s[80:81]
    v_pk_mul_f32 v[222:223], v[222:223], s[80:81]
    v_cvt_pk_bf16_f32 v2, v216, v217
    v_cvt_pk_bf16_f32 v3, v218, v219
    v_cvt_pk_bf16_f32 v4, v220, v221
    v_cvt_pk_bf16_f32 v5, v222, v223
    v_cndmask_b32 v140, v2, v4, s[52:53]
    v_cndmask_b32 v141, v3, v5, s[52:53]
    v_cndmask_b32 v142, v4, v2, s[52:53]
    v_cndmask_b32 v143, v5, v3, s[52:53]
    v_pk_mul_f32 v[224:225], v[224:225], s[80:81]
    v_pk_mul_f32 v[226:227], v[226:227], s[80:81]
    v_pk_mul_f32 v[228:229], v[228:229], s[80:81]
    v_pk_mul_f32 v[230:231], v[230:231], s[80:81]
    v_cvt_pk_bf16_f32 v2, v224, v225
    v_cvt_pk_bf16_f32 v3, v226, v227
    v_cvt_pk_bf16_f32 v4, v228, v229
    v_cvt_pk_bf16_f32 v5, v230, v231
    v_cndmask_b32 v144, v2, v4, s[52:53]
    v_cndmask_b32 v145, v3, v5, s[52:53]
    v_cndmask_b32 v146, v4, v2, s[52:53]
    v_cndmask_b32 v147, v5, v3, s[52:53]
    v_pk_mul_f32 v[232:233], v[232:233], s[80:81]
    v_pk_mul_f32 v[234:235], v[234:235], s[80:81]
    v_pk_mul_f32 v[236:237], v[236:237], s[80:81]
    v_pk_mul_f32 v[238:239], v[238:239], s[80:81]
    v_cvt_pk_bf16_f32 v2, v232, v233
    v_cvt_pk_bf16_f32 v3, v234, v235
    v_cvt_pk_bf16_f32 v4, v236, v237
    v_cvt_pk_bf16_f32 v5, v238, v239
    v_cndmask_b32 v148, v2, v4, s[52:53]
    v_cndmask_b32 v149, v3, v5, s[52:53]
    v_cndmask_b32 v150, v4, v2, s[52:53]
    v_cndmask_b32 v151, v5, v3, s[52:53]
    v_lshlrev_b32 v2, 4, v1
    s_lshl_b32 s45, s79, 12
    s_lshl_b32 s46, s32, 4
    s_add_u32 s45, s45, s46
    s_add_u32 s45, s45, 81920
    v_add_u32 v2, s45, v2
    ds_write_b128 v2, v[112:115] offset:0
    ds_write_b128 v2, v[116:119] offset:1024
    ds_write_b128 v2, v[120:123] offset:4096
    ds_write_b128 v2, v[124:127] offset:5120
    ds_write_b128 v2, v[128:131] offset:8192
    ds_write_b128 v2, v[132:135] offset:9216
    ds_write_b128 v2, v[136:139] offset:12288
    ds_write_b128 v2, v[140:143] offset:13312
    ds_write_b128 v2, v[144:147] offset:16384
    ds_write_b128 v2, v[148:151] offset:17408
    s_waitcnt lgkmcnt(0)
    s_barrier
    v_lshlrev_b32 v26, 4, v1
    s_mul_i32 s45, s37, 1179648
    s_add_u32 s24, s24, s45
    s_addc_u32 s25, s25, 0
    s_mov_b32 s26, 1179648
    s_lshl_b32 s45, s34, 3
    s_add_u32 s45, s45, s35
    s_lshl_b32 s45, s45, 5
    s_lshl_b32 s46, s37, 3
    s_add_u32 s45, s45, s46
    s_mul_i32 s45, s45, 40960
    s_add_u32 s8, s6, s45
    s_addc_u32 s9, s7, 0
    s_mov_b32 s10, 327680
    s_mov_b32 s11, 0x20000
    s_mov_b32 s76, 81920
    s_and_b32 s47, s40, 1
    s_mul_i32 s62, s47, 5120
    s_add_u32 s62, s62, 10240
    s_lshl_b32 s63, s47, 12
    s_add_u32 s63, s63, 14336
    s_mul_i32 s75, s47, 320
    s_mul_i32 s78, s38, 288
    s_add_u32 s45, s75, 0
    v_add_u32 v2, s45, v1
    s_mov_b32 s46, 3641
    v_mul_u32_u24 v3, s46, v2
    v_lshrrev_b32 v3, 16, v3
    v_mul_u32_u24 v4, 18, v3
    v_sub_u32 v4, v2, v4
    v_mul_u32_u24 v3, 1152, v3
    v_lshlrev_b32 v4, 4, v4
    v_add_u32 v3, v3, v4
    v_add_u32 v12, s78, v3
    s_add_u32 s45, s75, 64
    v_add_u32 v2, s45, v1
    s_mov_b32 s46, 3641
    v_mul_u32_u24 v3, s46, v2
    v_lshrrev_b32 v3, 16, v3
    v_mul_u32_u24 v4, 18, v3
    v_sub_u32 v4, v2, v4
    v_mul_u32_u24 v3, 1152, v3
    v_lshlrev_b32 v4, 4, v4
    v_add_u32 v3, v3, v4
    v_add_u32 v13, s78, v3
    v_subrev_u32 v13, 1024, v13
    s_add_u32 s45, s75, 128
    v_add_u32 v2, s45, v1
    s_mov_b32 s46, 3641
    v_mul_u32_u24 v3, s46, v2
    v_lshrrev_b32 v3, 16, v3
    v_mul_u32_u24 v4, 18, v3
    v_sub_u32 v4, v2, v4
    v_mul_u32_u24 v3, 1152, v3
    v_lshlrev_b32 v4, 4, v4
    v_add_u32 v3, v3, v4
    v_add_u32 v14, s78, v3
    v_subrev_u32 v14, 2048, v14
    s_add_u32 s45, s75, 192
    v_add_u32 v2, s45, v1
    s_mov_b32 s46, 3641
    v_mul_u32_u24 v3, s46, v2
    v_lshrrev_b32 v3, 16, v3
    v_mul_u32_u24 v4, 18, v3
    v_sub_u32 v4, v2, v4
    v_mul_u32_u24 v3, 1152, v3
    v_lshlrev_b32 v4, 4, v4
    v_add_u32 v3, v3, v4
    v_add_u32 v15, s78, v3
    v_subrev_u32 v15, 3072, v15
    s_lshl_b32 s45, s47, 8
    s_add_u32 s45, s45, 256
    v_add_u32 v2, s45, v1
    s_mov_b32 s46, 3641
    v_mul_u32_u24 v3, s46, v2
    v_lshrrev_b32 v3, 16, v3
    v_mul_u32_u24 v4, 18, v3
    v_sub_u32 v4, v2, v4
    v_mul_u32_u24 v3, 1152, v3
    v_lshlrev_b32 v4, 4, v4
    v_add_u32 v3, v3, v4
    v_add_u32 v16, s78, v3
    s_mov_b32 s75, 4294930432
    s_add_u32 s60, s43, s57
    s_add_u32 s61, s44, s57
    s_mov_b32 m0, s60
    v_xor_b32 v37, 64, v30
    buffer_load_dwordx4 v30, s[16:19], s61 offen nt lds
    s_mov_b32 m0, s60
    s_nop 0
    buffer_load_dwordx4 v37, s[16:19], s61 offen offset:1024 nt lds
    s_add_u32 s60, s60, 8192
    s_mov_b32 m0, s60
    v_xor_b32 v38, 128, v31
    buffer_load_dwordx4 v31, s[20:23], s61 offen nt lds
    s_mov_b32 m0, s60
    s_add_u32 s44, s44, 8192
    buffer_load_dwordx4 v38, s[20:23], s61 offen offset:1024 nt lds
    s_cmp_eq_u32 s44, 131072
    s_cselect_b32 s44, 524288, s44
    s_add_u32 s43, s43, 16384
    s_cmp_eq_u32 s43, 81920
    s_cselect_b32 s43, 0, s43
    s_waitcnt vmcnt(8)
    s_barrier
    s_add_u32 s60, s43, s57
    s_add_u32 s61, s44, s57
    s_mov_b32 m0, s60
    v_xor_b32 v37, 64, v30
    buffer_load_dwordx4 v30, s[16:19], s61 offen nt lds
    s_mov_b32 m0, s60
    s_nop 0
    buffer_load_dwordx4 v37, s[16:19], s61 offen offset:1024 nt lds
    s_add_u32 s60, s60, 8192
    s_mov_b32 m0, s60
    v_xor_b32 v38, 128, v31
    buffer_load_dwordx4 v31, s[20:23], s61 offen nt lds
    s_mov_b32 m0, s60
    s_add_u32 s44, s44, 8192
    buffer_load_dwordx4 v38, s[20:23], s61 offen offset:1024 nt lds
    s_cmp_eq_u32 s44, 131072
    s_cselect_b32 s44, 524288, s44
    s_add_u32 s43, s43, 16384
    s_cmp_eq_u32 s43, 81920
    s_cselect_b32 s43, 0, s43
    s_waitcnt vmcnt(8)
    s_barrier
    s_add_u32 s60, s43, s57
    s_add_u32 s61, s44, s57
    s_mov_b32 m0, s60
    v_xor_b32 v37, 64, v30
    buffer_load_dwordx4 v30, s[16:19], s61 offen nt lds
    s_mov_b32 m0, s60
    s_nop 0
    buffer_load_dwordx4 v37, s[16:19], s61 offen offset:1024 nt lds
    s_add_u32 s60, s60, 8192
    s_mov_b32 m0, s60
    v_xor_b32 v38, 128, v31
    buffer_load_dwordx4 v31, s[20:23], s61 offen nt lds
    s_mov_b32 m0, s60
    s_add_u32 s44, s44, 8192
    buffer_load_dwordx4 v38, s[20:23], s61 offen offset:1024 nt lds
    s_cmp_eq_u32 s44, 131072
    s_cselect_b32 s44, 524288, s44
    s_add_u32 s43, s43, 16384
    s_cmp_eq_u32 s43, 81920
    s_cselect_b32 s43, 0, s43
    s_waitcnt vmcnt(8)
    s_barrier
    s_add_u32 s60, s43, s57
    s_add_u32 s61, s44, s57
    s_mov_b32 m0, s60
    v_xor_b32 v37, 64, v30
    buffer_load_dwordx4 v30, s[16:19], s61 offen nt lds
    s_mov_b32 m0, s60
    s_nop 0
    buffer_load_dwordx4 v37, s[16:19], s61 offen offset:1024 nt lds
    s_add_u32 s60, s60, 8192
    s_mov_b32 m0, s60
    v_xor_b32 v38, 128, v31
    buffer_load_dwordx4 v31, s[20:23], s61 offen nt lds
    s_mov_b32 m0, s60
    s_add_u32 s44, s44, 8192
    buffer_load_dwordx4 v38, s[20:23], s61 offen offset:1024 nt lds
    s_cmp_eq_u32 s44, 131072
    s_cselect_b32 s44, 524288, s44
    s_add_u32 s43, s43, 16384
    s_cmp_eq_u32 s43, 81920
    s_cselect_b32 s43, 0, s43
    s_waitcnt vmcnt(8)
    s_barrier
    s_add_u32 s60, s43, s57
    s_add_u32 s61, s44, s57
    s_mov_b32 m0, s60
    v_xor_b32 v37, 64, v30
    buffer_load_dwordx4 v30, s[16:19], s61 offen nt lds
    s_mov_b32 m0, s60
    s_nop 0
    buffer_load_dwordx4 v37, s[16:19], s61 offen offset:1024 nt lds
    s_add_u32 s60, s60, 8192
    s_mov_b32 m0, s60
    v_xor_b32 v38, 128, v31
    buffer_load_dwordx4 v31, s[20:23], s61 offen nt lds
    s_mov_b32 m0, s60
    s_add_u32 s44, s44, 8192
    buffer_load_dwordx4 v38, s[20:23], s61 offen offset:1024 nt lds
    s_cmp_eq_u32 s44, 131072
    s_cselect_b32 s44, 524288, s44
    s_add_u32 s43, s43, 16384
    s_cmp_eq_u32 s43, 81920
    s_cselect_b32 s43, 0, s43
    s_waitcnt vmcnt(8)
    s_barrier
    s_add_u32 s60, s43, s57
    s_add_u32 s61, s44, s57
    s_mov_b32 m0, s60
    v_xor_b32 v37, 64, v30
    buffer_load_dwordx4 v30, s[16:19], s61 offen nt lds
    s_mov_b32 m0, s60
    s_nop 0
    buffer_load_dwordx4 v37, s[16:19], s61 offen offset:1024 nt lds
    s_add_u32 s60, s60, 8192
    s_mov_b32 m0, s60
    v_xor_b32 v38, 128, v31
    buffer_load_dwordx4 v31, s[20:23], s61 offen nt lds
    s_mov_b32 m0, s60
    s_add_u32 s44, s44, 8192
    buffer_load_dwordx4 v38, s[20:23], s61 offen offset:1024 nt lds
    s_cmp_eq_u32 s44, 131072
    s_cselect_b32 s44, 524288, s44
    s_add_u32 s43, s43, 16384
    s_cmp_eq_u32 s43, 81920
    s_cselect_b32 s43, 0, s43
    s_waitcnt vmcnt(8)
    s_barrier
    s_add_u32 s60, s43, s57
    s_add_u32 s61, s44, s57
    s_mov_b32 m0, s60
    v_xor_b32 v37, 64, v30
    buffer_load_dwordx4 v30, s[16:19], s61 offen nt lds
    s_mov_b32 m0, s60
    s_nop 0
    buffer_load_dwordx4 v37, s[16:19], s61 offen offset:1024 nt lds
    s_add_u32 s60, s60, 8192
    s_mov_b32 m0, s60
    v_xor_b32 v38, 128, v31
    buffer_load_dwordx4 v31, s[20:23], s61 offen nt lds
    s_mov_b32 m0, s60
    s_add_u32 s44, s44, 8192
    buffer_load_dwordx4 v38, s[20:23], s61 offen offset:1024 nt lds
    s_cmp_eq_u32 s44, 131072
    s_cselect_b32 s44, 524288, s44
    s_add_u32 s43, s43, 16384
    s_cmp_eq_u32 s43, 81920
    s_cselect_b32 s43, 0, s43
    s_waitcnt vmcnt(8)
    s_barrier
    s_add_u32 s60, s43, s57
    s_add_u32 s61, s44, s57
    s_mov_b32 m0, s60
    v_xor_b32 v37, 64, v30
    buffer_load_dwordx4 v30, s[16:19], s61 offen nt lds
    s_mov_b32 m0, s60
    s_nop 0
    buffer_load_dwordx4 v37, s[16:19], s61 offen offset:1024 nt lds
    s_add_u32 s60, s60, 8192
    s_mov_b32 m0, s60
    v_xor_b32 v38, 128, v31
    buffer_load_dwordx4 v31, s[20:23], s61 offen nt lds
    s_mov_b32 m0, s60
    s_add_u32 s44, s44, 8192
    buffer_load_dwordx4 v38, s[20:23], s61 offen offset:1024 nt lds
    s_cmp_eq_u32 s44, 131072
    s_cselect_b32 s44, 524288, s44
    s_add_u32 s43, s43, 16384
    s_cmp_eq_u32 s43, 81920
    s_cselect_b32 s43, 0, s43
    s_waitcnt vmcnt(8)
    s_barrier
    s_cmp_lg_u32 s33, 4
    s_cbranch_scc1 L_polld_105
    s_and_b32 s45, s49, 0xffffff00
    v_mov_b32 v2, 0
    s_mov_b32 s46, 0
L_poll_104:
    buffer_load_dwordx4 v[4:7], v2, s[28:31], s45 offen sc0 sc1
    s_waitcnt vmcnt(0)
    v_and_b32 v4, v4, v5
    v_and_b32 v6, v6, v7
    v_and_b32 v4, v4, v6
    s_nop 0
    v_readfirstlane_b32 s47, v4
    s_add_u32 s46, s46, 1
    s_and_b32 s47, s47, 1
    s_cmp_eq_u32 s47, 1
    s_cbranch_scc1 L_polld_105
    s_sleep 2
    s_cmp_lt_u32 s46, 200000
    s_cbranch_scc1 L_poll_104
L_polld_105:
    s_add_u32 s60, s43, s57
    s_add_u32 s61, s44, s57
    s_mov_b32 m0, s60
    v_xor_b32 v37, 64, v30
    buffer_load_dwordx4 v30, s[16:19], s61 offen nt lds
    s_mov_b32 m0, s60
    s_nop 0
    buffer_load_dwordx4 v37, s[16:19], s61 offen offset:1024 nt lds
    s_add_u32 s60, s60, 8192
    s_mov_b32 m0, s60
    v_xor_b32 v38, 128, v31
    buffer_load_dwordx4 v31, s[20:23], s61 offen nt lds
    s_mov_b32 m0, s60
    s_add_u32 s44, s44, 8192
    buffer_load_dwordx4 v38, s[20:23], s61 offen offset:1024 nt lds
    s_cmp_eq_u32 s44, 131072
    s_cselect_b32 s44, 524288, s44
    s_add_u32 s43, s43, 16384
    s_cmp_eq_u32 s43, 81920
    s_cselect_b32 s43, 0, s43
    s_waitcnt vmcnt(8)
    s_barrier
    s_add_u32 s60, s43, s57
    s_add_u32 s61, s44, s57
    s_mov_b32 m0, s60
    v_xor_b32 v37, 64, v30
    buffer_load_dwordx4 v30, s[16:19], s61 offen nt lds
    s_mov_b32 m0, s60
    s_nop 0
    buffer_load_dwordx4 v37, s[16:19], s61 offen offset:1024 nt lds
    s_add_u32 s60, s60, 8192
    s_mov_b32 m0, s60
    v_xor_b32 v38, 128, v31
    buffer_load_dwordx4 v31, s[20:23], s61 offen nt lds
    s_mov_b32 m0, s60
    s_add_u32 s44, s44, 8192
    buffer_load_dwordx4 v38, s[20:23], s61 offen offset:1024 nt lds
    s_cmp_eq_u32 s44, 131072
    s_cselect_b32 s44, 524288, s44
    s_add_u32 s43, s43, 16384
    s_cmp_eq_u32 s43, 81920
    s_cselect_b32 s43, 0, s43
    s_add_u32 m0, s76, s62
    s_add_u32 s75, s75, 36864
    buffer_load_dwordx4 v12, s[24:27], s75 offen  lds
    buffer_load_dwordx4 v13, s[24:27], s75 offen offset:1024  lds
    buffer_load_dwordx4 v14, s[24:27], s75 offen offset:2048  lds
    buffer_load_dwordx4 v15, s[24:27], s75 offen offset:3072  lds
    s_add_u32 m0, s76, s63
    s_nop 0
    buffer_load_dwordx4 v16, s[24:27], s75 offen  lds
    s_add_u32 s76, s76, 20480
    s_cmp_eq_u32 s76, 163840
    s_cselect_b32 s76, 0, s76
    s_waitcnt vmcnt(13)
    s_barrier
    s_add_u32 s60, s43, s57
    s_add_u32 s61, s44, s57
    s_mov_b32 m0, s60
    v_xor_b32 v37, 64, v30
    buffer_load_dwordx4 v30, s[16:19], s61 offen nt lds
    s_mov_b32 m0, s60
    s_nop 0
    buffer_load_dwordx4 v37, s[16:19], s61 offen offset:1024 nt lds
    s_add_u32 s60, s60, 8192
    s_mov_b32 m0, s60
    v_xor_b32 v38, 128, v31
    buffer_load_dwordx4 v31, s[20:23], s61 offen nt lds
    s_mov_b32 m0, s60
    s_add_u32 s44, s44, 8192
    buffer_load_dwordx4 v38, s[20:23], s61 offen offset:1024 nt lds
    s_cmp_eq_u32 s44, 131072
    s_cselect_b32 s44, 524288, s44
    s_add_u32 s43, s43, 16384
    s_cmp_eq_u32 s43, 81920
    s_cselect_b32 s43, 0, s43
    s_add_u32 m0, s76, s62
    s_add_u32 s75, s75, 36864
    buffer_load_dwordx4 v12, s[24:27], s75 offen  lds
    buffer_load_dwordx4 v13, s[24:27], s75 offen offset:1024  lds
    buffer_load_dwordx4 v14, s[24:27], s75 offen offset:2048  lds
    buffer_load_dwordx4 v15, s[24:27], s75 offen offset:3072  lds
    s_add_u32 m0, s76, s63
    s_nop 0
    buffer_load_dwordx4 v16, s[24:27], s75 offen  lds
    s_add_u32 s76, s76, 20480
    s_cmp_eq_u32 s76, 163840
    s_cselect_b32 s76, 0, s76
    s_waitcnt vmcnt(18)
    s_barrier
    s_add_u32 s60, s43, s57
    s_add_u32 s61, s44, s57
    s_mov_b32 m0, s60
    v_xor_b32 v37, 64, v30
    buffer_load_dwordx4 v30, s[16:19], s61 offen nt lds
    s_mov_b32 m0, s60
    s_nop 0
    buffer_load_dwordx4 v37, s[16:19], s61 offen offset:1024 nt lds
    s_add_u32 s60, s60, 8192
    s_mov_b32 m0, s60
    v_xor_b32 v38, 128, v31
    buffer_load_dwordx4 v31, s[20:23], s61 offen nt lds
    s_mov_b32 m0, s60
    s_add_u32 s44, s44, 8192
    buffer_load_dwordx4 v38, s[20:23], s61 offen offset:1024 nt lds
    s_cmp_eq_u32 s44, 131072
    s_cselect_b32 s44, 524288, s44
    s_add_u32 s43, s43, 16384
    s_cmp_eq_u32 s43, 81920
    s_cselect_b32 s43, 0, s43
    s_add_u32 m0, s76, s62
    s_add_u32 s75, s75, 36864
    buffer_load_dwordx4 v12, s[24:27], s75 offen  lds
    buffer_load_dwordx4 v13, s[24:27], s75 offen offset:1024  lds
    buffer_load_dwordx4 v14, s[24:27], s75 offen offset:2048  lds
    buffer_load_dwordx4 v15, s[24:27], s75 offen offset:3072  lds
    s_add_u32 m0, s76, s63
    s_nop 0
    buffer_load_dwordx4 v16, s[24:27], s75 offen  lds
    s_add_u32 s76, s76, 20480
    s_cmp_eq_u32 s76, 163840
    s_cselect_b32 s76, 0, s76
    s_waitcnt vmcnt(23)
    s_barrier
    s_add_u32 s60, s43, s57
    s_add_u32 s61, s44, s57
    s_mov_b32 m0, s60
    v_xor_b32 v37, 64, v30
    buffer_load_dwordx4 v30, s[16:19], s61 offen nt lds
    s_mov_b32 m0, s60
    s_nop 0
    buffer_load_dwordx4 v37, s[16:19], s61 offen offset:1024 nt lds
    s_add_u32 s60, s60, 8192
    s_mov_b32 m0, s60
    v_xor_b32 v38, 128, v31
    buffer_load_dwordx4 v31, s[20:23], s61 offen nt lds
    s_mov_b32 m0, s60
    s_add_u32 s44, s44, 8192
    buffer_load_dwordx4 v38, s[20:23], s61 offen offset:1024 nt lds
    s_cmp_eq_u32 s44, 131072
    s_cselect_b32 s44, 524288, s44
    s_add_u32 s43, s43, 16384
    s_cmp_eq_u32 s43, 81920
    s_cselect_b32 s43, 0, s43
    s_add_u32 m0, s76, s62
    s_add_u32 s75, s75, 36864
    buffer_load_dwordx4 v12, s[24:27], s75 offen  lds
    buffer_load_dwordx4 v13, s[24:27], s75 offen offset:1024  lds
    buffer_load_dwordx4 v14, s[24:27], s75 offen offset:2048  lds
    buffer_load_dwordx4 v15, s[24:27], s75 offen offset:3072  lds
    s_add_u32 m0, s76, s63
    s_nop 0
    buffer_load_dwordx4 v16, s[24:27], s75 offen  lds
    s_add_u32 s76, s76, 20480
    s_cmp_eq_u32 s76, 163840
    s_cselect_b32 s76, 0, s76
    s_waitcnt vmcnt(23)
    s_barrier
    s_add_u32 s60, s43, s57
    s_add_u32 s61, s44, s57
    s_mov_b32 m0, s60
    v_xor_b32 v37, 64, v30
    buffer_load_dwordx4 v30, s[16:19], s61 offen nt lds
    s_mov_b32 m0, s60
    s_nop 0
    buffer_load_dwordx4 v37, s[16:19], s61 offen offset:1024 nt lds
    s_add_u32 s60, s60, 8192
    s_mov_b32 m0, s60
    v_xor_b32 v38, 128, v31
    buffer_load_dwordx4 v31, s[20:23], s61 offen nt lds
    s_mov_b32 m0, s60
    s_add_u32 s44, s44, 8192
    buffer_load_dwordx4 v38, s[20:23], s61 offen offset:1024 nt lds
    s_cmp_eq_u32 s44, 131072
    s_cselect_b32 s44, 524288, s44
    s_add_u32 s43, s43, 16384
    s_cmp_eq_u32 s43, 81920
    s_cselect_b32 s43, 0, s43
    s_waitcnt vmcnt(18)
    s_barrier
    s_add_u32 s60, s43, s57
    s_add_u32 s61, s44, s57
    s_mov_b32 m0, s60
    v_xor_b32 v37, 64, v30
    buffer_load_dwordx4 v30, s[16:19], s61 offen nt lds
    s_mov_b32 m0, s60
    s_nop 0
    buffer_load_dwordx4 v37, s[16:19], s61 offen offset:1024 nt lds
    s_add_u32 s60, s60, 8192
    s_mov_b32 m0, s60
    v_xor_b32 v38, 128, v31
    buffer_load_dwordx4 v31, s[20:23], s61 offen nt lds
    s_mov_b32 m0, s60
    s_add_u32 s44, s44, 8192
    buffer_load_dwordx4 v38, s[20:23], s61 offen offset:1024 nt lds
    s_cmp_eq_u32 s44, 131072
    s_cselect_b32 s44, 524288, s44
    s_add_u32 s43, s43, 16384
    s_cmp_eq_u32 s43, 81920
    s_cselect_b32 s43, 0, s43
    s_waitcnt vmcnt(13)
    s_barrier
    s_add_u32 s60, s43, s57
    s_add_u32 s61, s44, s57
    s_mov_b32 m0, s60
    v_xor_b32 v37, 64, v30
    buffer_load_dwordx4 v30, s[16:19], s61 offen nt lds
    s_mov_b32 m0, s60
    s_nop 0
    buffer_load_dwordx4 v37, s[16:19], s61 offen offset:1024 nt lds
    s_add_u32 s60, s60, 8192
    s_mov_b32 m0, s60
    v_xor_b32 v38, 128, v31
    buffer_load_dwordx4 v31, s[20:23], s61 offen nt lds
    s_mov_b32 m0, s60
    s_add_u32 s44, s44, 8192
    buffer_load_dwordx4 v38, s[20:23], s61 offen offset:1024 nt lds
    s_cmp_eq_u32 s44, 131072
    s_cselect_b32 s44, 524288, s44
    s_add_u32 s43, s43, 16384
    s_cmp_eq_u32 s43, 81920
    s_cselect_b32 s43, 0, s43
    s_waitcnt vmcnt(8)
    s_barrier
    s_mov_b32 s79, 0
    s_waitcnt vmcnt(0)
    s_barrier
    s_add_u32 m0, s76, s62
    s_add_u32 s75, s75, 36864
    buffer_load_dwordx4 v12, s[24:27], s75 offen  lds
    buffer_load_dwordx4 v13, s[24:27], s75 offen offset:1024  lds
    buffer_load_dwordx4 v14, s[24:27], s75 offen offset:2048  lds
    buffer_load_dwordx4 v15, s[24:27], s75 offen offset:3072  lds
    s_add_u32 m0, s76, s63
    s_nop 0
    buffer_load_dwordx4 v16, s[24:27], s75 offen  lds
    s_add_u32 s76, s76, 20480
    s_cmp_eq_u32 s76, 163840
    s_cselect_b32 s76, 0, s76
    s_add_u32 m0, s76, s62
    s_add_u32 s75, s75, 36864
    buffer_load_dwordx4 v12, s[24:27], s75 offen  lds
    buffer_load_dwordx4 v13, s[24:27], s75 offen offset:1024  lds
    buffer_load_dwordx4 v14, s[24:27], s75 offen offset:2048  lds
    buffer_load_dwordx4 v15, s[24:27], s75 offen offset:3072  lds
    s_add_u32 m0, s76, s63
    s_nop 0
    buffer_load_dwordx4 v16, s[24:27], s75 offen  lds
    s_add_u32 s76, s76, 20480
    s_cmp_eq_u32 s76, 163840
    s_cselect_b32 s76, 0, s76
    v_lshrrev_b32 v2, 4, v1
    v_bfe_u32 v3, v1, 2, 2
    v_lshlrev_b32 v2, 2, v2
    v_add_u32 v2, v2, v3
    v_mul_u32_u24 v2, 288, v2
    v_and_b32 v3, 3, v1
    v_lshlrev_b32 v3, 3, v3
    v_add_u32 v2, v2, v3
    v_add_u32 v24, 10400, v2
    s_lshl_b32 s45, s39, 10
    v_add_u32 v25, s45, v26
    v_mov_b64 v[160:161], 0
    v_mov_b64 v[162:163], 0
    v_mov_b64 v[164:165], 0
    v_mov_b64 v[166:167], 0
    v_mov_b64 v[168:169], 0
    v_mov_b64 v[170:171], 0
    v_mov_b64 v[172:173], 0
    v_mov_b64 v[174:175], 0
    v_mov_b64 v[176:177], 0
    v_mov_b64 v[178:179], 0
    v_mov_b64 v[180:181], 0
    v_mov_b64 v[182:183], 0
    v_mov_b64 v[184:185], 0
    v_mov_b64 v[186:187], 0
    v_mov_b64 v[188:189], 0
    v_mov_b64 v[190:191], 0
    s_mov_b32 s77, 81920
    v_add_u32 v2, s77, v24
    v_add_u32 v3, s77, v25
    s_add_u32 s77, s77, 20480
    s_cmp_eq_u32 s77, 163840
    s_cselect_b32 s77, 0, s77
    ds_read_b128 v[56:59], v3 offset:0
    ds_read_b128 v[60:63], v3 offset:1024
    ds_read_b64_tr_b16 v[80:81], v2 offset:0
    ds_read_b64_tr_b16 v[82:83], v2 offset:4608
    ds_read_b64_tr_b16 v[84:85], v2 offset:32
    ds_read_b64_tr_b16 v[86:87], v2 offset:4640
    ds_read_b64_tr_b16 v[88:89], v2 offset:64
    ds_read_b64_tr_b16 v[90:91], v2 offset:4672
    ds_read_b64_tr_b16 v[92:93], v2 offset:96
    ds_read_b64_tr_b16 v[94:95], v2 offset:4704
    s_waitcnt lgkmcnt(0)
    s_barrier
    v_mfma_f32_16x16x32_bf16 v[160:163], v[80:83], v[56:59], v[160:163]
    v_add_u32 v4, s77, v24
    v_add_u32 v5, s77, v25
    s_add_u32 s77, s77, 20480
    s_cmp_eq_u32 s77, 163840
    s_cselect_b32 s77, 0, s77
    s_add_u32 m0, s76, s62
    s_add_u32 s75, s75, 36864
    buffer_load_dwordx4 v12, s[24:27], s75 offen  lds
    v_mfma_f32_16x16x32_bf16 v[176:179], v[80:83], v[60:63], v[176:179]
    ds_read_b128 v[68:71], v5 offset:0
    v_mfma_f32_16x16x32_bf16 v[164:167], v[84:87], v[56:59], v[164:167]
    ds_read_b128 v[72:75], v5 offset:1024
    buffer_load_dwordx4 v13, s[24:27], s75 offen offset:1024  lds
    v_mfma_f32_16x16x32_bf16 v[180:183], v[84:87], v[60:63], v[180:183]
    ds_read_b64_tr_b16 v[220:221], v4 offset:0
    ds_read_b64_tr_b16 v[222:223], v4 offset:4608
    v_mfma_f32_16x16x32_bf16 v[168:171], v[88:91], v[56:59], v[168:171]
    ds_read_b64_tr_b16 v[224:225], v4 offset:32
    ds_read_b64_tr_b16 v[226:227], v4 offset:4640
    buffer_load_dwordx4 v14, s[24:27], s75 offen offset:2048  lds
    v_mfma_f32_16x16x32_bf16 v[184:187], v[88:91], v[60:63], v[184:187]
    ds_read_b64_tr_b16 v[228:229], v4 offset:64
    ds_read_b64_tr_b16 v[230:231], v4 offset:4672
    buffer_load_dwordx4 v15, s[24:27], s75 offen offset:3072  lds
    v_mfma_f32_16x16x32_bf16 v[172:175], v[92:95], v[56:59], v[172:175]
    ds_read_b64_tr_b16 v[232:233], v4 offset:96
    ds_read_b64_tr_b16 v[234:235], v4 offset:4704
    v_mfma_f32_16x16x32_bf16 v[188:191], v[92:95], v[60:63], v[188:191]
    s_add_u32 m0, s76, s63
    s_nop 0
    buffer_load_dwordx4 v16, s[24:27], s75 offen  lds
    s_add_u32 s76, s76, 20480
    s_cmp_eq_u32 s76, 163840
    s_cselect_b32 s76, 0, s76
    s_waitcnt lgkmcnt(6)
    v_mfma_f32_16x16x32_bf16 v[160:163], v[220:223], v[68:71], v[160:163]
    v_add_u32 v2, s77, v24
    v_add_u32 v3, s77, v25
    s_add_u32 s77, s77, 20480
    s_cmp_eq_u32 s77, 163840
    s_cselect_b32 s77, 0, s77
    s_add_u32 m0, s76, s62
    s_add_u32 s75, s75, 36864
    buffer_load_dwordx4 v12, s[24:27], s75 offen  lds
    v_mfma_f32_16x16x32_bf16 v[176:179], v[220:223], v[72:75], v[176:179]
    ds_read_b128 v[56:59], v3 offset:0
    s_waitcnt lgkmcnt(5)
    v_mfma_f32_16x16x32_bf16 v[164:167], v[224:227], v[68:71], v[164:167]
    ds_read_b128 v[60:63], v3 offset:1024
    buffer_load_dwordx4 v13, s[24:27], s75 offen offset:1024  lds
    v_mfma_f32_16x16x32_bf16 v[180:183], v[224:227], v[72:75], v[180:183]
    ds_read_b64_tr_b16 v[80:81], v2 offset:0
    ds_read_b64_tr_b16 v[82:83], v2 offset:4608
    s_waitcnt lgkmcnt(6)
    v_mfma_f32_16x16x32_bf16 v[168:171], v[228:231], v[68:71], v[168:171]
    ds_read_b64_tr_b16 v[84:85], v2 offset:32
    ds_read_b64_tr_b16 v[86:87], v2 offset:4640
    buffer_load_dwordx4 v14, s[24:27], s75 offen offset:2048  lds
    v_mfma_f32_16x16x32_bf16 v[184:187], v[228:231], v[72:75], v[184:187]
    ds_read_b64_tr_b16 v[88:89], v2 offset:64
    ds_read_b64_tr_b16 v[90:91], v2 offset:4672
    buffer_load_dwordx4 v15, s[24:27], s75 offen offset:3072  lds
    s_waitcnt lgkmcnt(8)
    v_mfma_f32_16x16x32_bf16 v[172:175], v[232:235], v[68:71], v[172:175]
    ds_read_b64_tr_b16 v[92:93], v2 offset:96
    ds_read_b64_tr_b16 v[94:95], v2 offset:4704
    v_mfma_f32_16x16x32_bf16 v[188:191], v[232:235], v[72:75], v[188:191]
    s_add_u32 m0, s76, s63
    s_nop 0
    buffer_load_dwordx4 v16, s[24:27], s75 offen  lds
    s_add_u32 s76, s76, 20480
    s_cmp_eq_u32 s76, 163840
    s_cselect_b32 s76, 0, s76
    s_waitcnt lgkmcnt(0)
    s_waitcnt vmcnt(15)
    s_barrier
    v_mfma_f32_16x16x32_bf16 v[160:163], v[80:83], v[56:59], v[160:163]
    v_add_u32 v4, s77, v24
    v_add_u32 v5, s77, v25
    s_add_u32 s77, s77, 20480
    s_cmp_eq_u32 s77, 163840
    s_cselect_b32 s77, 0, s77
    s_add_u32 m0, s76, s62
    s_add_u32 s75, s75, 36864
    buffer_load_dwordx4 v12, s[24:27], s75 offen  lds
    v_mfma_f32_16x16x32_bf16 v[176:179], v[80:83], v[60:63], v[176:179]
    ds_read_b128 v[68:71], v5 offset:0
    v_mfma_f32_16x16x32_bf16 v[164:167], v[84:87], v[56:59], v[164:167]
    ds_read_b128 v[72:75], v5 offset:1024
    buffer_load_dwordx4 v13, s[24:27], s75 offen offset:1024  lds
    v_mfma_f32_16x16x32_bf16 v[180:183], v[84:87], v[60:63], v[180:183]
    ds_read_b64_tr_b16 v[220:221], v4 offset:0
    ds_read_b64_tr_b16 v[222:223], v4 offset:4608
    v_mfma_f32_16x16x32_bf16 v[168:171], v[88:91], v[56:59], v[168:171]
    ds_read_b64_tr_b16 v[224:225], v4 offset:32
    ds_read_b64_tr_b16 v[226:227], v4 offset:4640
    buffer_load_dwordx4 v14, s[24:27], s75 offen offset:2048  lds
    v_mfma_f32_16x16x32_bf16 v[184:187], v[88:91], v[60:63], v[184:187]
    ds_read_b64_tr_b16 v[228:229], v4 offset:64
    ds_read_b64_tr_b16 v[230:231], v4 offset:4672
    buffer_load_dwordx4 v15, s[24:27], s75 offen offset:3072  lds
    v_mfma_f32_16x16x32_bf16 v[172:175], v[92:95], v[56:59], v[172:175]
    ds_read_b64_tr_b16 v[232:233], v4 offset:96
    ds_read_b64_tr_b16 v[234:235], v4 offset:4704
    v_mfma_f32_16x16x32_bf16 v[188:191], v[92:95], v[60:63], v[188:191]
    s_add_u32 m0, s76, s63
    s_nop 0
    buffer_load_dwordx4 v16, s[24:27], s75 offen  lds
    s_add_u32 s76, s76, 20480
    s_cmp_eq_u32 s76, 163840
    s_cselect_b32 s76, 0, s76
    s_waitcnt lgkmcnt(6)
    v_mfma_f32_16x16x32_bf16 v[160:163], v[220:223], v[68:71], v[160:163]
    v_add_u32 v2, s77, v24
    v_add_u32 v3, s77, v25
    s_add_u32 s77, s77, 20480
    s_cmp_eq_u32 s77, 163840
    s_cselect_b32 s77, 0, s77
    s_add_u32 m0, s76, s62
    s_add_u32 s75, s75, 36864
    buffer_load_dwordx4 v12, s[24:27], s75 offen  lds
    v_mfma_f32_16x16x32_bf16 v[176:179], v[220:223], v[72:75], v[176:179]
    ds_read_b128 v[56:59], v3 offset:0
    s_waitcnt lgkmcnt(5)
    v_mfma_f32_16x16x32_bf16 v[164:167], v[224:227], v[68:71], v[164:167]
    ds_read_b128 v[60:63], v3 offset:1024
    buffer_load_dwordx4 v13, s[24:27], s75 offen offset:1024  lds
    v_mfma_f32_16x16x32_bf16 v[180:183], v[224:227], v[72:75], v[180:183]
    ds_read_b64_tr_b16 v[80:81], v2 offset:0
    ds_read_b64_tr_b16 v[82:83], v2 offset:4608
    s_waitcnt lgkmcnt(6)
    v_mfma_f32_16x16x32_bf16 v[168:171], v[228:231], v[68:71], v[168:171]
    ds_read_b64_tr_b16 v[84:85], v2 offset:32
    ds_read_b64_tr_b16 v[86:87], v2 offset:4640
    buffer_load_dwordx4 v14, s[24:27], s75 offen offset:2048  lds
    v_mfma_f32_16x16x32_bf16 v[184:187], v[228:231], v[72:75], v[184:187]
    ds_read_b64_tr_b16 v[88:89], v2 offset:64
    ds_read_b64_tr_b16 v[90:91], v2 offset:4672
    buffer_load_dwordx4 v15, s[24:27], s75 offen offset:3072  lds
    s_waitcnt lgkmcnt(8)
    v_mfma_f32_16x16x32_bf16 v[172:175], v[232:235], v[68:71], v[172:175]
    ds_read_b64_tr_b16 v[92:93], v2 offset:96
    ds_read_b64_tr_b16 v[94:95], v2 offset:4704
    v_mfma_f32_16x16x32_bf16 v[188:191], v[232:235], v[72:75], v[188:191]
    s_add_u32 m0, s76, s63
    s_nop 0
    buffer_load_dwordx4 v16, s[24:27], s75 offen  lds
    s_add_u32 s76, s76, 20480
    s_cmp_eq_u32 s76, 163840
    s_cselect_b32 s76, 0, s76
    s_waitcnt lgkmcnt(0)
    s_waitcnt vmcnt(15)
    s_mov_b32 s41, 4
L_op_106:
    s_barrier
    s_cmp_lg_u32 s41, 8
    s_cbranch_scc1 L_k6_108
L_k6_108:
    s_cmp_lg_u32 s41, 10
    s_cbranch_scc1 L_k10_109
    s_cmp_lg_u32 s33, 4
    s_cbranch_scc1 L_polld_111
    s_and_b32 s45, s49, 0xffffff00
    v_mov_b32 v2, 0
    s_mov_b32 s46, 0
L_poll_110:
    buffer_load_dwordx4 v[4:7], v2, s[28:31], s45 offen sc0 sc1
    s_waitcnt vmcnt(0)
    v_and_b32 v4, v4, v5
    v_and_b32 v6, v6, v7
    v_and_b32 v4, v4, v6
    s_nop 0
    v_readfirstlane_b32 s47, v4
    s_add_u32 s46, s46, 1
    s_and_b32 s47, s47, 2
    s_cmp_eq_u32 s47, 2
    s_cbranch_scc1 L_polld_111
    s_sleep 2
    s_cmp_lt_u32 s46, 200000
    s_cbranch_scc1 L_poll_110
L_polld_111:
    s_barrier
L_k10_109:
    s_cmp_ge_u32 s41, 26
    s_cbranch_scc1 L_opn_107
    v_mfma_f32_16x16x32_bf16 v[160:163], v[80:83], v[56:59], v[160:163]
    v_add_u32 v4, s77, v24
    v_add_u32 v5, s77, v25
    s_add_u32 s77, s77, 20480
    s_cmp_eq_u32 s77, 163840
    s_cselect_b32 s77, 0, s77
    s_add_u32 m0, s76, s62
    s_add_u32 s75, s75, 36864
    buffer_load_dwordx4 v12, s[24:27], s75 offen  lds
    v_mfma_f32_16x16x32_bf16 v[176:179], v[80:83], v[60:63], v[176:179]
    ds_read_b128 v[68:71], v5 offset:0
    v_mfma_f32_16x16x32_bf16 v[164:167], v[84:87], v[56:59], v[164:167]
    ds_read_b128 v[72:75], v5 offset:1024
    buffer_load_dwordx4 v13, s[24:27], s75 offen offset:1024  lds
    v_mfma_f32_16x16x32_bf16 v[180:183], v[84:87], v[60:63], v[180:183]
    ds_read_b64_tr_b16 v[220:221], v4 offset:0
    ds_read_b64_tr_b16 v[222:223], v4 offset:4608
    v_mfma_f32_16x16x32_bf16 v[168:171], v[88:91], v[56:59], v[168:171]
    ds_read_b64_tr_b16 v[224:225], v4 offset:32
    ds_read_b64_tr_b16 v[226:227], v4 offset:4640
    buffer_load_dwordx4 v14, s[24:27], s75 offen offset:2048  lds
    v_mfma_f32_16x16x32_bf16 v[184:187], v[88:91], v[60:63], v[184:187]
    ds_read_b64_tr_b16 v[228:229], v4 offset:64
    ds_read_b64_tr_b16 v[230:231], v4 offset:4672
    buffer_load_dwordx4 v15, s[24:27], s75 offen offset:3072  lds
    v_mfma_f32_16x16x32_bf16 v[172:175], v[92:95], v[56:59], v[172:175]
    ds_read_b64_tr_b16 v[232:233], v4 offset:96
    ds_read_b64_tr_b16 v[234:235], v4 offset:4704
    v_mfma_f32_16x16x32_bf16 v[188:191], v[92:95], v[60:63], v[188:191]
    s_add_u32 m0, s76, s63
    s_nop 0
    buffer_load_dwordx4 v16, s[24:27], s75 offen  lds
    s_add_u32 s76, s76, 20480
    s_cmp_eq_u32 s76, 163840
    s_cselect_b32 s76, 0, s76
    s_waitcnt lgkmcnt(6)
    v_mfma_f32_16x16x32_bf16 v[160:163], v[220:223], v[68:71], v[160:163]
    v_add_u32 v2, s77, v24
    v_add_u32 v3, s77, v25
    s_add_u32 s77, s77, 20480
    s_cmp_eq_u32 s77, 163840
    s_cselect_b32 s77, 0, s77
    s_add_u32 m0, s76, s62
    s_add_u32 s75, s75, 36864
    buffer_load_dwordx4 v12, s[24:27], s75 offen  lds
    v_mfma_f32_16x16x32_bf16 v[176:179], v[220:223], v[72:75], v[176:179]
    ds_read_b128 v[56:59], v3 offset:0
    s_waitcnt lgkmcnt(5)
    v_mfma_f32_16x16x32_bf16 v[164:167], v[224:227], v[68:71], v[164:167]
    ds_read_b128 v[60:63], v3 offset:1024
    buffer_load_dwordx4 v13, s[24:27], s75 offen offset:1024  lds
    v_mfma_f32_16x16x32_bf16 v[180:183], v[224:227], v[72:75], v[180:183]
    ds_read_b64_tr_b16 v[80:81], v2 offset:0
    ds_read_b64_tr_b16 v[82:83], v2 offset:4608
    s_waitcnt lgkmcnt(6)
    v_mfma_f32_16x16x32_bf16 v[168:171], v[228:231], v[68:71], v[168:171]
    ds_read_b64_tr_b16 v[84:85], v2 offset:32
    ds_read_b64_tr_b16 v[86:87], v2 offset:4640
    buffer_load_dwordx4 v14, s[24:27], s75 offen offset:2048  lds
    v_mfma_f32_16x16x32_bf16 v[184:187], v[228:231], v[72:75], v[184:187]
    ds_read_b64_tr_b16 v[88:89], v2 offset:64
    ds_read_b64_tr_b16 v[90:91], v2 offset:4672
    buffer_load_dwordx4 v15, s[24:27], s75 offen offset:3072  lds
    s_waitcnt lgkmcnt(8)
    v_mfma_f32_16x16x32_bf16 v[172:175], v[232:235], v[68:71], v[172:175]
    ds_read_b64_tr_b16 v[92:93], v2 offset:96
    ds_read_b64_tr_b16 v[94:95], v2 offset:4704
    v_mfma_f32_16x16x32_bf16 v[188:191], v[232:235], v[72:75], v[188:191]
    s_add_u32 m0, s76, s63
    s_nop 0
    buffer_load_dwordx4 v16, s[24:27], s75 offen  lds
    s_add_u32 s76, s76, 20480
    s_cmp_eq_u32 s76, 163840
    s_cselect_b32 s76, 0, s76
    s_waitcnt lgkmcnt(0)
    s_waitcnt vmcnt(15)
    s_add_u32 s41, s41, 2
    s_branch L_op_106
L_opn_107:
    v_mfma_f32_16x16x32_bf16 v[160:163], v[80:83], v[56:59], v[160:163]
    v_add_u32 v4, s77, v24
    v_add_u32 v5, s77, v25
    s_add_u32 s77, s77, 20480
    s_cmp_eq_u32 s77, 163840
    s_cselect_b32 s77, 0, s77
    v_mfma_f32_16x16x32_bf16 v[176:179], v[80:83], v[60:63], v[176:179]
    ds_read_b128 v[68:71], v5 offset:0
    v_mfma_f32_16x16x32_bf16 v[164:167], v[84:87], v[56:59], v[164:167]
    ds_read_b128 v[72:75], v5 offset:1024
    v_mfma_f32_16x16x32_bf16 v[180:183], v[84:87], v[60:63], v[180:183]
    ds_read_b64_tr_b16 v[220:221], v4 offset:0
    ds_read_b64_tr_b16 v[222:223], v4 offset:4608
    v_mfma_f32_16x16x32_bf16 v[168:171], v[88:91], v[56:59], v[168:171]
    ds_read_b64_tr_b16 v[224:225], v4 offset:32
    ds_read_b64_tr_b16 v[226:227], v4 offset:4640
    v_mfma_f32_16x16x32_bf16 v[184:187], v[88:91], v[60:63], v[184:187]
    ds_read_b64_tr_b16 v[228:229], v4 offset:64
    ds_read_b64_tr_b16 v[230:231], v4 offset:4672
    v_mfma_f32_16x16x32_bf16 v[172:175], v[92:95], v[56:59], v[172:175]
    ds_read_b64_tr_b16 v[232:233], v4 offset:96
    ds_read_b64_tr_b16 v[234:235], v4 offset:4704
    v_mfma_f32_16x16x32_bf16 v[188:191], v[92:95], v[60:63], v[188:191]
    s_waitcnt lgkmcnt(6)
    v_mfma_f32_16x16x32_bf16 v[160:163], v[220:223], v[68:71], v[160:163]
    v_add_u32 v2, s77, v24
    v_add_u32 v3, s77, v25
    s_add_u32 s77, s77, 20480
    s_cmp_eq_u32 s77, 163840
    s_cselect_b32 s77, 0, s77
    v_mfma_f32_16x16x32_bf16 v[176:179], v[220:223], v[72:75], v[176:179]
    ds_read_b128 v[56:59], v3 offset:0
    s_waitcnt lgkmcnt(5)
    v_mfma_f32_16x16x32_bf16 v[164:167], v[224:227], v[68:71], v[164:167]
    ds_read_b128 v[60:63], v3 offset:1024
    v_mfma_f32_16x16x32_bf16 v[180:183], v[224:227], v[72:75], v[180:183]
    ds_read_b64_tr_b16 v[80:81], v2 offset:0
    ds_read_b64_tr_b16 v[82:83], v2 offset:4608
    s_waitcnt lgkmcnt(6)
    v_mfma_f32_16x16x32_bf16 v[168:171], v[228:231], v[68:71], v[168:171]
    ds_read_b64_tr_b16 v[84:85], v2 offset:32
    ds_read_b64_tr_b16 v[86:87], v2 offset:4640
    v_mfma_f32_16x16x32_bf16 v[184:187], v[228:231], v[72:75], v[184:187]
    ds_read_b64_tr_b16 v[88:89], v2 offset:64
    ds_read_b64_tr_b16 v[90:91], v2 offset:4672
    s_waitcnt lgkmcnt(8)
    v_mfma_f32_16x16x32_bf16 v[172:175], v[232:235], v[68:71], v[172:175]
    ds_read_b64_tr_b16 v[92:93], v2 offset:96
    ds_read_b64_tr_b16 v[94:95], v2 offset:4704
    v_mfma_f32_16x16x32_bf16 v[188:191], v[232:235], v[72:75], v[188:191]
    s_waitcnt lgkmcnt(0)
    s_waitcnt vmcnt(0)
    s_add_u32 s41, s41, 2
    s_cmp_lt_u32 s41, 32
    s_cbranch_scc1 L_op_106
    s_nop 7
    s_mul_i32 s66, s39, 3
    s_lshr_b32 s66, s66, 3
    s_lshl_b32 s78, s48, 8
    s_lshl_b32 s46, s37, 2
    s_add_u32 s78, s78, s46
    s_add_u32 s78, s78, 117456896
    s_lshl_b32 s67, s48, 4
    s_add_u32 s67, s67, s66
    s_lshl_b32 s67, s67, 1
    s_add_u32 s67, s67, s79
    s_lshl_b32 s67, s67, 13
    s_add_u32 s67, s67, 67108864
    s_cmp_eq_u32 s66, s37
    s_cbranch_scc1 L_keep_112
    v_cvt_pk_bf16_f32 v56, v160, v161
    v_cvt_pk_bf16_f32 v57, v162, v163
    v_cvt_pk_bf16_f32 v58, v164, v165
    v_cvt_pk_bf16_f32 v59, v166, v167
    v_cvt_pk_bf16_f32 v60, v168, v169
    v_cvt_pk_bf16_f32 v61, v170, v171
    v_cvt_pk_bf16_f32 v62, v172, v173
    v_cvt_pk_bf16_f32 v63, v174, v175
    v_cvt_pk_bf16_f32 v64, v176, v177
    v_cvt_pk_bf16_f32 v65, v178, v179
    v_cvt_pk_bf16_f32 v66, v180, v181
    v_cvt_pk_bf16_f32 v67, v182, v183
    v_cvt_pk_bf16_f32 v68, v184, v185
    v_cvt_pk_bf16_f32 v69, v186, v187
    v_cvt_pk_bf16_f32 v70, v188, v189
    v_cvt_pk_bf16_f32 v71, v190, v191
    s_lshl_b32 s45, s37, 16
    s_add_u32 s45, s45, s67
    s_add_u32 s46, s45, 0
    buffer_store_dwordx4 v[56:59], v26, s[28:31], s46 offen sc0 sc1
    s_add_u32 s46, s45, 1024
    buffer_store_dwordx4 v[60:63], v26, s[28:31], s46 offen sc0 sc1
    s_add_u32 s46, s45, 2048
    buffer_store_dwordx4 v[64:67], v26, s[28:31], s46 offen sc0 sc1
    s_add_u32 s46, s45, 3072
    buffer_store_dwordx4 v[68:71], v26, s[28:31], s46 offen sc0 sc1
L_keep_112:
    s_waitcnt vmcnt(0)
    s_barrier
    s_cmp_lg_u32 s33, 0
    s_cbranch_scc1 L_sig_115
    v_mov_b32 v2, 0
    v_mov_b32 v3, 1
    s_mov_b64 s[70:71], exec
    s_mov_b64 exec, 1
    buffer_store_dword v3, v2, s[28:31], s78 offen sc0 sc1
    s_mov_b64 exec, s[70:71]
L_sig_115:
    s_cmp_lg_u32 s33, 0
    s_cbranch_scc1 L_polld_117
    s_and_b32 s45, s78, 0xffffff00
    v_mov_b32 v2, 0
    s_mov_b32 s46, 0
L_poll_116:
    buffer_load_dwordx4 v[4:7], v2, s[28:31], s45 offen sc0 sc1
    s_waitcnt vmcnt(0)
    v_and_b32 v4, v4, v5
    v_and_b32 v6, v6, v7
    v_and_b32 v4, v4, v6
    s_nop 0
    v_readfirstlane_b32 s47, v4
    s_add_u32 s46, s46, 1
    s_and_b32 s47, s47, 1
    s_cmp_eq_u32 s47, 1
    s_cbranch_scc1 L_polld_117
    s_sleep 2
    s_cmp_lt_u32 s46, 200000
    s_cbranch_scc1 L_poll_116
L_polld_117:
    s_barrier
    s_cmp_lg_u32 s66, s37
    s_cbranch_scc1 L_s2e_114
    s_add_u32 s45, s37, 1
    s_and_b32 s45, s45, 3
    s_lshl_b32 s45, s45, 16
    s_add_u32 s45, s45, s67
    s_add_u32 s46, s45, 0
    buffer_load_dwordx4 v[56:59], v26, s[28:31], s46 offen sc0 sc1
    s_add_u32 s46, s45, 1024
    buffer_load_dwordx4 v[60:63], v26, s[28:31], s46 offen sc0 sc1
    s_add_u32 s46, s45, 2048
    buffer_load_dwordx4 v[64:67], v26, s[28:31], s46 offen sc0 sc1
    s_add_u32 s46, s45, 3072
    buffer_load_dwordx4 v[68:71], v26, s[28:31], s46 offen sc0 sc1
    s_add_u32 s45, s37, 2
    s_and_b32 s45, s45, 3
    s_lshl_b32 s45, s45, 16
    s_add_u32 s45, s45, s67
    s_add_u32 s46, s45, 0
    buffer_load_dwordx4 v[88:91], v26, s[28:31], s46 offen sc0 sc1
    s_add_u32 s46, s45, 1024
    buffer_load_dwordx4 v[92:95], v26, s[28:31], s46 offen sc0 sc1
    s_add_u32 s46, s45, 2048
    buffer_load_dwordx4 v[96:99], v26, s[28:31], s46 offen sc0 sc1
    s_add_u32 s46, s45, 3072
    buffer_load_dwordx4 v[100:103], v26, s[28:31], s46 offen sc0 sc1
    s_add_u32 s45, s37, 3
    s_and_b32 s45, s45, 3
    s_lshl_b32 s45, s45, 16
    s_add_u32 s45, s45, s67
    s_add_u32 s46, s45, 0
    buffer_load_dwordx4 v[120:123], v26, s[28:31], s46 offen sc0 sc1
    s_add_u32 s46, s45, 1024
    buffer_load_dwordx4 v[124:127], v26, s[28:31], s46 offen sc0 sc1
    s_add_u32 s46, s45, 2048
    buffer_load_dwordx4 v[128:131], v26, s[28:31], s46 offen sc0 sc1
    s_add_u32 s46, s45, 3072
    buffer_load_dwordx4 v[132:135], v26, s[28:31], s46 offen sc0 sc1
    s_load_dwordx2 s[80:81], s[0:1], 80
    v_and_b32 v2, 15, v1
    v_mul_u32_u24 v2, 2304, v2
    v_lshrrev_b32 v3, 4, v1
    v_lshlrev_b32 v3, 3, v3
    v_add_u32 v2, v2, v3
    s_mul_i32 s45, s35, 160
    s_lshl_b32 s46, s39, 4
    s_add_u32 s45, s45, s46
    s_mul_i32 s45, s45, 2304
    s_mul_i32 s46, s34, 1152
    s_add_u32 s45, s45, s46
    s_mul_i32 s46, s38, 288
    s_add_u32 s45, s45, s46
    s_add_u32 s45, s45, 160
    s_waitcnt lgkmcnt(0)
    s_mov_b32 s16, s80
    s_mov_b32 s17, s81
    s_mov_b32 s18, 2949120
    s_mov_b32 s19, 0x20000
    s_waitcnt vmcnt(8)
    v_lshlrev_b32 v4, 16, v56
    v_and_b32 v5, 0xffff0000, v56
    v_add_f32 v160, v160, v4
    v_add_f32 v161, v161, v5
    v_lshlrev_b32 v4, 16, v57
    v_and_b32 v5, 0xffff0000, v57
    v_add_f32 v162, v162, v4
    v_add_f32 v163, v163, v5
    v_lshlrev_b32 v4, 16, v58
    v_and_b32 v5, 0xffff0000, v58
    v_add_f32 v164, v164, v4
    v_add_f32 v165, v165, v5
    v_lshlrev_b32 v4, 16, v59
    v_and_b32 v5, 0xffff0000, v59
    v_add_f32 v166, v166, v4
    v_add_f32 v167, v167, v5
    v_lshlrev_b32 v4, 16, v60
    v_and_b32 v5, 0xffff0000, v60
    v_add_f32 v168, v168, v4
    v_add_f32 v169, v169, v5
    v_lshlrev_b32 v4, 16, v61
    v_and_b32 v5, 0xffff0000, v61
    v_add_f32 v170, v170, v4
    v_add_f32 v171, v171, v5
    v_lshlrev_b32 v4, 16, v62
    v_and_b32 v5, 0xffff0000, v62
    v_add_f32 v172, v172, v4
    v_add_f32 v173, v173, v5
    v_lshlrev_b32 v4, 16, v63
    v_and_b32 v5, 0xffff0000, v63
    v_add_f32 v174, v174, v4
    v_add_f32 v175, v175, v5
    v_lshlrev_b32 v4, 16, v64
    v_and_b32 v5, 0xffff0000, v64
    v_add_f32 v176, v176, v4
    v_add_f32 v177, v177, v5
    v_lshlrev_b32 v4, 16, v65
    v_and_b32 v5, 0xffff0000, v65
    v_add_f32 v178, v178, v4
    v_add_f32 v179, v179, v5
    v_lshlrev_b32 v4, 16, v66
    v_and_b32 v5, 0xffff0000, v66
    v_add_f32 v180, v180, v4
    v_add_f32 v181, v181, v5
    v_lshlrev_b32 v4, 16, v67
    v_and_b32 v5, 0xffff0000, v67
    v_add_f32 v182, v182, v4
    v_add_f32 v183, v183, v5
    v_lshlrev_b32 v4, 16, v68
    v_and_b32 v5, 0xffff0000, v68
    v_add_f32 v184, v184, v4
    v_add_f32 v185, v185, v5
    v_lshlrev_b32 v4, 16, v69
    v_and_b32 v5, 0xffff0000, v69
    v_add_f32 v186, v186, v4
    v_add_f32 v187, v187, v5
    v_lshlrev_b32 v4, 16, v70
    v_and_b32 v5, 0xffff0000, v70
    v_add_f32 v188, v188, v4
    v_add_f32 v189, v189, v5
    v_lshlrev_b32 v4, 16, v71
    v_and_b32 v5, 0xffff0000, v71
    v_add_f32 v190, v190, v4
    v_add_f32 v191, v191, v5
    s_waitcnt vmcnt(4)
    v_lshlrev_b32 v4, 16, v88
    v_and_b32 v5, 0xffff0000, v88
    v_add_f32 v160, v160, v4
    v_add_f32 v161, v161, v5
    v_lshlrev_b32 v4, 16, v89
    v_and_b32 v5, 0xffff0000, v89
    v_add_f32 v162, v162, v4
    v_add_f32 v163, v163, v5
    v_lshlrev_b32 v4, 16, v90
    v_and_b32 v5, 0xffff0000, v90
    v_add_f32 v164, v164, v4
    v_add_f32 v165, v165, v5
    v_lshlrev_b32 v4, 16, v91
    v_and_b32 v5, 0xffff0000, v91
    v_add_f32 v166, v166, v4
    v_add_f32 v167, v167, v5
    v_lshlrev_b32 v4, 16, v92
    v_and_b32 v5, 0xffff0000, v92
    v_add_f32 v168, v168, v4
    v_add_f32 v169, v169, v5
    v_lshlrev_b32 v4, 16, v93
    v_and_b32 v5, 0xffff0000, v93
    v_add_f32 v170, v170, v4
    v_add_f32 v171, v171, v5
    v_lshlrev_b32 v4, 16, v94
    v_and_b32 v5, 0xffff0000, v94
    v_add_f32 v172, v172, v4
    v_add_f32 v173, v173, v5
    v_lshlrev_b32 v4, 16, v95
    v_and_b32 v5, 0xffff0000, v95
    v_add_f32 v174, v174, v4
    v_add_f32 v175, v175, v5
    v_lshlrev_b32 v4, 16, v96
    v_and_b32 v5, 0xffff0000, v96
    v_add_f32 v176, v176, v4
    v_add_f32 v177, v177, v5
    v_lshlrev_b32 v4, 16, v97
    v_and_b32 v5, 0xffff0000, v97
    v_add_f32 v178, v178, v4
    v_add_f32 v179, v179, v5
    v_lshlrev_b32 v4, 16, v98
    v_and_b32 v5, 0xffff0000, v98
    v_add_f32 v180, v180, v4
    v_add_f32 v181, v181, v5
    v_lshlrev_b32 v4, 16, v99
    v_and_b32 v5, 0xffff0000, v99
    v_add_f32 v182, v182, v4
    v_add_f32 v183, v183, v5
    v_lshlrev_b32 v4, 16, v100
    v_and_b32 v5, 0xffff0000, v100
    v_add_f32 v184, v184, v4
    v_add_f32 v185, v185, v5
    v_lshlrev_b32 v4, 16, v101
    v_and_b32 v5, 0xffff0000, v101
    v_add_f32 v186, v186, v4
    v_add_f32 v187, v187, v5
    v_lshlrev_b32 v4, 16, v102
    v_and_b32 v5, 0xffff0000, v102
    v_add_f32 v188, v188, v4
    v_add_f32 v189, v189, v5
    v_lshlrev_b32 v4, 16, v103
    v_and_b32 v5, 0xffff0000, v103
    v_add_f32 v190, v190, v4
    v_add_f32 v191, v191, v5
    s_waitcnt vmcnt(0)
    v_lshlrev_b32 v4, 16, v120
    v_and_b32 v5, 0xffff0000, v120
    v_add_f32 v160, v160, v4
    v_add_f32 v161, v161, v5
    v_lshlrev_b32 v4, 16, v121
    v_and_b32 v5, 0xffff0000, v121
    v_add_f32 v162, v162, v4
    v_add_f32 v163, v163, v5
    v_lshlrev_b32 v4, 16, v122
    v_and_b32 v5, 0xffff0000, v122
    v_add_f32 v164, v164, v4
    v_add_f32 v165, v165, v5
    v_lshlrev_b32 v4, 16, v123
    v_and_b32 v5, 0xffff0000, v123
    v_add_f32 v166, v166, v4
    v_add_f32 v167, v167, v5
    v_lshlrev_b32 v4, 16, v124
    v_and_b32 v5, 0xffff0000, v124
    v_add_f32 v168, v168, v4
    v_add_f32 v169, v169, v5
    v_lshlrev_b32 v4, 16, v125
    v_and_b32 v5, 0xffff0000, v125
    v_add_f32 v170, v170, v4
    v_add_f32 v171, v171, v5
    v_lshlrev_b32 v4, 16, v126
    v_and_b32 v5, 0xffff0000, v126
    v_add_f32 v172, v172, v4
    v_add_f32 v173, v173, v5
    v_lshlrev_b32 v4, 16, v127
    v_and_b32 v5, 0xffff0000, v127
    v_add_f32 v174, v174, v4
    v_add_f32 v175, v175, v5
    v_lshlrev_b32 v4, 16, v128
    v_and_b32 v5, 0xffff0000, v128
    v_add_f32 v176, v176, v4
    v_add_f32 v177, v177, v5
    v_lshlrev_b32 v4, 16, v129
    v_and_b32 v5, 0xffff0000, v129
    v_add_f32 v178, v178, v4
    v_add_f32 v179, v179, v5
    v_lshlrev_b32 v4, 16, v130
    v_and_b32 v5, 0xffff0000, v130
    v_add_f32 v180, v180, v4
    v_add_f32 v181, v181, v5
    v_lshlrev_b32 v4, 16, v131
    v_and_b32 v5, 0xffff0000, v131
    v_add_f32 v182, v182, v4
    v_add_f32 v183, v183, v5
    v_lshlrev_b32 v4, 16, v132
    v_and_b32 v5, 0xffff0000, v132
    v_add_f32 v184, v184, v4
    v_add_f32 v185, v185, v5
    v_lshlrev_b32 v4, 16, v133
    v_and_b32 v5, 0xffff0000, v133
    v_add_f32 v186, v186, v4
    v_add_f32 v187, v187, v5
    v_lshlrev_b32 v4, 16, v134
    v_and_b32 v5, 0xffff0000, v134
    v_add_f32 v188, v188, v4
    v_add_f32 v189, v189, v5
    v_lshlrev_b32 v4, 16, v135
    v_and_b32 v5, 0xffff0000, v135
    v_add_f32 v190, v190, v4
    v_add_f32 v191, v191, v5
    v_cvt_pk_bf16_f32 v56, v160, v161
    v_cvt_pk_bf16_f32 v57, v162, v163
    s_add_u32 s46, s45, 0
    buffer_store_dwordx2 v[56:57], v2, s[16:19], s46 offen
    v_cvt_pk_bf16_f32 v58, v164, v165
    v_cvt_pk_bf16_f32 v59, v166, v167
    s_add_u32 s46, s45, 32
    buffer_store_dwordx2 v[58:59], v2, s[16:19], s46 offen
    v_cvt_pk_bf16_f32 v60, v168, v169
    v_cvt_pk_bf16_f32 v61, v170, v171
    s_add_u32 s46, s45, 64
    buffer_store_dwordx2 v[60:61], v2, s[16:19], s46 offen
    v_cvt_pk_bf16_f32 v62, v172, v173
    v_cvt_pk_bf16_f32 v63, v174, v175
    s_add_u32 s46, s45, 96
    buffer_store_dwordx2 v[62:63], v2, s[16:19], s46 offen
    v_cvt_pk_bf16_f32 v64, v176, v177
    v_cvt_pk_bf16_f32 v65, v178, v179
    s_add_u32 s46, s45, 36864
    buffer_store_dwordx2 v[64:65], v2, s[16:19], s46 offen
    v_cvt_pk_bf16_f32 v66, v180, v181
    v_cvt_pk_bf16_f32 v67, v182, v183
    s_add_u32 s46, s45, 36896
    buffer_store_dwordx2 v[66:67], v2, s[16:19], s46 offen
    v_cvt_pk_bf16_f32 v68, v184, v185
    v_cvt_pk_bf16_f32 v69, v186, v187
    s_add_u32 s46, s45, 36928
    buffer_store_dwordx2 v[68:69], v2, s[16:19], s46 offen
    v_cvt_pk_bf16_f32 v70, v188, v189
    v_cvt_pk_bf16_f32 v71, v190, v191
    s_add_u32 s46, s45, 36960
    buffer_store_dwordx2 v[70:71], v2, s[16:19], s46 offen
L_s2e_114:
    s_branch L_k1_fin
L_k1_fin:
L_k1_end:
    s_endpgm
.section .rodata,"a"
.p2align 6
.amdhsa_kernel concat_heads__mha_block_cached__gqa_block_cached__near_ridge_kernel
  .amdhsa_next_free_vgpr 256
  .amdhsa_next_free_sgpr 102
  .amdhsa_accum_offset 256
  .amdhsa_group_segment_fixed_size 0
  .amdhsa_kernarg_size 104
  .amdhsa_user_sgpr_count 2
  .amdhsa_user_sgpr_kernarg_segment_ptr 1
  .amdhsa_system_sgpr_workgroup_id_x 1
.end_amdhsa_kernel
```
